```python
import torch

def _softmax(x, axis=-1):
    return torch.softmax(x, dim=axis)
def _gelu(x):
    return torch.nn.functional.gelu(x, approximate="tanh")
def _silu(x):
    return torch.nn.functional.silu(x)
def _sigmoid(x):
    return torch.sigmoid(x)
def _layernorm(x, axis=-1, eps=1e-5):
    m = x.mean(dim=axis, keepdim=True)
    v = x.var(dim=axis, keepdim=True, unbiased=False)
    return (x - m) / torch.sqrt(v + eps)
def _scatter_add(tgt, idx, src, axis=0):
    return tgt.clone().index_add_(axis, idx, src)
def _segment_sum(src, seg, n):
    out = torch.zeros((n,) + src.shape[1:], dtype=src.dtype)
    return out.index_add_(0, seg, src)
def _pad(x, pw):
    flat = tuple(v for pair in reversed(pw) for v in pair)
    return torch.nn.functional.pad(x, flat)

kernel_name = 'interleave_layers__linear_kernel_hedgehog__geglu_ffn__prompt'

def setup_inputs():

    _w = (lambda a: (lambda t: t.to(torch.bfloat16) if t.is_floating_point() else t)(torch.as_tensor(a)))
    def _A_setup():
        B, S, D, H = 1, 2048, 640, 32
        Dh = D // H
        return {
            "x": _w((lambda *s: torch.randn(*s, dtype=torch.bfloat16) * 0.05)(B, S, D)),
            "wqkv": _w((lambda *s: torch.randn(*s, dtype=torch.bfloat16) * 0.2)(D, 3 * D)),
            "w_phi": _w((lambda *s: torch.randn(*s, dtype=torch.bfloat16) * 0.2)(H, Dh, Dh) * (Dh ** -0.5)),
            "wo": _w((lambda *s: torch.randn(*s, dtype=torch.bfloat16) * 0.05)(D, D)),
        }
    _A_in = _A_setup()

    def _B_setup():
        B, S, D, F = 1, 2048, 640, 1728
        return {
            "x": _w((lambda *s: torch.randn(*s, dtype=torch.bfloat16) * 0.05)(B, S, D)),
            "w_gate": _w((lambda *s: torch.randn(*s, dtype=torch.bfloat16) * 0.05)(D, F)),
            "w_up": _w((lambda *s: torch.randn(*s, dtype=torch.bfloat16) * 0.05)(D, F)),
            "w_down": _w((lambda *s: torch.randn(*s, dtype=torch.bfloat16) * 0.05)(F, D)),
        }
    _B_in = _B_setup()

    return {
        "A_x": _A_in["x"],
        "A_wqkv": _A_in["wqkv"],
        "A_w_phi": _A_in["w_phi"],
        "A_wo": _A_in["wo"],
        "B_x": _B_in["x"],
        "B_w_gate": _B_in["w_gate"],
        "B_w_up": _B_in["w_up"],
        "B_w_down": _B_in["w_down"],
    }

def reference(A_x, A_wqkv, A_w_phi, A_wo, B_x, B_w_gate, B_w_up, B_w_down):
    def _A_ref(x, wqkv, w_phi, wo):
        B, S, D = x.shape
        H = 32; Dh = D // H
        qkv = (lambda x, *d: x.permute(*d))((x @ wqkv).reshape(B, S, 3, H, Dh), 2, 0, 3, 1, 4)
        q, k, v = qkv[0], qkv[1], qkv[2]
        pq = torch.einsum("bhsd,hdf->bhsf", q, w_phi)
        pk = torch.einsum("bhsd,hdf->bhsf", k, w_phi)
        phi_q = torch.concatenate([_softmax(pq, axis=-1), _softmax(-pq, axis=-1)], axis=-1)
        phi_k = torch.concatenate([_softmax(pk, axis=-1), _softmax(-pk, axis=-1)], axis=-1)
        kv = torch.einsum("bhsf,bhsd->bhfd", phi_k, v)
        z  = torch.einsum("bhsf->bhf", phi_k)
        num = torch.einsum("bhqf,bhfd->bhqd", phi_q, kv)
        den = torch.einsum("bhqf,bhf->bhq", phi_q, z)[..., None] + 1e-6
        o = num / den
        return (lambda x, *d: x.permute(*d))(o, 0, 2, 1, 3).reshape(B, S, D) @ wo

    def _B_ref(x, w_gate, w_up, w_down):
        return (_gelu(x @ w_gate) * (x @ w_up)) @ w_down

    x = A_x
    x = x + _A_ref(_layernorm(x, axis=-1), A_wqkv, A_w_phi, A_wo)
    x = x + _B_ref(_layernorm(x, axis=-1), B_w_gate, B_w_up, B_w_down)
    x = x + _A_ref(_layernorm(x, axis=-1), A_wqkv, A_w_phi, A_wo)
    x = x + _B_ref(_layernorm(x, axis=-1), B_w_gate, B_w_up, B_w_down)
    return x
```

```asm
; @launch grid=(256,1,1) block=(256,1,1) lds=163840
.amdgcn_target "amdgcn-amd-amdhsa--gfx950"
.text
.globl interleave_layers__linear_kernel_hedgehog__geglu_ffn__prompt_kernel
.p2align 8
.type interleave_layers__linear_kernel_hedgehog__geglu_ffn__prompt_kernel,@function
interleave_layers__linear_kernel_hedgehog__geglu_ffn__prompt_kernel:
    s_cmp_ge_u32 s2, 256
    s_cbranch_scc1 interleave_layers__linear_kernel_hedgehog__geglu_ffn__prompt_kernel_end
    s_load_dwordx16 s[36:51], s[0:1], 0
    s_load_dwordx2 s[96:97], s[0:1], 80
    s_load_dwordx2 s[98:99], s[0:1], 64
    v_lshrrev_b32 v44, 6, v0
    s_and_b32 s17, s2, 7
    v_readfirstlane_b32 s16, v44
    s_waitcnt lgkmcnt(0)
    s_mov_b32 s4, s96
    s_mov_b32 s5, s97
    s_mov_b32 s6, 0x4000000
    s_mov_b32 s7, 0x20000
    v_and_b32 v1, 63, v0
    v_lshlrev_b32 v2, 4, v1
    v_mov_b32 v4, 0x40000000
    v_mov_b32 v5, 0
    s_mov_b32 s3, 22832128
    buffer_load_dword v5, v5, s[4:7], s3 offen sc1
    v_mov_b32 v3, 0x3f80
    s_mul_i32 s33, s16, 10240
    v_bfe_u32 v6, v1, 2, 2
    v_and_b32 v7, 3, v1
    s_cmp_ge_u32 s2, 64
    s_cbranch_scc1 interleave_layers__linear_kernel_hedgehog__geglu_ffn__prompt_kernel_notq
    s_mov_b32 s8, s38
    s_mov_b32 s9, s39
    s_mov_b32 s10, 0x258000
    s_mov_b32 s11, 0x20000
    s_mov_b32 s12, s40
    s_mov_b32 s13, s41
    s_mov_b32 s14, 0x6400
    s_mov_b32 s15, 0x20000
    s_lshr_b32 s18, s2, 3
    s_mul_i32 s33, s16, 10400
    v_mul_u32_u24 v8, 205, v1
    v_lshrrev_b32 v8, 11, v8
    v_mul_u32_u24 v9, 10, v8
    v_sub_u32 v9, v1, v9
    v_lshlrev_b32 v9, 4, v9
    v_mul_u32_u24 v8, 1280, v8
    v_add_u32 v8, v8, v9
    v_cmp_gt_u32 vcc, 60, v1
    s_nop 1
    v_cndmask_b32 v8, v4, v8, vcc
    s_mul_i32 s19, s17, 307200
    s_mul_i32 s20, s18, 160
    s_add_u32 s19, s19, s20
    s_mul_i32 s20, s16, 76800
    s_add_u32 s19, s19, s20
    v_lshlrev_b32 v9, 4, v0
    v_cmp_gt_u32 vcc, 200, v0
    s_nop 1
    v_cndmask_b32 v9, v4, v9, vcc
    s_lshl_b32 s20, s16, 10
    s_add_u32 m0, s20, 41600
    s_mul_i32 s21, s18, 3200
    buffer_load_dwordx4 v9, s[12:15], s21 offen lds
    s_add_u32 m0, s33, 0
    s_nop 0
    buffer_load_dwordx4 v8, s[8:11], s19 offen lds
    s_add_u32 s19, s19, 7680
    s_add_u32 m0, s33, 1040
    s_nop 0
    buffer_load_dwordx4 v8, s[8:11], s19 offen lds
    s_add_u32 s19, s19, 7680
    s_add_u32 m0, s33, 2080
    s_nop 0
    buffer_load_dwordx4 v8, s[8:11], s19 offen lds
    s_add_u32 s19, s19, 7680
    s_add_u32 m0, s33, 3120
    s_nop 0
    buffer_load_dwordx4 v8, s[8:11], s19 offen lds
    s_add_u32 s19, s19, 7680
    s_add_u32 m0, s33, 4160
    s_nop 0
    buffer_load_dwordx4 v8, s[8:11], s19 offen lds
    s_add_u32 s19, s19, 7680
    s_add_u32 m0, s33, 5200
    s_nop 0
    buffer_load_dwordx4 v8, s[8:11], s19 offen lds
    s_add_u32 s19, s19, 7680
    s_add_u32 m0, s33, 6240
    s_nop 0
    buffer_load_dwordx4 v8, s[8:11], s19 offen lds
    s_add_u32 s19, s19, 7680
    s_add_u32 m0, s33, 7280
    s_nop 0
    buffer_load_dwordx4 v8, s[8:11], s19 offen lds
    s_add_u32 s19, s19, 7680
    s_add_u32 m0, s33, 8320
    s_nop 0
    buffer_load_dwordx4 v8, s[8:11], s19 offen lds
    s_add_u32 s19, s19, 7680
    s_add_u32 m0, s33, 9360
    s_nop 0
    buffer_load_dwordx4 v8, s[8:11], s19 offen lds
    s_mov_b32 s58, 0
    s_mov_b32 s59, 0
    s_mov_b32 s68, 0
    s_mov_b32 s69, 0
    s_getpc_b64 s[64:65]
pc_1:
    s_sub_u32 s64, s64, pc_1-interleave_layers__linear_kernel_hedgehog__geglu_ffn__prompt_kernel
    s_subb_u32 s65, s65, 0
    s_mov_b32 s66, interleave_layers__linear_kernel_hedgehog__geglu_ffn__prompt_kernel_end-interleave_layers__linear_kernel_hedgehog__geglu_ffn__prompt_kernel
    s_mov_b32 s67, 0x20000
    s_lshr_b32 s3, s2, 3
    s_lshl_b32 s3, s3, 2
    s_add_u32 s3, s3, s16
    s_lshl_b32 s3, s3, 10
    buffer_load_dwordx4 v[244:247], v2, s[64:67], s3 offen
    v_and_b32 v8, 31, v1
    v_bfe_u32 v9, v8, 2, 1
    v_bfe_u32 v10, v8, 3, 1
    v_and_b32 v11, 3, v8
    v_lshl_add_u32 v12, v10, 2, v11
    v_mad_u32_u24 v12, v9, 20, v12
    v_mad_u32_u24 v13, v10, 20, v11
    v_mad_u32_u24 v13, v9, 40, v13
    v_add_u32 v13, 16, v13
    v_lshrrev_b32 v14, 4, v8
    v_mad_u32_u24 v12, v14, 40, v12
    v_lshrrev_b32 v15, 5, v1
    s_cmp_lt_u32 s16, 2
    s_cselect_b32 s20, 160, 0
    v_add_u32 v16, 0, v12
    v_lshrrev_b32 v17, 1, v16
    v_and_b32 v16, 1, v16
    v_mul_u32_u24 v16, 480, v16
    v_mul_u32_u24 v17, 1040, v17
    v_add_u32 v16, v16, v17
    v_lshl_add_u32 v16, v15, 4, v16
    v_add_u32 v24, s20, v16
    v_add_u32 v16, 8, v12
    v_lshrrev_b32 v17, 1, v16
    v_and_b32 v16, 1, v16
    v_mul_u32_u24 v16, 480, v16
    v_mul_u32_u24 v17, 1040, v17
    v_add_u32 v16, v16, v17
    v_lshl_add_u32 v16, v15, 4, v16
    v_add_u32 v25, s20, v16
    v_add_u32 v16, 0, v13
    v_lshrrev_b32 v17, 1, v16
    v_and_b32 v16, 1, v16
    v_mul_u32_u24 v16, 480, v16
    v_mul_u32_u24 v17, 1040, v17
    v_add_u32 v16, v16, v17
    v_lshl_add_u32 v16, v15, 4, v16
    v_add_u32 v26, s20, v16
    v_lshrrev_b32 v16, 3, v8
    v_lshl_add_u32 v16, v16, 2, v11
    s_lshl_b32 s21, s16, 4
    v_add_u32 v16, s21, v16
    v_subrev_u32 v16, 20, v16
    v_cmp_gt_u32 s[28:29], 20, v16
    v_bfe_u32 v16, v1, 4, 1
    v_lshl_add_u32 v16, v16, 2, v7
    v_and_b32 v17, 1, v16
    v_lshrrev_b32 v16, 1, v16
    v_lshl_add_u32 v16, v16, 2, s21
    v_subrev_u32 v16, 20, v16
    v_cmp_gt_u32 vcc, 20, v16
    s_nop 1
    v_cndmask_b32 v16, 0, v16, vcc
    v_lshlrev_b32 v16, 1, v16
    v_mad_u32_u24 v16, v17, 40, v16
    v_and_b32 v17, 1, v6
    v_mul_u32_u24 v17, 480, v17
    v_add_u32 v16, v16, v17
    v_lshrrev_b32 v17, 1, v6
    v_mul_u32_u24 v17, 1040, v17
    v_add_u32 v16, v16, v17
    v_mul_u32_u24 v17, 10400, v15
    v_add_u32 v16, 320, v16
    v_add_u32 v27, v16, v17
    v_add_u32 v28, v27, v17
    v_bfe_u32 v16, v1, 4, 1
    v_lshl_add_u32 v16, v16, 2, v7
    v_and_b32 v17, 1, v16
    v_lshrrev_b32 v16, 1, v16
    s_cmp_lt_u32 s16, 2
    s_cselect_b32 s22, 0, 40
    s_sub_u32 s21, s21, s22
    v_lshl_add_u32 v16, v16, 2, s21
    v_cmp_gt_u32 s[30:31], 20, v16
    v_lshlrev_b32 v16, 1, v16
    v_mad_u32_u24 v16, v6, 40, v16
    v_mul_u32_u24 v18, 320, v15
    v_add_u32 v16, v16, v18
    v_add_u32 v16, 41600, v16
    v_lshlrev_b32 v18, 3, v15
    v_mul_u32_u24 v17, 20, v17
    v_sub_u32 v17, v18, v17
    v_mov_b32 v19, 44800
    v_add_u32 v18, 0, v17
    v_cmp_gt_u32 vcc, 20, v18
    s_nop 0
    s_and_b64 vcc, vcc, s[30:31]
    v_add_u32 v18, 0, v16
    v_cndmask_b32 v68, v19, v18, vcc
    v_add_u32 v18, 1600, v16
    v_cndmask_b32 v74, v19, v18, vcc
    v_add_u32 v18, 4, v17
    v_cmp_gt_u32 vcc, 20, v18
    s_nop 0
    s_and_b64 vcc, vcc, s[30:31]
    v_add_u32 v18, 160, v16
    v_cndmask_b32 v69, v19, v18, vcc
    v_add_u32 v18, 1760, v16
    v_cndmask_b32 v75, v19, v18, vcc
    v_add_u32 v18, 16, v17
    v_cmp_gt_u32 vcc, 20, v18
    s_nop 0
    s_and_b64 vcc, vcc, s[30:31]
    v_add_u32 v18, 640, v16
    v_cndmask_b32 v70, v19, v18, vcc
    v_add_u32 v18, 2240, v16
    v_cndmask_b32 v76, v19, v18, vcc
    v_add_u32 v18, 20, v17
    v_cmp_gt_u32 vcc, 20, v18
    s_nop 0
    s_and_b64 vcc, vcc, s[30:31]
    v_add_u32 v18, 800, v16
    v_cndmask_b32 v71, v19, v18, vcc
    v_add_u32 v18, 2400, v16
    v_cndmask_b32 v77, v19, v18, vcc
    v_add_u32 v18, 32, v17
    v_cmp_gt_u32 vcc, 20, v18
    s_nop 0
    s_and_b64 vcc, vcc, s[30:31]
    v_add_u32 v18, 1280, v16
    v_cndmask_b32 v72, v19, v18, vcc
    v_add_u32 v18, 2880, v16
    v_cndmask_b32 v78, v19, v18, vcc
    v_add_u32 v18, 36, v17
    v_cmp_gt_u32 vcc, 20, v18
    s_nop 0
    s_and_b64 vcc, vcc, s[30:31]
    v_add_u32 v18, 1440, v16
    v_cndmask_b32 v73, v19, v18, vcc
    v_add_u32 v18, 3040, v16
    v_cndmask_b32 v79, v19, v18, vcc
    v_mov_b32 v20, 0x3f803f80
    v_mov_b32 v21, 0x3f803f80
    v_mov_b32 v22, 0x3f803f80
    v_mov_b32 v23, 0x3f803f80
    s_cmp_lt_u32 s16, 2
    s_cselect_b32 s24, 2, 1
    s_cselect_b32 s25, 1, 40
    s_mul_i32 s25, s25, s16
    s_mul_i32 s26, s17, 5
    s_mul_i32 s26, s26, s24
    s_add_u32 s25, s25, s26
    s_mul_i32 s26, s18, 320
    s_add_u32 s25, s25, s26
    s_lshl_b32 s25, s25, 10
    s_add_u32 s25, s25, 0x0
    s_lshl_b32 s24, s24, 10
    s_lshl_b32 s26, s18, 3
    s_add_u32 s26, s26, s16
    s_lshl_b32 s26, s26, 8
    s_add_u32 s26, s26, s17
    s_lshl_b32 s26, s26, 2
    s_add_u32 s26, s26, 0x564000
    v_lshlrev_b32 v30, 5, v8
    s_cmp_eq_u32 s16, 3
    s_cselect_b32 s22, 24, 32
    v_cmp_gt_u32 vcc, s22, v8
    s_nop 1
    v_cndmask_b32 v31, v4, v2, vcc
    s_lshl_b32 s57, s18, 3
    s_add_u32 s57, s57, s17
    s_lshl_b32 s57, s57, 7
    s_add_u32 s57, s57, 22814720
    s_waitcnt vmcnt(1)
    s_barrier
    ds_read_b64_tr_b16 v[44:45], v68
    ds_read_b64_tr_b16 v[46:47], v69
    ds_read_b64_tr_b16 v[48:49], v70
    ds_read_b64_tr_b16 v[50:51], v71
    ds_read_b64_tr_b16 v[52:53], v72
    ds_read_b64_tr_b16 v[54:55], v73
    ds_read_b64_tr_b16 v[56:57], v74
    ds_read_b64_tr_b16 v[58:59], v75
    ds_read_b64_tr_b16 v[60:61], v76
    ds_read_b64_tr_b16 v[62:63], v77
    ds_read_b64_tr_b16 v[64:65], v78
    ds_read_b64_tr_b16 v[66:67], v79
    ds_read_b128 v[80:83], v24 offset:0
    ds_read_b128 v[84:87], v24 offset:32
    ds_read_b128 v[88:91], v24 offset:64
    ds_read_b128 v[92:95], v25 offset:0
    ds_read_b128 v[96:99], v25 offset:32
    ds_read_b128 v[100:103], v25 offset:64
    ds_read_b64_tr_b16 v[224:225], v27 offset:0
    ds_read_b64_tr_b16 v[226:227], v27 offset:2080
    ds_read_b64_tr_b16 v[228:229], v27 offset:20800
    ds_read_b64_tr_b16 v[230:231], v27 offset:22880
    ds_read_b128 v[104:107], v26 offset:0
    ds_read_b128 v[108:111], v26 offset:32
    ds_read_b128 v[112:115], v26 offset:64
    ds_read_b64_tr_b16 v[232:233], v27 offset:4160
    ds_read_b64_tr_b16 v[234:235], v27 offset:6240
    ds_read_b64_tr_b16 v[236:237], v27 offset:24960
    ds_read_b64_tr_b16 v[238:239], v27 offset:27040
    s_waitcnt lgkmcnt(15)
    v_mfma_f32_32x32x16_bf16 v[152:167], v[80:83], v[44:47], 0
    v_mfma_f32_32x32x16_bf16 v[152:167], v[84:87], v[48:51], v[152:167]
    s_waitcnt lgkmcnt(14)
    v_mfma_f32_32x32x16_bf16 v[152:167], v[88:91], v[52:55], v[152:167]
    ds_read_b128 v[116:119], v24 offset:80
    ds_read_b128 v[120:123], v24 offset:112
    ds_read_b128 v[124:127], v24 offset:144
    ds_read_b64_tr_b16 v[240:241], v28 offset:8320
    ds_read_b64_tr_b16 v[242:243], v28 offset:18720
    s_waitcnt vmcnt(0)
    ds_read_b64_tr_b16 v[244:245], v27 offset:80
    ds_read_b64_tr_b16 v[246:247], v27 offset:2160
    s_waitcnt lgkmcnt(15)
    v_mfma_f32_32x32x16_bf16 v[168:183], v[92:95], v[44:47], 0
    v_mfma_f32_32x32x16_bf16 v[168:183], v[96:99], v[48:51], v[168:183]
    v_mfma_f32_32x32x16_bf16 v[168:183], v[100:103], v[52:55], v[168:183]
    s_add_u32 s27, s25, 0
    v_cvt_pk_bf16_f32 v184, v152, v153
    v_cvt_pk_bf16_f32 v185, v154, v155
    v_cvt_pk_bf16_f32 v186, v156, v157
    v_cvt_pk_bf16_f32 v187, v158, v159
    v_cndmask_b32 v184, v184, v224, s[28:29]
    v_cndmask_b32 v185, v185, v225, s[28:29]
    v_cndmask_b32 v186, v186, v226, s[28:29]
    v_cndmask_b32 v187, v187, v227, s[28:29]
    buffer_store_dwordx4 v[184:187], v31, s[4:7], s27 offen sc1
    s_add_u32 s27, s27, s24
    v_cvt_pk_bf16_f32 v188, v160, v161
    v_cvt_pk_bf16_f32 v189, v162, v163
    v_cvt_pk_bf16_f32 v190, v164, v165
    v_cvt_pk_bf16_f32 v191, v166, v167
    v_cndmask_b32 v188, v188, v228, s[28:29]
    v_cndmask_b32 v189, v189, v229, s[28:29]
    s_waitcnt lgkmcnt(14)
    v_cndmask_b32 v190, v190, v230, s[28:29]
    v_cndmask_b32 v191, v191, v231, s[28:29]
    buffer_store_dwordx4 v[188:191], v31, s[4:7], s27 offen sc1
    s_add_u32 s27, s27, s24
    ds_read_b128 v[128:131], v25 offset:80
    ds_read_b128 v[132:135], v25 offset:112
    ds_read_b128 v[136:139], v25 offset:144
    ds_read_b64_tr_b16 v[248:249], v27 offset:20880
    ds_read_b64_tr_b16 v[250:251], v27 offset:22960
    ds_read_b64_tr_b16 v[252:253], v27 offset:4240
    ds_read_b64_tr_b16 v[254:255], v27 offset:6320
    s_waitcnt lgkmcnt(15)
    v_mfma_f32_32x32x16_bf16 v[152:167], v[104:107], v[44:47], 0
    v_mfma_f32_32x32x16_bf16 v[152:167], v[108:111], v[48:51], v[152:167]
    v_mfma_f32_32x32x16_bf16 v[152:167], v[112:115], v[52:55], v[152:167]
    v_cvt_pk_bf16_f32 v192, v168, v169
    v_cvt_pk_bf16_f32 v193, v170, v171
    v_cvt_pk_bf16_f32 v194, v172, v173
    v_cvt_pk_bf16_f32 v195, v174, v175
    v_cndmask_b32 v192, v192, v232, s[28:29]
    v_cndmask_b32 v193, v193, v233, s[28:29]
    v_cndmask_b32 v194, v194, v234, s[28:29]
    v_cndmask_b32 v195, v195, v235, s[28:29]
    buffer_store_dwordx4 v[192:195], v31, s[4:7], s27 offen sc1
    s_add_u32 s27, s27, s24
    v_cvt_pk_bf16_f32 v196, v176, v177
    v_cvt_pk_bf16_f32 v197, v178, v179
    v_cvt_pk_bf16_f32 v198, v180, v181
    v_cvt_pk_bf16_f32 v199, v182, v183
    v_cndmask_b32 v196, v196, v236, s[28:29]
    v_cndmask_b32 v197, v197, v237, s[28:29]
    s_waitcnt lgkmcnt(14)
    v_cndmask_b32 v198, v198, v238, s[28:29]
    v_cndmask_b32 v199, v199, v239, s[28:29]
    buffer_store_dwordx4 v[196:199], v31, s[4:7], s27 offen sc1
    s_add_u32 s27, s27, s24
    ds_read_b128 v[140:143], v26 offset:80
    ds_read_b128 v[144:147], v26 offset:112
    ds_read_b128 v[148:151], v26 offset:144
    ds_read_b64_tr_b16 v[32:33], v27 offset:25040
    ds_read_b64_tr_b16 v[34:35], v27 offset:27120
    ds_read_b64_tr_b16 v[36:37], v28 offset:8400
    ds_read_b64_tr_b16 v[38:39], v28 offset:18800
    s_waitcnt lgkmcnt(15)
    v_mfma_f32_32x32x16_bf16 v[168:183], v[116:119], v[56:59], 0
    v_mfma_f32_32x32x16_bf16 v[168:183], v[120:123], v[60:63], v[168:183]
    v_mfma_f32_32x32x16_bf16 v[168:183], v[124:127], v[64:67], v[168:183]
    v_cvt_pk_bf16_f32 v200, v152, v153
    v_cvt_pk_bf16_f32 v201, v154, v155
    v_cvt_pk_bf16_f32 v202, v156, v157
    v_cvt_pk_bf16_f32 v203, v158, v159
    v_cndmask_b32 v200, v200, v240, s[28:29]
    v_cndmask_b32 v201, v201, v241, s[28:29]
    v_cndmask_b32 v202, v202, v242, s[28:29]
    v_cndmask_b32 v203, v203, v243, s[28:29]
    buffer_store_dwordx4 v[200:203], v31, s[4:7], s27 offen sc1
    s_add_u32 s27, s27, s24
    v_mfma_f32_32x32x16_bf16 v[208:223], v[20:23], v[184:187], 0
    v_mfma_f32_32x32x16_bf16 v[208:223], v[20:23], v[188:191], v[208:223]
    v_mfma_f32_32x32x16_bf16 v[208:223], v[20:23], v[192:195], v[208:223]
    v_mfma_f32_32x32x16_bf16 v[208:223], v[20:23], v[196:199], v[208:223]
    v_mfma_f32_32x32x16_bf16 v[208:223], v[20:23], v[200:203], v[208:223]
    s_waitcnt lgkmcnt(13)
    v_mfma_f32_32x32x16_bf16 v[152:167], v[128:131], v[56:59], 0
    s_waitcnt lgkmcnt(12)
    v_mfma_f32_32x32x16_bf16 v[152:167], v[132:135], v[60:63], v[152:167]
    s_waitcnt lgkmcnt(11)
    v_mfma_f32_32x32x16_bf16 v[152:167], v[136:139], v[64:67], v[152:167]
    s_add_u32 s27, s25, 163840
    v_cvt_pk_bf16_f32 v184, v168, v169
    v_cvt_pk_bf16_f32 v185, v170, v171
    v_cvt_pk_bf16_f32 v186, v172, v173
    v_cvt_pk_bf16_f32 v187, v174, v175
    v_cndmask_b32 v184, v184, v244, s[28:29]
    v_cndmask_b32 v185, v185, v245, s[28:29]
    v_cndmask_b32 v186, v186, v246, s[28:29]
    v_cndmask_b32 v187, v187, v247, s[28:29]
    buffer_store_dwordx4 v[184:187], v31, s[4:7], s27 offen sc1
    s_add_u32 s27, s27, s24
    v_cvt_pk_bf16_f32 v188, v176, v177
    v_cvt_pk_bf16_f32 v189, v178, v179
    v_cvt_pk_bf16_f32 v190, v180, v181
    v_cvt_pk_bf16_f32 v191, v182, v183
    s_waitcnt lgkmcnt(10)
    v_cndmask_b32 v188, v188, v248, s[28:29]
    v_cndmask_b32 v189, v189, v249, s[28:29]
    s_waitcnt lgkmcnt(9)
    v_cndmask_b32 v190, v190, v250, s[28:29]
    v_cndmask_b32 v191, v191, v251, s[28:29]
    buffer_store_dwordx4 v[188:191], v31, s[4:7], s27 offen sc1
    s_add_u32 s27, s27, s24
    s_waitcnt lgkmcnt(6)
    v_mfma_f32_32x32x16_bf16 v[168:183], v[140:143], v[56:59], 0
    s_waitcnt lgkmcnt(5)
    v_mfma_f32_32x32x16_bf16 v[168:183], v[144:147], v[60:63], v[168:183]
    s_waitcnt lgkmcnt(4)
    v_mfma_f32_32x32x16_bf16 v[168:183], v[148:151], v[64:67], v[168:183]
    v_cvt_pk_bf16_f32 v192, v152, v153
    v_cvt_pk_bf16_f32 v193, v154, v155
    v_cvt_pk_bf16_f32 v194, v156, v157
    v_cvt_pk_bf16_f32 v195, v158, v159
    v_cndmask_b32 v192, v192, v252, s[28:29]
    v_cndmask_b32 v193, v193, v253, s[28:29]
    v_cndmask_b32 v194, v194, v254, s[28:29]
    v_cndmask_b32 v195, v195, v255, s[28:29]
    buffer_store_dwordx4 v[192:195], v31, s[4:7], s27 offen sc1
    s_add_u32 s27, s27, s24
    v_cvt_pk_bf16_f32 v196, v160, v161
    v_cvt_pk_bf16_f32 v197, v162, v163
    v_cvt_pk_bf16_f32 v198, v164, v165
    v_cvt_pk_bf16_f32 v199, v166, v167
    s_waitcnt lgkmcnt(3)
    v_cndmask_b32 v196, v196, v32, s[28:29]
    v_cndmask_b32 v197, v197, v33, s[28:29]
    s_waitcnt lgkmcnt(2)
    v_cndmask_b32 v198, v198, v34, s[28:29]
    v_cndmask_b32 v199, v199, v35, s[28:29]
    buffer_store_dwordx4 v[196:199], v31, s[4:7], s27 offen sc1
    s_add_u32 s27, s27, s24
    v_cvt_pk_bf16_f32 v200, v168, v169
    v_cvt_pk_bf16_f32 v201, v170, v171
    v_cvt_pk_bf16_f32 v202, v172, v173
    v_cvt_pk_bf16_f32 v203, v174, v175
    s_waitcnt lgkmcnt(1)
    v_cndmask_b32 v200, v200, v36, s[28:29]
    v_cndmask_b32 v201, v201, v37, s[28:29]
    s_waitcnt lgkmcnt(0)
    v_cndmask_b32 v202, v202, v38, s[28:29]
    v_cndmask_b32 v203, v203, v39, s[28:29]
    buffer_store_dwordx4 v[200:203], v31, s[4:7], s27 offen sc1
    s_add_u32 s27, s27, s24
    v_mfma_f32_32x32x16_bf16 v[152:167], v[20:23], v[184:187], 0
    v_mfma_f32_32x32x16_bf16 v[152:167], v[20:23], v[188:191], v[152:167]
    v_mfma_f32_32x32x16_bf16 v[152:167], v[20:23], v[192:195], v[152:167]
    v_mfma_f32_32x32x16_bf16 v[152:167], v[20:23], v[196:199], v[152:167]
    v_mfma_f32_32x32x16_bf16 v[152:167], v[20:23], v[200:203], v[152:167]
    buffer_store_dword v208, v30, s[4:7], s26 offen sc1
    s_add_u32 s26, s26, 4096
    s_nop 9
    buffer_store_dword v152, v30, s[4:7], s26 offen sc1
    s_mov_b32 s0, 0x40000000
    s_mov_b32 s1, 0
    s_mov_b32 s3, 0
    s_nop 1
    s_branch interleave_layers__linear_kernel_hedgehog__geglu_ffn__prompt_kernel_ptail
interleave_layers__linear_kernel_hedgehog__geglu_ffn__prompt_kernel_notq:
    s_nop 1
    s_sub_u32 s3, s2, 128
    s_cmp_ge_u32 s3, 108
    s_cbranch_scc1 interleave_layers__linear_kernel_hedgehog__geglu_ffn__prompt_kernel_notg
    s_and_b32 s18, s3, 3
    s_lshr_b32 s19, s3, 2
    s_lshr_b32 s20, s16, 1
    v_lshrrev_b32 v8, 3, v1
    v_bfe_u32 v9, v1, 4, 1
    s_lshl_b32 s21, s20, 1
    v_add_u32 v9, s21, v9
    v_lshlrev_b32 v9, 1, v9
    v_and_b32 v10, 7, v1
    v_xor_b32 v9, v9, v10
    v_lshlrev_b32 v9, 4, v9
    v_mul_u32_u24 v8, 3456, v8
    v_add_u32 v8, v8, v9
    s_and_b32 s21, s16, 1
    s_mul_i32 s21, s21, 80
    s_mul_i32 s22, s18, 160
    s_add_u32 s21, s21, s22
    s_mul_i32 s21, s21, 3456
    s_lshl_b32 s22, s19, 7
    s_add_u32 s21, s21, s22
    s_waitcnt vmcnt(0)
    s_mov_b32 s8, s50
    s_mov_b32 s9, s51
    s_mov_b32 s10, 0x21c000
    s_mov_b32 s11, 0x20000
    s_sub_u32 s58, s2, 64
    s_lshr_b32 s59, s58, 5
    s_lshl_b32 s59, s59, 3
    s_add_u32 s59, s59, s17
    s_bfe_u32 s58, s58, 0x20003
    s_sub_u32 s68, s2, 232
    s_lshr_b32 s69, s68, 2
    s_add_u32 s69, s69, 48
    s_and_b32 s68, s68, 3
    v_mul_u32_u24 v240, 13, v1
    v_lshrrev_b32 v240, 8, v240
    v_mul_u32_u24 v241, 20, v240
    v_sub_u32 v241, v1, v241
    v_lshlrev_b32 v241, 4, v241
    v_cmp_gt_u32 vcc, 60, v1
    s_nop 1
    v_cndmask_b32 v241, v4, v241, vcc
    s_mul_i32 s62, s16, 9
    v_add_u32 v240, s62, v240
    s_lshl_b32 s70, s59, 1
    s_add_u32 s70, s70, 0
    s_cmp_ge_u32 s70, 28
    s_cselect_b32 s71, 1, 0
    s_cmp_ge_u32 s70, 56
    s_addc_u32 s71, s71, 0
    s_cmp_ge_u32 s70, 82
    s_addc_u32 s71, s71, 0
    s_mul_i32 s72, s71, 28
    s_cmp_eq_u32 s71, 3
    s_cselect_b32 s73, 2, 0
    s_sub_u32 s72, s72, s73
    s_sub_u32 s72, s70, s72
    s_mul_i32 s73, s72, 205
    s_lshr_b32 s73, s73, 10
    s_lshl_b32 s73, s73, 1
    s_add_u32 s73, s73, s72
    s_cmp_lt_u32 s71, 2
    s_cselect_b32 s74, 20, 18
    s_sub_u32 s75, s72, s74
    s_lshr_b32 s76, s75, 1
    s_mul_i32 s76, s76, 5
    s_add_u32 s76, s76, s75
    s_add_u32 s76, s76, 5
    s_cmp_eq_u32 s71, 3
    s_cselect_b32 s77, 7, 0
    s_sub_u32 s76, s76, s77
    s_cmp_lt_u32 s72, s74
    s_cselect_b32 s73, s73, s76
    s_mul_i32 s71, s71, 28
    s_add_u32 s73, s73, s71
    s_and_b32 s70, s70, -2
    s_cmp_eq_u32 s70, 80
    s_cselect_b32 s73, 80, s73
    s_lshl_b32 s78, s73, 4
    s_lshl_b32 s70, s59, 1
    s_add_u32 s70, s70, 1
    s_cmp_ge_u32 s70, 28
    s_cselect_b32 s71, 1, 0
    s_cmp_ge_u32 s70, 56
    s_addc_u32 s71, s71, 0
    s_cmp_ge_u32 s70, 82
    s_addc_u32 s71, s71, 0
    s_mul_i32 s72, s71, 28
    s_cmp_eq_u32 s71, 3
    s_cselect_b32 s73, 2, 0
    s_sub_u32 s72, s72, s73
    s_sub_u32 s72, s70, s72
    s_mul_i32 s73, s72, 205
    s_lshr_b32 s73, s73, 10
    s_lshl_b32 s73, s73, 1
    s_add_u32 s73, s73, s72
    s_cmp_lt_u32 s71, 2
    s_cselect_b32 s74, 20, 18
    s_sub_u32 s75, s72, s74
    s_lshr_b32 s76, s75, 1
    s_mul_i32 s76, s76, 5
    s_add_u32 s76, s76, s75
    s_add_u32 s76, s76, 5
    s_cmp_eq_u32 s71, 3
    s_cselect_b32 s77, 7, 0
    s_sub_u32 s76, s76, s77
    s_cmp_lt_u32 s72, s74
    s_cselect_b32 s73, s73, s76
    s_mul_i32 s71, s71, 28
    s_add_u32 s73, s73, s71
    s_and_b32 s70, s70, -2
    s_cmp_eq_u32 s70, 80
    s_cselect_b32 s73, 81, s73
    s_lshl_b32 s79, s73, 4
    s_sub_u32 s79, s79, 16
    s_mul_i32 s60, s58, 320
    s_mul_i32 s61, s16, 3120
    s_add_u32 s61, s61, 45696
    v_add_u32 v242, 0, v240
    v_mov_b32 v243, s78
    v_mov_b32 v248, s79
    v_cmp_gt_u32 vcc, 16, v242
    s_nop 1
    v_cndmask_b32 v243, v248, v243, vcc
    v_add_u32 v243, v243, v242
    v_mul_u32_u24 v243, 1280, v243
    v_add_u32 v243, v243, v241
    v_cmp_gt_u32 vcc, 32, v242
    s_nop 1
    v_cndmask_b32 v243, v4, v243, vcc
    s_add_u32 m0, s61, 0
    s_nop 0
    buffer_load_dwordx4 v243, s[8:11], s60 offen lds
    v_add_u32 v242, 3, v240
    v_mov_b32 v243, s78
    v_mov_b32 v248, s79
    v_cmp_gt_u32 vcc, 16, v242
    s_nop 1
    v_cndmask_b32 v243, v248, v243, vcc
    v_add_u32 v243, v243, v242
    v_mul_u32_u24 v243, 1280, v243
    v_add_u32 v243, v243, v241
    v_cmp_gt_u32 vcc, 32, v242
    s_nop 1
    v_cndmask_b32 v243, v4, v243, vcc
    s_add_u32 m0, s61, 1040
    s_nop 0
    buffer_load_dwordx4 v243, s[8:11], s60 offen lds
    v_add_u32 v242, 6, v240
    v_mov_b32 v243, s78
    v_mov_b32 v248, s79
    v_cmp_gt_u32 vcc, 16, v242
    s_nop 1
    v_cndmask_b32 v243, v248, v243, vcc
    v_add_u32 v243, v243, v242
    v_mul_u32_u24 v243, 1280, v243
    v_add_u32 v243, v243, v241
    v_cmp_gt_u32 vcc, 32, v242
    s_nop 1
    v_cndmask_b32 v243, v4, v243, vcc
    s_add_u32 m0, s61, 2080
    s_nop 0
    buffer_load_dwordx4 v243, s[8:11], s60 offen lds
    s_lshl_b32 s70, s69, 1
    s_add_u32 s70, s70, 0
    s_cmp_ge_u32 s70, 28
    s_cselect_b32 s71, 1, 0
    s_cmp_ge_u32 s70, 56
    s_addc_u32 s71, s71, 0
    s_cmp_ge_u32 s70, 82
    s_addc_u32 s71, s71, 0
    s_mul_i32 s72, s71, 28
    s_cmp_eq_u32 s71, 3
    s_cselect_b32 s73, 2, 0
    s_sub_u32 s72, s72, s73
    s_sub_u32 s72, s70, s72
    s_mul_i32 s73, s72, 205
    s_lshr_b32 s73, s73, 10
    s_lshl_b32 s73, s73, 1
    s_add_u32 s73, s73, s72
    s_cmp_lt_u32 s71, 2
    s_cselect_b32 s74, 20, 18
    s_sub_u32 s75, s72, s74
    s_lshr_b32 s76, s75, 1
    s_mul_i32 s76, s76, 5
    s_add_u32 s76, s76, s75
    s_add_u32 s76, s76, 5
    s_cmp_eq_u32 s71, 3
    s_cselect_b32 s77, 7, 0
    s_sub_u32 s76, s76, s77
    s_cmp_lt_u32 s72, s74
    s_cselect_b32 s73, s73, s76
    s_mul_i32 s71, s71, 28
    s_add_u32 s73, s73, s71
    s_and_b32 s70, s70, -2
    s_cmp_eq_u32 s70, 80
    s_cselect_b32 s73, 80, s73
    s_lshl_b32 s78, s73, 4
    s_lshl_b32 s70, s69, 1
    s_add_u32 s70, s70, 1
    s_cmp_ge_u32 s70, 28
    s_cselect_b32 s71, 1, 0
    s_cmp_ge_u32 s70, 56
    s_addc_u32 s71, s71, 0
    s_cmp_ge_u32 s70, 82
    s_addc_u32 s71, s71, 0
    s_mul_i32 s72, s71, 28
    s_cmp_eq_u32 s71, 3
    s_cselect_b32 s73, 2, 0
    s_sub_u32 s72, s72, s73
    s_sub_u32 s72, s70, s72
    s_mul_i32 s73, s72, 205
    s_lshr_b32 s73, s73, 10
    s_lshl_b32 s73, s73, 1
    s_add_u32 s73, s73, s72
    s_cmp_lt_u32 s71, 2
    s_cselect_b32 s74, 20, 18
    s_sub_u32 s75, s72, s74
    s_lshr_b32 s76, s75, 1
    s_mul_i32 s76, s76, 5
    s_add_u32 s76, s76, s75
    s_add_u32 s76, s76, 5
    s_cmp_eq_u32 s71, 3
    s_cselect_b32 s77, 7, 0
    s_sub_u32 s76, s76, s77
    s_cmp_lt_u32 s72, s74
    s_cselect_b32 s73, s73, s76
    s_mul_i32 s71, s71, 28
    s_add_u32 s73, s73, s71
    s_and_b32 s70, s70, -2
    s_cmp_eq_u32 s70, 80
    s_cselect_b32 s73, 81, s73
    s_lshl_b32 s79, s73, 4
    s_sub_u32 s79, s79, 16
    s_mul_i32 s60, s68, 320
    s_cmp_ge_u32 s2, 232
    s_cselect_b32 s60, s60, 0x40000000
    s_mul_i32 s61, s16, 3120
    s_add_u32 s61, s61, 58176
    v_add_u32 v242, 0, v240
    v_mov_b32 v243, s78
    v_mov_b32 v248, s79
    v_cmp_gt_u32 vcc, 16, v242
    s_nop 1
    v_cndmask_b32 v243, v248, v243, vcc
    v_add_u32 v243, v243, v242
    v_mul_u32_u24 v243, 1280, v243
    v_add_u32 v243, v243, v241
    v_cmp_gt_u32 vcc, 32, v242
    s_nop 1
    v_cndmask_b32 v243, v4, v243, vcc
    s_add_u32 m0, s61, 0
    s_nop 0
    buffer_load_dwordx4 v243, s[8:11], s60 offen lds
    v_add_u32 v242, 3, v240
    v_mov_b32 v243, s78
    v_mov_b32 v248, s79
    v_cmp_gt_u32 vcc, 16, v242
    s_nop 1
    v_cndmask_b32 v243, v248, v243, vcc
    v_add_u32 v243, v243, v242
    v_mul_u32_u24 v243, 1280, v243
    v_add_u32 v243, v243, v241
    v_cmp_gt_u32 vcc, 32, v242
    s_nop 1
    v_cndmask_b32 v243, v4, v243, vcc
    s_add_u32 m0, s61, 1040
    s_nop 0
    buffer_load_dwordx4 v243, s[8:11], s60 offen lds
    v_add_u32 v242, 6, v240
    v_mov_b32 v243, s78
    v_mov_b32 v248, s79
    v_cmp_gt_u32 vcc, 16, v242
    s_nop 1
    v_cndmask_b32 v243, v248, v243, vcc
    v_add_u32 v243, v243, v242
    v_mul_u32_u24 v243, 1280, v243
    v_add_u32 v243, v243, v241
    v_cmp_gt_u32 vcc, 32, v242
    s_nop 1
    v_cndmask_b32 v243, v4, v243, vcc
    s_add_u32 m0, s61, 2080
    s_nop 0
    buffer_load_dwordx4 v243, s[8:11], s60 offen lds
    s_getpc_b64 s[64:65]
pc_2:
    s_sub_u32 s64, s64, pc_2-interleave_layers__linear_kernel_hedgehog__geglu_ffn__prompt_kernel
    s_subb_u32 s65, s65, 0
    s_mov_b32 s66, interleave_layers__linear_kernel_hedgehog__geglu_ffn__prompt_kernel_end-interleave_layers__linear_kernel_hedgehog__geglu_ffn__prompt_kernel
    s_mov_b32 s67, 0x20000
    s_lshr_b32 s3, s2, 3
    s_lshl_b32 s3, s3, 2
    s_add_u32 s3, s3, s16
    s_lshl_b32 s3, s3, 10
    buffer_load_dwordx4 v[244:247], v2, s[64:67], s3 offen
    s_waitcnt vmcnt(0)
    s_cmp_lt_u32 s16, 2
    s_cselect_b32 s8, s46, s48
    s_cselect_b32 s9, s47, s49
    s_mov_b32 s10, 0x21c000
    s_mov_b32 s11, 0x20000
    s_add_u32 m0, s33, 0
    s_nop 0
    buffer_load_dwordx4 v8, s[8:11], s21 offen lds
    s_add_u32 s21, s21, 27648
    s_add_u32 m0, s33, 1024
    s_nop 0
    buffer_load_dwordx4 v8, s[8:11], s21 offen lds
    s_add_u32 s21, s21, 27648
    s_add_u32 m0, s33, 2048
    s_nop 0
    buffer_load_dwordx4 v8, s[8:11], s21 offen lds
    s_add_u32 s21, s21, 27648
    s_add_u32 m0, s33, 3072
    s_nop 0
    buffer_load_dwordx4 v8, s[8:11], s21 offen lds
    s_add_u32 s21, s21, 27648
    s_add_u32 m0, s33, 4096
    s_nop 0
    buffer_load_dwordx4 v8, s[8:11], s21 offen lds
    s_add_u32 s21, s21, 27648
    s_add_u32 m0, s33, 5120
    s_nop 0
    buffer_load_dwordx4 v8, s[8:11], s21 offen lds
    s_add_u32 s21, s21, 27648
    s_add_u32 m0, s33, 6144
    s_nop 0
    buffer_load_dwordx4 v8, s[8:11], s21 offen lds
    s_add_u32 s21, s21, 27648
    s_add_u32 m0, s33, 7168
    s_nop 0
    buffer_load_dwordx4 v8, s[8:11], s21 offen lds
    s_add_u32 s21, s21, 27648
    s_add_u32 m0, s33, 8192
    s_nop 0
    buffer_load_dwordx4 v8, s[8:11], s21 offen lds
    s_add_u32 s21, s21, 27648
    s_add_u32 m0, s33, 9216
    s_nop 0
    buffer_load_dwordx4 v8, s[8:11], s21 offen lds
    v_bfe_u32 v8, v1, 4, 1
    v_lshrrev_b32 v9, 5, v1
    v_lshrrev_b32 v10, 1, v6
    v_lshl_add_u32 v10, v8, 1, v10
    v_xor_b32 v10, s16, v10
    v_lshlrev_b32 v10, 5, v10
    v_and_b32 v11, 1, v7
    v_lshl_add_u32 v10, v11, 4, v10
    v_lshrrev_b32 v11, 1, v7
    v_lshl_add_u32 v10, v11, 3, v10
    v_mul_u32_u24 v8, 20480, v8
    v_add_u32 v10, v10, v8
    v_lshl_add_u32 v10, v6, 7, v10
    v_mul_u32_u24 v11, 2560, v9
    v_add_u32 v14, v10, v11
    v_add_u32 v15, v14, v11
    s_lshl_b32 s19, s19, 2
    s_add_u32 s19, s19, s16
    s_mul_i32 s20, s19, 9363
    s_lshr_b32 s20, s20, 16
    s_mul_i32 s21, s20, 7
    s_sub_u32 s21, s19, s21
    s_cmp_lt_u32 s21, 2
    s_cselect_b32 s24, 2, 1
    s_cselect_b32 s25, 1, 40
    s_mul_i32 s25, s25, s21
    s_mul_i32 s26, s20, 280
    s_add_u32 s25, s25, s26
    s_mul_i32 s26, s18, 10
    s_mul_i32 s26, s26, s24
    s_add_u32 s25, s25, s26
    s_lshl_b32 s25, s25, 10
    s_add_u32 s25, s25, 0x582000
    s_lshl_b32 s24, s24, 10
    s_lshl_b32 s26, s19, 7
    s_add_u32 s26, s26, s18
    s_lshl_b32 s26, s26, 2
    s_add_u32 s26, s26, 0x574000
    v_and_b32 v30, 31, v1
    v_lshlrev_b32 v30, 4, v30
    s_mov_b32 s57, 0x40000000
    v_mov_b32 v20, 0x3f803f80
    v_mov_b32 v21, 0x3f803f80
    v_mov_b32 v22, 0x3f803f80
    v_mov_b32 v23, 0x3f803f80
    s_waitcnt vmcnt(0)
    s_barrier
    ds_read_b64_tr_b16 a[160:161], v14 offset:0
    ds_read_b64_tr_b16 a[162:163], v14 offset:512
    ds_read_b64_tr_b16 a[164:165], v14 offset:5120
    ds_read_b64_tr_b16 a[166:167], v14 offset:5632
    ds_read_b64_tr_b16 a[168:169], v14 offset:1024
    ds_read_b64_tr_b16 a[170:171], v14 offset:1536
    ds_read_b64_tr_b16 a[172:173], v14 offset:6144
    ds_read_b64_tr_b16 a[174:175], v14 offset:6656
    ds_read_b64_tr_b16 a[176:177], v15 offset:2048
    ds_read_b64_tr_b16 a[178:179], v15 offset:4608
    ds_read_b64_tr_b16 a[180:181], v14 offset:10240
    ds_read_b64_tr_b16 a[182:183], v14 offset:10752
    ds_read_b64_tr_b16 a[184:185], v14 offset:15360
    ds_read_b64_tr_b16 a[186:187], v14 offset:15872
    ds_read_b64_tr_b16 a[188:189], v14 offset:11264
    ds_read_b64_tr_b16 a[190:191], v14 offset:11776
    ds_read_b64_tr_b16 a[192:193], v14 offset:16384
    ds_read_b64_tr_b16 a[194:195], v14 offset:16896
    ds_read_b64_tr_b16 a[196:197], v15 offset:12288
    ds_read_b64_tr_b16 a[198:199], v15 offset:14848
    s_waitcnt lgkmcnt(15)
    v_mfma_f32_32x32x16_bf16 v[80:95], v[20:23], a[160:163], 0
    v_mfma_f32_32x32x16_bf16 v[80:95], v[20:23], a[164:167], v[80:95]
    s_waitcnt lgkmcnt(14)
    v_mfma_f32_32x32x16_bf16 v[80:95], v[20:23], a[168:171], v[80:95]
    s_waitcnt lgkmcnt(12)
    v_mfma_f32_32x32x16_bf16 v[80:95], v[20:23], a[172:175], v[80:95]
    s_waitcnt lgkmcnt(10)
    v_mfma_f32_32x32x16_bf16 v[80:95], v[20:23], a[176:179], v[80:95]
    s_waitcnt lgkmcnt(8)
    v_mfma_f32_32x32x16_bf16 v[80:95], v[20:23], a[180:183], v[80:95]
    s_waitcnt lgkmcnt(6)
    v_mfma_f32_32x32x16_bf16 v[80:95], v[20:23], a[184:187], v[80:95]
    s_waitcnt lgkmcnt(4)
    v_mfma_f32_32x32x16_bf16 v[80:95], v[20:23], a[188:191], v[80:95]
    s_waitcnt lgkmcnt(2)
    v_mfma_f32_32x32x16_bf16 v[80:95], v[20:23], a[192:195], v[80:95]
    s_waitcnt lgkmcnt(0)
    v_mfma_f32_32x32x16_bf16 v[80:95], v[20:23], a[196:199], v[80:95]
    s_mov_b32 s0, s25
    s_mov_b32 s1, s24
    s_mov_b32 s3, 0
    s_nop 8
    buffer_store_dword v80, v30, s[4:7], s26 offen sc1
    s_nop 1
    s_branch interleave_layers__linear_kernel_hedgehog__geglu_ffn__prompt_kernel_ptail
interleave_layers__linear_kernel_hedgehog__geglu_ffn__prompt_kernel_notg:
    s_nop 1
    s_sub_u32 s19, s2, 236
    s_cmp_ge_u32 s19, 20
    s_cbranch_scc1 interleave_layers__linear_kernel_hedgehog__geglu_ffn__prompt_kernel_noto
    s_mov_b32 s8, s42
    s_mov_b32 s9, s43
    s_mov_b32 s10, 0xc8000
    s_mov_b32 s11, 0x20000
    s_lshl_b32 s20, s19, 2
    s_add_u32 s20, s20, s16
    s_mul_i32 s21, s20, 205
    s_lshr_b32 s21, s21, 10
    s_mul_i32 s22, s21, 5
    s_sub_u32 s22, s20, s22
    s_mul_i32 s20, s21, 40
    s_and_b32 s21, s22, 1
    s_mul_i32 s21, s21, 20
    s_add_u32 s20, s20, s21
    s_lshr_b32 s21, s22, 1
    s_lshl_b32 s21, s21, 3
    s_add_u32 s20, s20, s21
    s_cmp_eq_u32 s22, 4
    s_cselect_b32 s21, 20, 4
    s_add_u32 s21, s21, s20
    s_movk_i32 s24, 100
    s_branch interleave_layers__linear_kernel_hedgehog__geglu_ffn__prompt_kernel_rows
interleave_layers__linear_kernel_hedgehog__geglu_ffn__prompt_kernel_noto:
    s_mov_b32 s8, s36
    s_mov_b32 s9, s37
    s_mov_b32 s10, 0x280000
    s_mov_b32 s11, 0x20000
    s_sub_u32 s19, s2, 64
    s_lshr_b32 s19, s19, 3
    s_lshl_b32 s20, s17, 3
    s_add_u32 s19, s19, s20
    s_lshl_b32 s20, s19, 2
    s_add_u32 s20, s20, s16
    s_lshl_b32 s20, s20, 3
    s_add_u32 s21, s20, 4
    s_mov_b32 s24, 0
interleave_layers__linear_kernel_hedgehog__geglu_ffn__prompt_kernel_rows:
    s_nop 0
    s_mul_i32 s20, s20, 1280
    s_mul_i32 s21, s21, 1280
    s_mul_i32 s33, s16, 10368
    s_add_u32 m0, s33, 0
    s_nop 0
    buffer_load_dwordx4 v2, s[8:11], s20 offen lds
    s_add_u32 s20, s20, 1280
    s_add_u32 m0, s33, 1296
    s_nop 0
    buffer_load_dwordx4 v2, s[8:11], s20 offen lds
    s_add_u32 s20, s20, 1280
    s_add_u32 m0, s33, 2592
    s_nop 0
    buffer_load_dwordx4 v2, s[8:11], s20 offen lds
    s_add_u32 s20, s20, 1280
    s_add_u32 m0, s33, 3888
    s_nop 0
    buffer_load_dwordx4 v2, s[8:11], s20 offen lds
    s_add_u32 s20, s20, 1280
    s_add_u32 m0, s33, 5184
    s_nop 0
    buffer_load_dwordx4 v2, s[8:11], s21 offen lds
    s_add_u32 s21, s21, 1280
    s_add_u32 m0, s33, 6480
    s_nop 0
    buffer_load_dwordx4 v2, s[8:11], s21 offen lds
    s_add_u32 s21, s21, 1280
    s_add_u32 m0, s33, 7776
    s_nop 0
    buffer_load_dwordx4 v2, s[8:11], s21 offen lds
    s_add_u32 s21, s21, 1280
    s_add_u32 m0, s33, 9072
    s_nop 0
    buffer_load_dwordx4 v2, s[8:11], s21 offen lds
    s_add_u32 s21, s21, 1280
    s_mov_b64 exec, 0xffff
    s_sub_u32 s20, s20, 4096
    s_add_u32 m0, s33, 1024
    s_nop 0
    buffer_load_dwordx4 v2, s[8:11], s20 offen lds
    s_add_u32 s20, s20, 1280
    s_add_u32 m0, s33, 2320
    s_nop 0
    buffer_load_dwordx4 v2, s[8:11], s20 offen lds
    s_add_u32 s20, s20, 1280
    s_add_u32 m0, s33, 3616
    s_nop 0
    buffer_load_dwordx4 v2, s[8:11], s20 offen lds
    s_add_u32 s20, s20, 1280
    s_add_u32 m0, s33, 4912
    s_nop 0
    buffer_load_dwordx4 v2, s[8:11], s20 offen lds
    s_add_u32 s20, s20, 1280
    s_sub_u32 s21, s21, 4096
    s_add_u32 m0, s33, 6208
    s_nop 0
    buffer_load_dwordx4 v2, s[8:11], s21 offen lds
    s_add_u32 s21, s21, 1280
    s_add_u32 m0, s33, 7504
    s_nop 0
    buffer_load_dwordx4 v2, s[8:11], s21 offen lds
    s_add_u32 s21, s21, 1280
    s_add_u32 m0, s33, 8800
    s_nop 0
    buffer_load_dwordx4 v2, s[8:11], s21 offen lds
    s_add_u32 s21, s21, 1280
    s_add_u32 m0, s33, 10096
    s_nop 0
    buffer_load_dwordx4 v2, s[8:11], s21 offen lds
    s_add_u32 s21, s21, 1280
    s_mov_b64 exec, -1
    s_mov_b32 s8, s50
    s_mov_b32 s9, s51
    s_mov_b32 s10, 0x21c000
    s_mov_b32 s11, 0x20000
    s_sub_u32 s58, s2, 64
    s_lshr_b32 s59, s58, 5
    s_lshl_b32 s59, s59, 3
    s_add_u32 s59, s59, s17
    s_bfe_u32 s58, s58, 0x20003
    s_sub_u32 s68, s2, 232
    s_lshr_b32 s69, s68, 2
    s_add_u32 s69, s69, 48
    s_and_b32 s68, s68, 3
    v_mul_u32_u24 v240, 13, v1
    v_lshrrev_b32 v240, 8, v240
    v_mul_u32_u24 v241, 20, v240
    v_sub_u32 v241, v1, v241
    v_lshlrev_b32 v241, 4, v241
    v_cmp_gt_u32 vcc, 60, v1
    s_nop 1
    v_cndmask_b32 v241, v4, v241, vcc
    s_mul_i32 s62, s16, 9
    v_add_u32 v240, s62, v240
    s_lshl_b32 s70, s59, 1
    s_add_u32 s70, s70, 0
    s_cmp_ge_u32 s70, 28
    s_cselect_b32 s71, 1, 0
    s_cmp_ge_u32 s70, 56
    s_addc_u32 s71, s71, 0
    s_cmp_ge_u32 s70, 82
    s_addc_u32 s71, s71, 0
    s_mul_i32 s72, s71, 28
    s_cmp_eq_u32 s71, 3
    s_cselect_b32 s73, 2, 0
    s_sub_u32 s72, s72, s73
    s_sub_u32 s72, s70, s72
    s_mul_i32 s73, s72, 205
    s_lshr_b32 s73, s73, 10
    s_lshl_b32 s73, s73, 1
    s_add_u32 s73, s73, s72
    s_cmp_lt_u32 s71, 2
    s_cselect_b32 s74, 20, 18
    s_sub_u32 s75, s72, s74
    s_lshr_b32 s76, s75, 1
    s_mul_i32 s76, s76, 5
    s_add_u32 s76, s76, s75
    s_add_u32 s76, s76, 5
    s_cmp_eq_u32 s71, 3
    s_cselect_b32 s77, 7, 0
    s_sub_u32 s76, s76, s77
    s_cmp_lt_u32 s72, s74
    s_cselect_b32 s73, s73, s76
    s_mul_i32 s71, s71, 28
    s_add_u32 s73, s73, s71
    s_and_b32 s70, s70, -2
    s_cmp_eq_u32 s70, 80
    s_cselect_b32 s73, 80, s73
    s_lshl_b32 s78, s73, 4
    s_lshl_b32 s70, s59, 1
    s_add_u32 s70, s70, 1
    s_cmp_ge_u32 s70, 28
    s_cselect_b32 s71, 1, 0
    s_cmp_ge_u32 s70, 56
    s_addc_u32 s71, s71, 0
    s_cmp_ge_u32 s70, 82
    s_addc_u32 s71, s71, 0
    s_mul_i32 s72, s71, 28
    s_cmp_eq_u32 s71, 3
    s_cselect_b32 s73, 2, 0
    s_sub_u32 s72, s72, s73
    s_sub_u32 s72, s70, s72
    s_mul_i32 s73, s72, 205
    s_lshr_b32 s73, s73, 10
    s_lshl_b32 s73, s73, 1
    s_add_u32 s73, s73, s72
    s_cmp_lt_u32 s71, 2
    s_cselect_b32 s74, 20, 18
    s_sub_u32 s75, s72, s74
    s_lshr_b32 s76, s75, 1
    s_mul_i32 s76, s76, 5
    s_add_u32 s76, s76, s75
    s_add_u32 s76, s76, 5
    s_cmp_eq_u32 s71, 3
    s_cselect_b32 s77, 7, 0
    s_sub_u32 s76, s76, s77
    s_cmp_lt_u32 s72, s74
    s_cselect_b32 s73, s73, s76
    s_mul_i32 s71, s71, 28
    s_add_u32 s73, s73, s71
    s_and_b32 s70, s70, -2
    s_cmp_eq_u32 s70, 80
    s_cselect_b32 s73, 81, s73
    s_lshl_b32 s79, s73, 4
    s_sub_u32 s79, s79, 16
    s_mul_i32 s60, s58, 320
    s_mul_i32 s61, s16, 3120
    s_add_u32 s61, s61, 45696
    v_add_u32 v242, 0, v240
    v_mov_b32 v243, s78
    v_mov_b32 v248, s79
    v_cmp_gt_u32 vcc, 16, v242
    s_nop 1
    v_cndmask_b32 v243, v248, v243, vcc
    v_add_u32 v243, v243, v242
    v_mul_u32_u24 v243, 1280, v243
    v_add_u32 v243, v243, v241
    v_cmp_gt_u32 vcc, 32, v242
    s_nop 1
    v_cndmask_b32 v243, v4, v243, vcc
    s_add_u32 m0, s61, 0
    s_nop 0
    buffer_load_dwordx4 v243, s[8:11], s60 offen lds
    v_add_u32 v242, 3, v240
    v_mov_b32 v243, s78
    v_mov_b32 v248, s79
    v_cmp_gt_u32 vcc, 16, v242
    s_nop 1
    v_cndmask_b32 v243, v248, v243, vcc
    v_add_u32 v243, v243, v242
    v_mul_u32_u24 v243, 1280, v243
    v_add_u32 v243, v243, v241
    v_cmp_gt_u32 vcc, 32, v242
    s_nop 1
    v_cndmask_b32 v243, v4, v243, vcc
    s_add_u32 m0, s61, 1040
    s_nop 0
    buffer_load_dwordx4 v243, s[8:11], s60 offen lds
    v_add_u32 v242, 6, v240
    v_mov_b32 v243, s78
    v_mov_b32 v248, s79
    v_cmp_gt_u32 vcc, 16, v242
    s_nop 1
    v_cndmask_b32 v243, v248, v243, vcc
    v_add_u32 v243, v243, v242
    v_mul_u32_u24 v243, 1280, v243
    v_add_u32 v243, v243, v241
    v_cmp_gt_u32 vcc, 32, v242
    s_nop 1
    v_cndmask_b32 v243, v4, v243, vcc
    s_add_u32 m0, s61, 2080
    s_nop 0
    buffer_load_dwordx4 v243, s[8:11], s60 offen lds
    s_lshl_b32 s70, s69, 1
    s_add_u32 s70, s70, 0
    s_cmp_ge_u32 s70, 28
    s_cselect_b32 s71, 1, 0
    s_cmp_ge_u32 s70, 56
    s_addc_u32 s71, s71, 0
    s_cmp_ge_u32 s70, 82
    s_addc_u32 s71, s71, 0
    s_mul_i32 s72, s71, 28
    s_cmp_eq_u32 s71, 3
    s_cselect_b32 s73, 2, 0
    s_sub_u32 s72, s72, s73
    s_sub_u32 s72, s70, s72
    s_mul_i32 s73, s72, 205
    s_lshr_b32 s73, s73, 10
    s_lshl_b32 s73, s73, 1
    s_add_u32 s73, s73, s72
    s_cmp_lt_u32 s71, 2
    s_cselect_b32 s74, 20, 18
    s_sub_u32 s75, s72, s74
    s_lshr_b32 s76, s75, 1
    s_mul_i32 s76, s76, 5
    s_add_u32 s76, s76, s75
    s_add_u32 s76, s76, 5
    s_cmp_eq_u32 s71, 3
    s_cselect_b32 s77, 7, 0
    s_sub_u32 s76, s76, s77
    s_cmp_lt_u32 s72, s74
    s_cselect_b32 s73, s73, s76
    s_mul_i32 s71, s71, 28
    s_add_u32 s73, s73, s71
    s_and_b32 s70, s70, -2
    s_cmp_eq_u32 s70, 80
    s_cselect_b32 s73, 80, s73
    s_lshl_b32 s78, s73, 4
    s_lshl_b32 s70, s69, 1
    s_add_u32 s70, s70, 1
    s_cmp_ge_u32 s70, 28
    s_cselect_b32 s71, 1, 0
    s_cmp_ge_u32 s70, 56
    s_addc_u32 s71, s71, 0
    s_cmp_ge_u32 s70, 82
    s_addc_u32 s71, s71, 0
    s_mul_i32 s72, s71, 28
    s_cmp_eq_u32 s71, 3
    s_cselect_b32 s73, 2, 0
    s_sub_u32 s72, s72, s73
    s_sub_u32 s72, s70, s72
    s_mul_i32 s73, s72, 205
    s_lshr_b32 s73, s73, 10
    s_lshl_b32 s73, s73, 1
    s_add_u32 s73, s73, s72
    s_cmp_lt_u32 s71, 2
    s_cselect_b32 s74, 20, 18
    s_sub_u32 s75, s72, s74
    s_lshr_b32 s76, s75, 1
    s_mul_i32 s76, s76, 5
    s_add_u32 s76, s76, s75
    s_add_u32 s76, s76, 5
    s_cmp_eq_u32 s71, 3
    s_cselect_b32 s77, 7, 0
    s_sub_u32 s76, s76, s77
    s_cmp_lt_u32 s72, s74
    s_cselect_b32 s73, s73, s76
    s_mul_i32 s71, s71, 28
    s_add_u32 s73, s73, s71
    s_and_b32 s70, s70, -2
    s_cmp_eq_u32 s70, 80
    s_cselect_b32 s73, 81, s73
    s_lshl_b32 s79, s73, 4
    s_sub_u32 s79, s79, 16
    s_mul_i32 s60, s68, 320
    s_cmp_ge_u32 s2, 232
    s_cselect_b32 s60, s60, 0x40000000
    s_mul_i32 s61, s16, 3120
    s_add_u32 s61, s61, 58176
    v_add_u32 v242, 0, v240
    v_mov_b32 v243, s78
    v_mov_b32 v248, s79
    v_cmp_gt_u32 vcc, 16, v242
    s_nop 1
    v_cndmask_b32 v243, v248, v243, vcc
    v_add_u32 v243, v243, v242
    v_mul_u32_u24 v243, 1280, v243
    v_add_u32 v243, v243, v241
    v_cmp_gt_u32 vcc, 32, v242
    s_nop 1
    v_cndmask_b32 v243, v4, v243, vcc
    s_add_u32 m0, s61, 0
    s_nop 0
    buffer_load_dwordx4 v243, s[8:11], s60 offen lds
    v_add_u32 v242, 3, v240
    v_mov_b32 v243, s78
    v_mov_b32 v248, s79
    v_cmp_gt_u32 vcc, 16, v242
    s_nop 1
    v_cndmask_b32 v243, v248, v243, vcc
    v_add_u32 v243, v243, v242
    v_mul_u32_u24 v243, 1280, v243
    v_add_u32 v243, v243, v241
    v_cmp_gt_u32 vcc, 32, v242
    s_nop 1
    v_cndmask_b32 v243, v4, v243, vcc
    s_add_u32 m0, s61, 1040
    s_nop 0
    buffer_load_dwordx4 v243, s[8:11], s60 offen lds
    v_add_u32 v242, 6, v240
    v_mov_b32 v243, s78
    v_mov_b32 v248, s79
    v_cmp_gt_u32 vcc, 16, v242
    s_nop 1
    v_cndmask_b32 v243, v248, v243, vcc
    v_add_u32 v243, v243, v242
    v_mul_u32_u24 v243, 1280, v243
    v_add_u32 v243, v243, v241
    v_cmp_gt_u32 vcc, 32, v242
    s_nop 1
    v_cndmask_b32 v243, v4, v243, vcc
    s_add_u32 m0, s61, 2080
    s_nop 0
    buffer_load_dwordx4 v243, s[8:11], s60 offen lds
    s_getpc_b64 s[64:65]
pc_3:
    s_sub_u32 s64, s64, pc_3-interleave_layers__linear_kernel_hedgehog__geglu_ffn__prompt_kernel
    s_subb_u32 s65, s65, 0
    s_mov_b32 s66, interleave_layers__linear_kernel_hedgehog__geglu_ffn__prompt_kernel_end-interleave_layers__linear_kernel_hedgehog__geglu_ffn__prompt_kernel
    s_mov_b32 s67, 0x20000
    s_lshr_b32 s3, s2, 3
    s_lshl_b32 s3, s3, 2
    s_add_u32 s3, s3, s16
    s_lshl_b32 s3, s3, 10
    buffer_load_dwordx4 v[244:247], v2, s[64:67], s3 offen
    s_cmp_eq_u32 s24, 0
    s_cbranch_scc1 interleave_layers__linear_kernel_hedgehog__geglu_ffn__prompt_kernel_x
    v_lshrrev_b32 v8, 4, v1
    v_lshl_add_u32 v8, v8, 3, v6
    v_mul_u32_u24 v8, 1296, v8
    v_mad_u32_u24 v8, v7, 40, v8
    s_mul_i32 s26, s16, 320
    v_add_u32 v8, s26, v8
    s_mul_i32 s26, s16, 200
    s_mul_i32 s27, s19, 5
    s_add_u32 s26, s26, s27
    s_lshl_b32 s26, s26, 10
    s_add_u32 s25, s26, 0x280000
    s_mov_b32 s57, 0x40000000
    s_waitcnt vmcnt(1)
    s_barrier
    ds_read_b64_tr_b16 a[160:161], v8 offset:0
    ds_read_b64_tr_b16 a[162:163], v8 offset:5184
    ds_read_b64_tr_b16 a[164:165], v8 offset:8
    ds_read_b64_tr_b16 a[166:167], v8 offset:5192
    ds_read_b64_tr_b16 a[168:169], v8 offset:16
    ds_read_b64_tr_b16 a[170:171], v8 offset:5200
    ds_read_b64_tr_b16 a[172:173], v8 offset:24
    ds_read_b64_tr_b16 a[174:175], v8 offset:5208
    ds_read_b64_tr_b16 a[176:177], v8 offset:32
    ds_read_b64_tr_b16 a[178:179], v8 offset:5216
    ds_read_b64_tr_b16 a[180:181], v8 offset:160
    ds_read_b64_tr_b16 a[182:183], v8 offset:5344
    ds_read_b64_tr_b16 a[184:185], v8 offset:168
    ds_read_b64_tr_b16 a[186:187], v8 offset:5352
    ds_read_b64_tr_b16 a[188:189], v8 offset:176
    ds_read_b64_tr_b16 a[190:191], v8 offset:5360
    ds_read_b64_tr_b16 a[192:193], v8 offset:184
    ds_read_b64_tr_b16 a[194:195], v8 offset:5368
    ds_read_b64_tr_b16 a[196:197], v8 offset:192
    ds_read_b64_tr_b16 a[198:199], v8 offset:5376
    s_mov_b32 s0, s25
    s_movk_i32 s1, 1024
    s_mov_b32 s3, 97280
    s_waitcnt lgkmcnt(0)
    s_nop 1
    s_branch interleave_layers__linear_kernel_hedgehog__geglu_ffn__prompt_kernel_ptail
interleave_layers__linear_kernel_hedgehog__geglu_ffn__prompt_kernel_x:
    s_nop 1
    v_and_b32 v8, 31, v1
    v_lshrrev_b32 v9, 5, v1
    v_mul_u32_u24 v10, 1296, v8
    s_mul_i32 s26, s16, 320
    v_add_u32 v10, s26, v10
    v_mad_u32_u24 v14, v9, 40, v10
    v_mad_u32_u24 v15, v9, 40, v14
    s_mul_i32 s24, s19, 40
    s_mul_i32 s25, s16, 10
    s_add_u32 s24, s24, s25
    s_lshl_b32 s24, s24, 10
    s_add_u32 s24, s24, 0x9e2000
    s_lshl_b32 s25, s19, 2
    s_add_u32 s25, s25, s16
    s_lshl_b32 s25, s25, 9
    s_add_u32 s25, s25, 0xc62000
    v_lshlrev_b32 v13, 4, v8
    v_lshl_add_u32 v13, v9, 3, v13
    s_lshl_b32 s57, s19, 7
    s_add_u32 s57, s57, 22822912
    s_waitcnt vmcnt(1)
    s_barrier
    ds_read2_b64 v[32:35], v14 offset0:0 offset1:1
    ds_read2_b64 v[36:39], v14 offset0:10 offset1:11
    ds_read2_b64 v[40:43], v14 offset0:2 offset1:3
    ds_read2_b64 v[44:47], v14 offset0:12 offset1:13
    ds_read2_b64 v[48:51], v15 offset0:4 offset1:9
    ds_read2_b64 v[52:55], v14 offset0:20 offset1:21
    ds_read2_b64 v[56:59], v14 offset0:30 offset1:31
    ds_read2_b64 v[60:63], v14 offset0:22 offset1:23
    ds_read2_b64 v[64:67], v14 offset0:32 offset1:33
    ds_read2_b64 v[68:71], v15 offset0:24 offset1:29
    s_waitcnt lgkmcnt(9)
    buffer_store_dwordx4 v[32:35], v2, s[4:7], s24 offen offset:0 sc1
    s_waitcnt lgkmcnt(8)
    buffer_store_dwordx4 v[36:39], v2, s[4:7], s24 offen offset:1024 sc1
    s_waitcnt lgkmcnt(7)
    buffer_store_dwordx4 v[40:43], v2, s[4:7], s24 offen offset:2048 sc1
    s_waitcnt lgkmcnt(6)
    buffer_store_dwordx4 v[44:47], v2, s[4:7], s24 offen offset:3072 sc1
    s_add_u32 s24, s24, 4096
    s_waitcnt lgkmcnt(5)
    buffer_store_dwordx4 v[48:51], v2, s[4:7], s24 offen offset:0 sc1
    s_waitcnt lgkmcnt(4)
    buffer_store_dwordx4 v[52:55], v2, s[4:7], s24 offen offset:1024 sc1
    s_waitcnt lgkmcnt(3)
    buffer_store_dwordx4 v[56:59], v2, s[4:7], s24 offen offset:2048 sc1
    s_waitcnt lgkmcnt(2)
    buffer_store_dwordx4 v[60:63], v2, s[4:7], s24 offen offset:3072 sc1
    s_add_u32 s24, s24, 4096
    s_waitcnt lgkmcnt(1)
    buffer_store_dwordx4 v[64:67], v2, s[4:7], s24 offen offset:0 sc1
    s_waitcnt lgkmcnt(0)
    buffer_store_dwordx4 v[68:71], v2, s[4:7], s24 offen offset:1024 sc1
    v_mov_b32 v20, 0
    v_mov_b32 v21, 0
    v_mov_b32 v22, 0
    v_mov_b32 v23, 0
    v_dot2c_f32_bf16 v20, 0x3f803f80, v32
    v_dot2c_f32_bf16 v21, v32, v32
    v_dot2c_f32_bf16 v22, 0x3f803f80, v52
    v_dot2c_f32_bf16 v23, v52, v52
    v_dot2c_f32_bf16 v20, 0x3f803f80, v33
    v_dot2c_f32_bf16 v21, v33, v33
    v_dot2c_f32_bf16 v22, 0x3f803f80, v53
    v_dot2c_f32_bf16 v23, v53, v53
    v_dot2c_f32_bf16 v20, 0x3f803f80, v34
    v_dot2c_f32_bf16 v21, v34, v34
    v_dot2c_f32_bf16 v22, 0x3f803f80, v54
    v_dot2c_f32_bf16 v23, v54, v54
    v_dot2c_f32_bf16 v20, 0x3f803f80, v35
    v_dot2c_f32_bf16 v21, v35, v35
    v_dot2c_f32_bf16 v22, 0x3f803f80, v55
    v_dot2c_f32_bf16 v23, v55, v55
    v_dot2c_f32_bf16 v20, 0x3f803f80, v36
    v_dot2c_f32_bf16 v21, v36, v36
    v_dot2c_f32_bf16 v22, 0x3f803f80, v56
    v_dot2c_f32_bf16 v23, v56, v56
    v_dot2c_f32_bf16 v20, 0x3f803f80, v37
    v_dot2c_f32_bf16 v21, v37, v37
    v_dot2c_f32_bf16 v22, 0x3f803f80, v57
    v_dot2c_f32_bf16 v23, v57, v57
    v_dot2c_f32_bf16 v20, 0x3f803f80, v38
    v_dot2c_f32_bf16 v21, v38, v38
    v_dot2c_f32_bf16 v22, 0x3f803f80, v58
    v_dot2c_f32_bf16 v23, v58, v58
    v_dot2c_f32_bf16 v20, 0x3f803f80, v39
    v_dot2c_f32_bf16 v21, v39, v39
    v_dot2c_f32_bf16 v22, 0x3f803f80, v59
    v_dot2c_f32_bf16 v23, v59, v59
    v_dot2c_f32_bf16 v20, 0x3f803f80, v40
    v_dot2c_f32_bf16 v21, v40, v40
    v_dot2c_f32_bf16 v22, 0x3f803f80, v60
    v_dot2c_f32_bf16 v23, v60, v60
    v_dot2c_f32_bf16 v20, 0x3f803f80, v41
    v_dot2c_f32_bf16 v21, v41, v41
    v_dot2c_f32_bf16 v22, 0x3f803f80, v61
    v_dot2c_f32_bf16 v23, v61, v61
    v_dot2c_f32_bf16 v20, 0x3f803f80, v42
    v_dot2c_f32_bf16 v21, v42, v42
    v_dot2c_f32_bf16 v22, 0x3f803f80, v62
    v_dot2c_f32_bf16 v23, v62, v62
    v_dot2c_f32_bf16 v20, 0x3f803f80, v43
    v_dot2c_f32_bf16 v21, v43, v43
    v_dot2c_f32_bf16 v22, 0x3f803f80, v63
    v_dot2c_f32_bf16 v23, v63, v63
    v_dot2c_f32_bf16 v20, 0x3f803f80, v44
    v_dot2c_f32_bf16 v21, v44, v44
    v_dot2c_f32_bf16 v22, 0x3f803f80, v64
    v_dot2c_f32_bf16 v23, v64, v64
    v_dot2c_f32_bf16 v20, 0x3f803f80, v45
    v_dot2c_f32_bf16 v21, v45, v45
    v_dot2c_f32_bf16 v22, 0x3f803f80, v65
    v_dot2c_f32_bf16 v23, v65, v65
    v_dot2c_f32_bf16 v20, 0x3f803f80, v46
    v_dot2c_f32_bf16 v21, v46, v46
    v_dot2c_f32_bf16 v22, 0x3f803f80, v66
    v_dot2c_f32_bf16 v23, v66, v66
    v_dot2c_f32_bf16 v20, 0x3f803f80, v47
    v_dot2c_f32_bf16 v21, v47, v47
    v_dot2c_f32_bf16 v22, 0x3f803f80, v67
    v_dot2c_f32_bf16 v23, v67, v67
    v_dot2c_f32_bf16 v20, 0x3f803f80, v48
    v_dot2c_f32_bf16 v21, v48, v48
    v_dot2c_f32_bf16 v22, 0x3f803f80, v68
    v_dot2c_f32_bf16 v23, v68, v68
    v_dot2c_f32_bf16 v20, 0x3f803f80, v49
    v_dot2c_f32_bf16 v21, v49, v49
    v_dot2c_f32_bf16 v22, 0x3f803f80, v69
    v_dot2c_f32_bf16 v23, v69, v69
    v_dot2c_f32_bf16 v20, 0x3f803f80, v50
    v_dot2c_f32_bf16 v21, v50, v50
    v_dot2c_f32_bf16 v22, 0x3f803f80, v70
    v_dot2c_f32_bf16 v23, v70, v70
    v_dot2c_f32_bf16 v20, 0x3f803f80, v51
    v_dot2c_f32_bf16 v21, v51, v51
    v_dot2c_f32_bf16 v22, 0x3f803f80, v71
    v_dot2c_f32_bf16 v23, v71, v71
    s_nop 0
    v_permlane32_swap_b32 v20, v21
    s_nop 0
    v_permlane32_swap_b32 v22, v23
    v_add_f32 v24, v20, v21
    v_add_f32 v25, v22, v23
    buffer_store_dwordx2 v[24:25], v13, s[4:7], s25 offen sc1
    s_mov_b32 s0, 0x40000000
    s_mov_b32 s1, 0
    s_mov_b32 s3, 0
interleave_layers__linear_kernel_hedgehog__geglu_ffn__prompt_kernel_ptail:
    s_nop 1
    v_lshrrev_b32 v10, 4, v1
    v_lshl_add_u32 v10, v10, 3, v6
    v_add_u32 v10, 0, v10
    v_mul_u32_u24 v11, 43, v10
    v_lshrrev_b32 v11, 7, v11
    v_mul_u32_u24 v12, 320, v10
    v_mad_u32_u24 v12, v7, 40, v12
    v_mul_u32_u24 v11, 80, v11
    v_add_u32 v11, v11, v12
    v_add_u32 v14, 45696, v11
    v_lshrrev_b32 v10, 4, v1
    v_lshl_add_u32 v10, v10, 3, v6
    v_add_u32 v10, 4, v10
    v_mul_u32_u24 v11, 43, v10
    v_lshrrev_b32 v11, 7, v11
    v_mul_u32_u24 v12, 320, v10
    v_mad_u32_u24 v12, v7, 40, v12
    v_mul_u32_u24 v11, 80, v11
    v_add_u32 v11, v11, v12
    v_add_u32 v15, 45696, v11
    s_add_u32 s20, s16, 0
    s_cmp_ge_u32 s20, 5
    s_cselect_b32 s22, 120, 0
    s_lshl_b32 s23, s20, 3
    s_add_u32 s22, s22, s23
    s_add_u32 s22, s22, 0
    v_add_u32 v16, s22, v14
    v_add_u32 v17, s22, v15
    ds_read_b64_tr_b16 a[200:201], v16
    ds_read_b64_tr_b16 a[202:203], v17
    s_add_u32 s20, s16, 4
    s_cmp_ge_u32 s20, 5
    s_cselect_b32 s22, 120, 0
    s_lshl_b32 s23, s20, 3
    s_add_u32 s22, s22, s23
    s_add_u32 s22, s22, 0
    v_add_u32 v16, s22, v14
    v_add_u32 v17, s22, v15
    ds_read_b64_tr_b16 a[204:205], v16
    ds_read_b64_tr_b16 a[206:207], v17
    s_add_u32 s20, s16, 8
    s_cmp_ge_u32 s20, 5
    s_cselect_b32 s22, 120, 0
    s_lshl_b32 s23, s20, 3
    s_add_u32 s22, s22, s23
    s_add_u32 s22, s22, 0
    v_add_u32 v16, s22, v14
    v_add_u32 v17, s22, v15
    ds_read_b64_tr_b16 a[208:209], v16
    ds_read_b64_tr_b16 a[210:211], v17
    s_mul_i32 s22, s58, 540
    s_mul_i32 s23, s59, 5
    s_add_u32 s22, s22, s23
    s_add_u32 s22, s22, s16
    s_lshl_b32 s22, s22, 10
    s_add_u32 s22, s22, 0x348000
    s_cmp_ge_u32 s2, 64
    s_cselect_b32 s24, s22, 0x40000000
    s_add_u32 s20, s16, 0
    s_cmp_ge_u32 s20, 5
    s_cselect_b32 s22, 120, 0
    s_lshl_b32 s23, s20, 3
    s_add_u32 s22, s22, s23
    s_add_u32 s22, s22, 12480
    v_add_u32 v16, s22, v14
    v_add_u32 v17, s22, v15
    ds_read_b64_tr_b16 a[212:213], v16
    ds_read_b64_tr_b16 a[214:215], v17
    s_add_u32 s20, s16, 4
    s_cmp_ge_u32 s20, 5
    s_cselect_b32 s22, 120, 0
    s_lshl_b32 s23, s20, 3
    s_add_u32 s22, s22, s23
    s_add_u32 s22, s22, 12480
    v_add_u32 v16, s22, v14
    v_add_u32 v17, s22, v15
    ds_read_b64_tr_b16 a[216:217], v16
    ds_read_b64_tr_b16 a[218:219], v17
    s_add_u32 s20, s16, 8
    s_cmp_ge_u32 s20, 5
    s_cselect_b32 s22, 120, 0
    s_lshl_b32 s23, s20, 3
    s_add_u32 s22, s22, s23
    s_add_u32 s22, s22, 12480
    v_add_u32 v16, s22, v14
    v_add_u32 v17, s22, v15
    ds_read_b64_tr_b16 a[220:221], v16
    ds_read_b64_tr_b16 a[222:223], v17
    s_mul_i32 s22, s68, 540
    s_mul_i32 s23, s69, 5
    s_add_u32 s22, s22, s23
    s_add_u32 s22, s22, s16
    s_lshl_b32 s22, s22, 10
    s_add_u32 s22, s22, 0x348000
    s_cmp_ge_u32 s2, 232
    s_cselect_b32 s25, s22, 0x40000000
    s_mov_b32 s58, s24
    s_mov_b32 s59, s25
    s_cmp_ge_u32 s16, 1
    s_cselect_b32 s100, 271360, 0
    s_add_u32 s100, s100, 4096
    s_mov_b32 s101, 0x40000000
    s_cmp_lt_u32 s16, 2
    s_cselect_b32 s101, 279552, s101
    v_readfirstlane_b32 s56, v5
    v_mov_b32 v228, -1
    v_mov_b32 v229, -1
    v_mov_b32 v230, -1
    v_mov_b32 v231, -1
    v_lshlrev_b32 v232, 4, v0
    s_add_u32 s56, s56, 16
    s_waitcnt lgkmcnt(0)
    v_and_b32 v45, 63, v0
    s_getreg_b32 s25, hwreg(HW_REG_XCC_ID, 0, 4)
    v_lshlrev_b32 v1, 4, v45
    s_lshr_b32 s18, s2, 3
    s_lshr_b32 s61, s18, 4
    s_lshl_b32 s19, s17, 1
    s_add_u32 s19, s19, s61
    s_and_b32 s20, s18, 15
    s_lshr_b32 s61, s18, 3
    s_lshl_b32 s21, s17, 2
    s_add_u32 s21, s21, s61
    s_and_b32 s22, s18, 7
    s_lshl_b32 s32, s16, 12
    s_lshl_b32 s33, s16, 14
    s_lshl_b32 s54, s16, 11
    s_mul_i32 s37, s20, 163840
    s_add_u32 s37, s37, s32
    s_add_u32 s37, s37, 0
    v_add_u32 v2, 4096, v1
    v_add_u32 v3, 8192, v1
    v_add_u32 v4, 12288, v1
    s_lshl_b32 s70, s19, 2
    s_add_u32 s70, s70, s16
    s_mul_i32 s34, s70, 40960
    s_lshl_b32 s35, s70, 11
    s_add_u32 s61, s34, 10362880
    s_add_u32 s62, s35, 12984320
    v_and_b32 v46, 31, v45
    v_lshlrev_b32 v47, 3, v46
    v_lshrrev_b32 v49, 5, v45
    v_lshlrev_b32 v205, 4, v49
    v_lshl_add_u32 v205, v46, 5, v205
    s_lshl_b32 s76, s20, 12
    s_add_u32 s76, s76, 5652480
    s_mov_b32 s77, 22831104
    s_lshl_b32 s78, s17, 5
    s_add_u32 s78, s78, s18
    s_lshl_b32 s78, s78, 2
    s_add_u32 s78, s78, 22831104
    s_xor_b32 s70, s56, s25
    v_mov_b32 v204, s70
    s_add_u32 s8, s96, 5775360
    s_addc_u32 s9, s97, 0
    s_mov_b32 s10, 0x438000
    s_mov_b32 s11, 0x20000
    s_mov_b32 s12, s98
    s_mov_b32 s13, s99
    s_mov_b32 s14, 0x280000
    s_mov_b32 s15, 0x20000
    v_mov_b32 v5, 0
    v_mov_b32 v6, 1
    v_add_u32 v38, 65536, v1
    v_add_u32 v39, 131072, v1
    v_and_b32 v48, 15, v45
    v_lshlrev_b32 v7, 2, v48
    v_and_b32 v8, 28, v7
    v_min_u32 v9, 9, v45
    v_lshlrev_b32 v9, 2, v9
    v_lshrrev_b32 v49, 5, v45
    v_lshlrev_b32 v47, 1, v47
    v_lshl_add_u32 v10, v49, 10, v47
    v_bfe_u32 v50, v45, 4, 1
    v_mul_u32_u24 v11, 55296, v50
    v_lshl_add_u32 v11, v48, 4, v11
    v_lshl_add_u32 v11, v49, 8, v11
    v_lshlrev_b32 v51, 4, v48
    v_lshl_add_u32 v12, v49, 10, v51
    v_lshl_add_u32 v12, v50, 9, v12
    v_lshl_add_u32 v13, v49, 9, v51
    v_lshl_add_u32 v13, v50, 3, v13
    v_add_u32 v13, 4096, v13
    v_lshlrev_b32 v14, 4, v48
    v_lshl_add_u32 v14, v49, 3, v14
    v_add_u32 v15, s33, v1
    s_add_u32 s70, s16, 1
    s_and_b32 s70, s70, 3
    s_lshl_b32 s70, s70, 14
    v_add_u32 v40, s70, v1
    s_add_u32 s70, s16, 2
    s_and_b32 s70, s70, 3
    s_lshl_b32 s70, s70, 14
    v_add_u32 v41, s70, v1
    s_add_u32 s70, s16, 3
    s_and_b32 s70, s70, 3
    s_lshl_b32 s70, s70, 14
    v_add_u32 v42, s70, v1
    s_mov_b32 s23, 0
    s_mov_b32 s24, 0
    s_mov_b32 s26, 0
    s_mov_b32 s27, -1
    s_movk_i32 s28, 0x3f80
    s_mov_b32 s29, 0x3f800000
    s_mov_b32 s30, 0x3f803f80
    s_lshl_b32 s70, s19, 2
    s_add_u32 s70, s70, s16
    s_lshl_b32 s36, s70, 7
    s_mul_i32 s38, s20, 286720
    s_add_u32 s38, s38, s32
    s_mul_i32 s39, s22, 100
    s_mul_i32 s71, s16, 25
    s_add_u32 s39, s39, s71
    s_lshl_b32 s39, s39, 10
    s_add_u32 s39, s39, 2621440
    s_mul_i32 s71, s16, 13
    s_min_u32 s72, s16, 1
    s_add_u32 s71, s71, s72
    s_mul_i32 s72, s71, 5
    s_mul_i32 s40, s22, 270
    s_add_u32 s40, s40, s72
    s_lshl_b32 s40, s40, 10
    s_add_u32 s40, s40, 3440640
    s_mul_i32 s53, s21, 216
    s_add_u32 s53, s53, s71
    s_lshl_b32 s53, s53, 10
    s_add_u32 s53, s53, 15736832
    s_mul_i32 s52, s21, 80
    s_mul_i32 s71, s16, 5
    s_add_u32 s52, s52, s71
    s_lshl_b32 s52, s52, 10
    s_add_u32 s52, s52, 13115392
    s_lshr_b32 s71, s16, 1
    s_and_b32 s72, s16, 1
    s_lshl_b32 s73, s21, 1
    s_add_u32 s73, s73, s71
    s_mul_i32 s41, s73, 40
    s_mul_i32 s74, s22, 5
    s_add_u32 s41, s41, s74
    s_lshl_b32 s41, s41, 2
    s_add_u32 s41, s41, s72
    s_lshl_b32 s41, s41, 8
    s_lshl_b32 s42, s73, 2
    s_lshr_b32 s74, s22, 1
    s_add_u32 s42, s42, s74
    s_lshl_b32 s42, s42, 1
    s_add_u32 s42, s42, s72
    s_lshl_b32 s42, s42, 6
    s_and_b32 s74, s22, 1
    s_add_u32 s42, s42, s74
    s_lshl_b32 s42, s42, 2
    s_lshl_b32 s43, s73, 4
    s_add_u32 s43, s43, s22
    s_lshl_b32 s43, s43, 1
    s_add_u32 s43, s43, s72
    s_lshl_b32 s43, s43, 2
    s_lshl_b32 s73, s19, 1
    s_add_u32 s73, s73, s71
    s_lshl_b32 s45, s73, 4
    s_add_u32 s45, s45, s20
    s_lshl_b32 s45, s45, 1
    s_add_u32 s45, s45, s72
    s_lshl_b32 s45, s45, 2
    s_lshl_b32 s73, s70, 1
    s_mul_i32 s44, s73, 20480
    s_mul_i32 s74, s20, 1280
    s_add_u32 s44, s44, s74
    s_mul_i32 s46, s73, 55296
    s_lshr_b32 s74, s20, 2
    s_mul_i32 s75, s74, 28
    s_and_b32 s73, s20, 3
    s_mul_i32 s55, s73, 5
    s_add_u32 s55, s55, s75
    s_cmp_eq_u32 s74, 3
    s_cselect_b32 s33, 2, 0
    s_sub_u32 s55, s55, s33
    s_lshl_b32 s73, s73, 1
    s_add_u32 s75, s75, s73
    s_cmp_lt_u32 s74, 2
    s_cselect_b32 s33, 15, 13
    s_add_u32 s33, s33, s75
    s_lshl_b32 s74, s55, 9
    s_cmp_eq_u32 s20, 11
    s_cselect_b32 s55, 77, s55
    s_cselect_b32 s33, 95, s33
    s_lshl_b32 s55, s55, 9
    s_lshl_b32 s33, s33, 9
    s_add_u32 s55, s55, s46
    s_add_u32 s33, s33, s46
    s_add_u32 s46, s46, s74
    s_cmp_lt_u32 s20, 15
    s_cselect_b32 s55, s55, 0x40000000
    s_cselect_b32 s33, s33, 0x40000000
    s_mul_i32 s47, s20, 55296
    s_mul_i32 s48, s19, 3456
    s_add_u32 s48, s48, s47
    s_lshl_b32 s73, s21, 7
    s_lshl_b32 s49, s16, 5
    s_add_u32 s49, s49, s73
    s_cmp_eq_u32 s16, 3
    s_cselect_b32 s74, 8, 0
    s_sub_u32 s50, s49, s74
    s_lshl_b32 s51, s21, 2
    s_add_u32 s51, s51, s16
    s_mul_i32 s51, s51, 20480
    s_mul_i32 s74, s22, 160
    s_add_u32 s51, s51, s74
    v_mov_b32 v206, s56
    s_lshr_b32 s70, s20, 1
    s_lshl_b32 s70, s70, 10
    s_add_u32 s70, s70, 22814720
    s_lshl_b32 s71, s19, 9
    s_add_u32 s71, s71, 22822912
    s_cmp_eq_u32 s16, 0
    s_cselect_b32 s57, s57, 0x40000000
    s_cselect_b32 s78, s78, 0x40000000
    v_and_b32 v207, 7, v45
    v_lshl_add_u32 v207, v207, 7, s70
    v_and_b32 v208, 3, v45
    v_lshl_add_u32 v208, v208, 7, s71
    v_cndmask_b32 v207, v207, v208, s[26:27]
    s_cmp_ge_u32 s2, 128
    s_cbranch_scc1 noflag_4
    s_waitcnt vmcnt(0)
    s_barrier
noflag_4:
    buffer_store_dword v206, v5, s[4:7], s57 offen sc1
    s_cmp_lg_u32 s16, 0
    s_cbranch_scc1 pok_6
    s_mov_b32 s31, 0
poll_5:
    buffer_load_dword v208, v207, s[4:7], 0 offen sc1
    s_add_u32 s31, s31, 1
    s_waitcnt vmcnt(0)
    v_cmp_ne_u32 vcc, s56, v208
    s_nop 0
    s_cbranch_vccz pok_6
    s_sleep 4
    s_cmp_lt_u32 s31, 32768
    s_cbranch_scc1 poll_5
pok_6:
    buffer_store_dwordx4 a[160:163], v1, s[4:7], s0 offen sc1
    s_add_u32 s0, s0, s1
    buffer_store_dwordx4 a[164:167], v1, s[4:7], s0 offen sc1
    s_add_u32 s0, s0, s1
    buffer_store_dwordx4 a[168:171], v1, s[4:7], s0 offen sc1
    s_add_u32 s0, s0, s1
    buffer_store_dwordx4 a[172:175], v1, s[4:7], s0 offen sc1
    s_add_u32 s0, s0, s1
    buffer_store_dwordx4 a[176:179], v1, s[4:7], s0 offen sc1
    s_add_u32 s0, s0, s1
    s_add_u32 s0, s0, s3
    buffer_store_dwordx4 a[180:183], v1, s[4:7], s0 offen sc1
    s_add_u32 s0, s0, s1
    buffer_store_dwordx4 a[184:187], v1, s[4:7], s0 offen sc1
    s_add_u32 s0, s0, s1
    buffer_store_dwordx4 a[188:191], v1, s[4:7], s0 offen sc1
    s_add_u32 s0, s0, s1
    buffer_store_dwordx4 a[192:195], v1, s[4:7], s0 offen sc1
    s_add_u32 s0, s0, s1
    buffer_store_dwordx4 a[196:199], v1, s[4:7], s0 offen sc1
    s_add_u32 s0, s0, s1
    buffer_store_dwordx4 a[200:203], v1, s[4:7], s58 offen sc1
    s_add_u32 s72, s58, s100
    buffer_store_dwordx4 a[204:207], v1, s[4:7], s72 offen sc1
    s_add_u32 s72, s58, s101
    buffer_store_dwordx4 a[208:211], v1, s[4:7], s72 offen sc1
    buffer_store_dwordx4 a[212:215], v1, s[4:7], s59 offen sc1
    s_add_u32 s72, s59, s100
    buffer_store_dwordx4 a[216:219], v1, s[4:7], s72 offen sc1
    s_add_u32 s72, s59, s101
    buffer_store_dwordx4 a[220:223], v1, s[4:7], s72 offen sc1
    s_sub_u32 s1, s2, 64
    s_mul_i32 s0, s1, 12288
    s_add_u32 s0, s0, 0x15c8000
    s_cmp_lt_u32 s1, 77
    s_cselect_b32 s0, s0, 0x40000000
    buffer_store_dwordx4 v[228:231], v232, s[4:7], s0 offen sc1
    s_add_u32 s0, s0, 4096
    buffer_store_dwordx4 v[228:231], v232, s[4:7], s0 offen sc1
    s_add_u32 s0, s0, 4096
    buffer_store_dwordx4 v[228:231], v232, s[4:7], s0 offen sc1
    s_barrier
    s_add_u32 m0, s32, 65536
    s_add_u32 s60, s37, 0
    buffer_load_dwordx4 v1, s[4:7], s60 offen offset:0 sc1 lds
    buffer_load_dwordx4 v1, s[4:7], s60 offen offset:1024 sc1 lds
    buffer_load_dwordx4 v1, s[4:7], s60 offen offset:2048 sc1 lds
    buffer_load_dwordx4 v1, s[4:7], s60 offen offset:3072 sc1 lds
    buffer_load_dwordx4 a[0:3], v1, s[4:7], s61 offen offset:0 sc1
    buffer_load_dwordx4 a[4:7], v1, s[4:7], s61 offen offset:1024 sc1
    s_add_u32 m0, s32, 81920
    s_add_u32 s60, s37, 16384
    buffer_load_dwordx4 v1, s[4:7], s60 offen offset:0 sc1 lds
    buffer_load_dwordx4 v1, s[4:7], s60 offen offset:1024 sc1 lds
    buffer_load_dwordx4 a[8:11], v1, s[4:7], s61 offen offset:2048 sc1
    buffer_load_dwordx4 a[12:15], v1, s[4:7], s61 offen offset:3072 sc1
    buffer_load_dwordx4 a[16:19], v2, s[4:7], s61 offen offset:0 sc1
    buffer_load_dwordx4 v1, s[4:7], s60 offen offset:2048 sc1 lds
    buffer_load_dwordx4 v1, s[4:7], s60 offen offset:3072 sc1 lds
    buffer_load_dwordx4 a[20:23], v2, s[4:7], s61 offen offset:1024 sc1
    s_waitcnt vmcnt(10)
    s_barrier
    ds_read_b128 v[108:111], v38 offset:0
    ds_read_b128 v[112:115], v38 offset:1024
    ds_read_b128 v[116:119], v38 offset:2048
    ds_read_b128 v[120:123], v38 offset:3072
    ds_read_b128 v[124:127], v38 offset:4096
    s_waitcnt vmcnt(9) lgkmcnt(3)
    v_mfma_f32_32x32x16_bf16 v[44:59], v[108:111], a[0:3], 0
    ds_read_b128 v[128:131], v38 offset:5120
    buffer_load_dwordx4 a[24:27], v2, s[4:7], s61 offen offset:2048 sc1
    v_mfma_f32_32x32x16_bf16 v[60:75], v[112:115], a[0:3], 0
    ds_read_b128 v[108:111], v38 offset:6144
    buffer_load_dwordx4 a[28:31], v2, s[4:7], s61 offen offset:3072 sc1
    s_waitcnt vmcnt(10) lgkmcnt(3)
    v_mfma_f32_32x32x16_bf16 v[44:59], v[116:119], a[4:7], v[44:59]
    ds_read_b128 v[112:115], v38 offset:7168
    s_add_u32 m0, s32, 98304
    s_add_u32 s60, s37, 32768
    buffer_load_dwordx4 v1, s[4:7], s60 offen offset:0 sc1 lds
    v_mfma_f32_32x32x16_bf16 v[60:75], v[120:123], a[4:7], v[60:75]
    ds_read_b128 v[116:119], v38 offset:8192
    buffer_load_dwordx4 v1, s[4:7], s60 offen offset:1024 sc1 lds
    s_waitcnt vmcnt(9) lgkmcnt(3)
    v_mfma_f32_32x32x16_bf16 v[44:59], v[124:127], a[8:11], v[44:59]
    ds_read_b128 v[120:123], v38 offset:9216
    buffer_load_dwordx4 a[32:35], v3, s[4:7], s61 offen offset:0 sc1
    v_mfma_f32_32x32x16_bf16 v[60:75], v[128:131], a[8:11], v[60:75]
    ds_read_b128 v[124:127], v38 offset:10240
    buffer_load_dwordx4 a[36:39], v3, s[4:7], s61 offen offset:1024 sc1
    s_waitcnt vmcnt(10) lgkmcnt(3)
    v_mfma_f32_32x32x16_bf16 v[44:59], v[108:111], a[12:15], v[44:59]
    ds_read_b128 v[128:131], v38 offset:11264
    buffer_load_dwordx4 a[40:43], v3, s[4:7], s61 offen offset:2048 sc1
    v_mfma_f32_32x32x16_bf16 v[60:75], v[112:115], a[12:15], v[60:75]
    ds_read_b128 v[108:111], v38 offset:12288
    buffer_load_dwordx4 v1, s[4:7], s60 offen offset:2048 sc1 lds
    s_waitcnt vmcnt(11) lgkmcnt(3)
    v_mfma_f32_32x32x16_bf16 v[44:59], v[116:119], a[16:19], v[44:59]
    ds_read_b128 v[112:115], v38 offset:13312
    buffer_load_dwordx4 v1, s[4:7], s60 offen offset:3072 sc1 lds
    v_and_b32 v220, 63, v0
    v_and_b32 v221, 31, v220
    v_lshrrev_b32 v222, 5, v220
    v_and_b32 v223, 1, v220
    v_mfma_f32_32x32x16_bf16 v[60:75], v[120:123], a[16:19], v[60:75]
    ds_read_b128 v[116:119], v38 offset:14336
    buffer_load_dwordx4 a[44:47], v3, s[4:7], s61 offen offset:3072 sc1
    v_bfe_u32 v224, v220, 1, 1
    s_waitcnt vmcnt(11)
    s_barrier
    s_waitcnt vmcnt(10) lgkmcnt(3)
    v_mfma_f32_32x32x16_bf16 v[44:59], v[124:127], a[20:23], v[44:59]
    ds_read_b128 v[120:123], v38 offset:15360
    buffer_load_dwordx4 a[48:51], v4, s[4:7], s61 offen offset:0 sc1
    v_lshl_or_b32 v223, v224, 2, v223
    v_bfe_u32 v224, v220, 2, 1
    v_lshl_or_b32 v223, v224, 1, v223
    s_lshl_b32 s64, s16, 5
    buffer_store_dword v204, v5, s[4:7], s78 offen sc1
    v_mfma_f32_32x32x16_bf16 v[60:75], v[128:131], a[20:23], v[60:75]
    ds_read_b128 v[124:127], v38 offset:16384
    buffer_load_dwordx4 a[52:55], v4, s[4:7], s61 offen offset:1024 sc1
    v_add_u32 v225, s64, v221
    v_lshlrev_b32 v225, 7, v225
    v_lshl_add_u32 v225, v223, 4, v225
    s_waitcnt vmcnt(12) lgkmcnt(3)
    v_mfma_f32_32x32x16_bf16 v[44:59], v[108:111], a[24:27], v[44:59]
    ds_read_b128 v[128:131], v38 offset:17408
    s_add_u32 m0, s32, 114688
    s_add_u32 s60, s37, 49152
    buffer_load_dwordx4 v1, s[4:7], s60 offen offset:0 sc1 lds
    v_lshl_add_u32 v225, v222, 14, v225
    v_add_u32 v144, 114688, v225
    v_mfma_f32_32x32x16_bf16 v[60:75], v[112:115], a[24:27], v[60:75]
    ds_read_b128 v[108:111], v38 offset:18432
    buffer_load_dwordx4 v1, s[4:7], s60 offen offset:1024 sc1 lds
    v_bfe_u32 v223, v220, 2, 2
    v_and_b32 v224, 1, v223
    v_lshrrev_b32 v225, 1, v223
    s_waitcnt vmcnt(13) lgkmcnt(3)
    v_mfma_f32_32x32x16_bf16 v[44:59], v[116:119], a[28:31], v[44:59]
    ds_read_b128 v[112:115], v38 offset:19456
    buffer_load_dwordx4 a[56:59], v4, s[4:7], s61 offen offset:2048 sc1
    v_lshl_or_b32 v224, v225, 2, v224
    v_lshl_add_u32 v223, v222, 3, v223
    s_lshr_b32 s64, s16, 1
    s_lshl_b32 s64, s64, 14
    v_mfma_f32_32x32x16_bf16 v[60:75], v[120:123], a[28:31], v[60:75]
    ds_read_b128 v[116:119], v38 offset:20480
    buffer_load_dwordx4 a[60:63], v4, s[4:7], s61 offen offset:3072 sc1
    s_add_u32 s64, s64, 114688
    v_lshl_add_u32 v223, v223, 7, s64
    v_bfe_u32 v225, v220, 4, 1
    s_waitcnt vmcnt(12) lgkmcnt(3)
    v_mfma_f32_32x32x16_bf16 v[44:59], v[124:127], a[32:35], v[44:59]
    ds_read_b128 v[120:123], v38 offset:21504
    s_add_u32 s61, s61, 16384
    buffer_load_dwordx4 a[64:67], v1, s[4:7], s61 offen offset:0 sc1
    v_and_b32 v226, 3, v220
    v_lshl_or_b32 v225, v225, 2, v226
    v_lshrrev_b32 v226, 2, v225
    v_mfma_f32_32x32x16_bf16 v[60:75], v[128:131], a[32:35], v[60:75]
    ds_read_b128 v[124:127], v38 offset:22528
    buffer_load_dwordx4 v1, s[4:7], s60 offen offset:2048 sc1 lds
    v_and_b32 v227, 1, v225
    v_lshl_or_b32 v226, v226, 1, v227
    s_waitcnt vmcnt(13) lgkmcnt(3)
    v_mfma_f32_32x32x16_bf16 v[44:59], v[108:111], a[36:39], v[44:59]
    ds_read_b128 v[128:131], v38 offset:23552
    buffer_load_dwordx4 v1, s[4:7], s60 offen offset:3072 sc1 lds
    s_bitcmp1_b32 s16, 0
    s_cselect_b64 s[66:67], -1, 0
    v_cndmask_b32 v226, v226, 4, s[66:67]
    v_xor_b32 v226, v226, v224
    v_mfma_f32_32x32x16_bf16 v[60:75], v[112:115], a[36:39], v[60:75]
    ds_read_b128 v[108:111], v38 offset:24576
    buffer_load_dwordx4 a[68:71], v1, s[4:7], s61 offen offset:1024 sc1
    v_lshl_add_u32 v226, v226, 4, v223
    v_bfe_u32 v227, v225, 1, 1
    v_lshl_add_u32 v145, v227, 3, v226
    s_waitcnt vmcnt(14) lgkmcnt(3)
    v_mfma_f32_32x32x16_bf16 v[44:59], v[116:119], a[40:43], v[44:59]
    ds_read_b128 v[112:115], v38 offset:25600
    buffer_load_dwordx4 a[72:75], v1, s[4:7], s61 offen offset:2048 sc1
    v_add_u32 v146, 512, v145
    v_xor_b32 v146, 32, v146
    v_min_u32 v225, 5, v225
    v_lshrrev_b32 v226, 1, v225
    v_mfma_f32_32x32x16_bf16 v[60:75], v[120:123], a[40:43], v[60:75]
    ds_read_b128 v[116:119], v38 offset:26624
    buffer_load_dwordx4 a[76:79], v1, s[4:7], s61 offen offset:3072 sc1
    v_add_u32 v226, 5, v226
    v_xor_b32 v226, v226, v224
    v_lshl_add_u32 v226, v226, 4, v223
    s_waitcnt vmcnt(13) lgkmcnt(3)
    v_mfma_f32_32x32x16_bf16 v[44:59], v[124:127], a[44:47], v[44:59]
    ds_read_b128 v[120:123], v38 offset:27648
    s_add_u32 m0, s32, 131072
    s_add_u32 s60, s37, 65536
    buffer_load_dwordx4 v1, s[4:7], s60 offen offset:0 sc1 lds
    v_and_b32 v227, 1, v225
    v_lshl_add_u32 v147, v227, 3, v226
    v_mfma_f32_32x32x16_bf16 v[60:75], v[128:131], a[44:47], v[60:75]
    ds_read_b128 v[124:127], v38 offset:28672
    buffer_load_dwordx4 v1, s[4:7], s60 offen offset:1024 sc1 lds
    v_add_u32 v148, 512, v147
    v_xor_b32 v148, 32, v148
    v_cndmask_b32 v223, v222, 4, s[66:67]
    s_waitcnt vmcnt(14) lgkmcnt(3)
    v_mfma_f32_32x32x16_bf16 v[44:59], v[108:111], a[48:51], v[44:59]
    ds_read_b128 v[128:131], v38 offset:29696
    buffer_load_dwordx4 a[80:83], v2, s[4:7], s61 offen offset:0 sc1
    s_lshr_b32 s64, s16, 1
    s_mul_i32 s64, s64, 5
    v_add_u32 v223, s64, v223
    v_mad_u32_u24 v223, v223, 21, v221
    v_mfma_f32_32x32x16_bf16 v[60:75], v[112:115], a[48:51], v[60:75]
    ds_read_b128 v[108:111], v38 offset:30720
    buffer_load_dwordx4 a[84:87], v2, s[4:7], s61 offen offset:1024 sc1
    v_lshlrev_b32 v223, 4, v223
    s_barrier
    s_waitcnt vmcnt(14) lgkmcnt(3)
    v_mfma_f32_32x32x16_bf16 v[44:59], v[116:119], a[52:55], v[44:59]
    ds_read_b128 v[112:115], v38 offset:31744
    buffer_load_dwordx4 a[88:91], v2, s[4:7], s61 offen offset:2048 sc1
    v_mov_b32 v227, 0x40000000
    v_cmp_gt_u32 vcc, 21, v221
    s_nop 1
    v_cndmask_b32 v223, v227, v223, vcc
    v_mfma_f32_32x32x16_bf16 v[60:75], v[120:123], a[52:55], v[60:75]
    ds_read_b128 v[116:119], v38 offset:32768
    buffer_load_dwordx4 v1, s[4:7], s60 offen offset:2048 sc1 lds
    v_add_u32 v224, 672, v223
    v_cndmask_b32 v150, v224, v227, s[66:67]
    s_and_b64 s[66:67], s[66:67], s[26:27]
    s_waitcnt vmcnt(13) lgkmcnt(3)
    v_mfma_f32_32x32x16_bf16 v[44:59], v[124:127], a[56:59], v[44:59]
    ds_read_b128 v[120:123], v38 offset:33792
    buffer_load_dwordx4 v1, s[4:7], s60 offen offset:3072 sc1 lds
    v_cndmask_b32 v149, v223, v227, s[66:67]
    v_lshlrev_b32 v223, 4, v0
    v_cmp_gt_u32 vcc, 0xd2, v0
    s_nop 1
    v_cndmask_b32 v151, v227, v223, vcc
    v_mfma_f32_32x32x16_bf16 v[60:75], v[128:131], a[56:59], v[60:75]
    ds_read_b128 v[124:127], v38 offset:34816
    buffer_load_dwordx4 a[92:95], v2, s[4:7], s61 offen offset:3072 sc1
    v_mul_u32_u24 v224, 3121, v0
    v_lshrrev_b32 v224, 16, v224
    v_mul_u32_u24 v225, 21, v224
    s_waitcnt vmcnt(14) lgkmcnt(3)
    v_mfma_f32_32x32x16_bf16 v[44:59], v[108:111], a[60:63], v[44:59]
    ds_read_b128 v[128:131], v38 offset:35840
    buffer_load_dwordx4 a[96:99], v3, s[4:7], s61 offen offset:0 sc1
    v_sub_u32 v225, v0, v225
    v_mad_u32_u24 v225, v225, 5, v224
    v_cmp_lt_u32 s[66:67], 4, v224
    v_add_u32 v226, 100, v225
    v_mfma_f32_32x32x16_bf16 v[60:75], v[112:115], a[60:63], v[60:75]
    ds_read_b128 v[108:111], v38 offset:36864
    buffer_load_dwordx4 a[100:103], v3, s[4:7], s61 offen offset:1024 sc1
    v_cndmask_b32 v225, v225, v226, s[66:67]
    v_lshlrev_b32 v225, 4, v225
    v_cndmask_b32 v152, v223, v225, vcc
    s_waitcnt vmcnt(15) lgkmcnt(3)
    v_mfma_f32_32x32x16_bf16 v[44:59], v[116:119], a[64:67], v[44:59]
    ds_read_b128 v[112:115], v38 offset:37888
    s_add_u32 m0, s32, 147456
    s_add_u32 s60, s37, 81920
    buffer_load_dwordx4 v1, s[4:7], s60 offen offset:0 sc1 lds
    v_lshrrev_b32 v223, 3, v221
    v_and_b32 v224, 3, v221
    v_mfma_f32_32x32x16_bf16 v[60:75], v[120:123], a[64:67], v[60:75]
    ds_read_b128 v[116:119], v38 offset:38912
    buffer_load_dwordx4 v1, s[4:7], s60 offen offset:1024 sc1 lds
    v_lshl_or_b32 v223, v223, 2, v224
    v_mad_u32_u24 v224, v222, 21, v223
    v_mul_u32_u24 v224, 80, v224
    s_waitcnt vmcnt(14) lgkmcnt(3)
    v_mfma_f32_32x32x16_bf16 v[44:59], v[124:127], a[68:71], v[44:59]
    ds_read_b128 v[120:123], v38 offset:39936
    buffer_load_dwordx4 a[104:107], v3, s[4:7], s61 offen offset:2048 sc1
    v_bfe_u32 v225, v221, 2, 1
    v_mov_b32 v226, 3360
    v_cmp_eq_u32 vcc, v225, v222
    s_nop 1
    v_cndmask_b32 v153, v226, v224, vcc
    v_mfma_f32_32x32x16_bf16 v[60:75], v[128:131], a[68:71], v[60:75]
    ds_read_b128 v[124:127], v38 offset:40960
    buffer_load_dwordx4 a[108:111], v3, s[4:7], s61 offen offset:3072 sc1
    v_add_u32 v224, 1280, v153
    v_cndmask_b32 v224, v226, v224, vcc
    v_cmp_gt_u32 vcc, 5, v223
    s_waitcnt vmcnt(15) lgkmcnt(3)
    v_mfma_f32_32x32x16_bf16 v[44:59], v[108:111], a[72:75], v[44:59]
    ds_read_b128 v[128:131], v38 offset:41984
    buffer_load_dwordx4 a[112:115], v4, s[4:7], s61 offen offset:0 sc1
    v_cndmask_b32 v154, v226, v224, vcc
    v_bfe_u32 v223, v220, 4, 1
    v_mul_u32_u24 v223, 20480, v223
    v_and_b32 v224, 15, v220
    v_mfma_f32_32x32x16_bf16 v[60:75], v[112:115], a[72:75], v[60:75]
    ds_read_b128 v[108:111], v38 offset:43008
    buffer_load_dwordx4 v1, s[4:7], s60 offen offset:2048 sc1 lds
    v_lshl_add_u32 v223, v224, 4, v223
    v_lshl_add_u32 v155, v222, 8, v223
    v_lshl_add_u32 v156, v222, 3, v223
    s_waitcnt vmcnt(16) lgkmcnt(3)
    v_mfma_f32_32x32x16_bf16 v[44:59], v[116:119], a[76:79], v[44:59]
    ds_read_b128 v[112:115], v38 offset:44032
    buffer_load_dwordx4 v1, s[4:7], s60 offen offset:3072 sc1 lds
    v_cmp_gt_u32 vcc, 24, v221
    s_nop 1
    v_cndmask_b32 v158, v227, v1, vcc
    v_mfma_f32_32x32x16_bf16 v[60:75], v[120:123], a[76:79], v[60:75]
    ds_read_b128 v[116:119], v38 offset:45056
    buffer_load_dwordx4 a[116:119], v4, s[4:7], s61 offen offset:1024 sc1
    s_cmp_lt_u32 s16, 2
    s_cselect_b64 vcc, -1, 0
    v_cndmask_b32 v157, v158, v1, vcc
    s_waitcnt vmcnt(15) lgkmcnt(3)
    v_mfma_f32_32x32x16_bf16 v[44:59], v[124:127], a[80:83], v[44:59]
    ds_read_b128 v[120:123], v38 offset:46080
    buffer_load_dwordx4 a[120:123], v4, s[4:7], s61 offen offset:2048 sc1
    v_mfma_f32_32x32x16_bf16 v[60:75], v[128:131], a[80:83], v[60:75]
    ds_read_b128 v[124:127], v38 offset:47104
    buffer_load_dwordx4 a[124:127], v4, s[4:7], s61 offen offset:3072 sc1
    s_barrier
    s_waitcnt vmcnt(16) lgkmcnt(3)
    v_mfma_f32_32x32x16_bf16 v[44:59], v[108:111], a[84:87], v[44:59]
    ds_read_b128 v[128:131], v38 offset:48128
    buffer_load_dwordx4 v[160:163], v205, s[4:7], s76 offen offset:0 sc1
    v_mfma_f32_32x32x16_bf16 v[60:75], v[112:115], a[84:87], v[60:75]
    ds_read_b128 v[108:111], v38 offset:49152
    buffer_load_dwordx4 v[164:167], v205, s[4:7], s76 offen offset:1024 sc1
    s_waitcnt vmcnt(17) lgkmcnt(3)
    v_mfma_f32_32x32x16_bf16 v[44:59], v[116:119], a[88:91], v[44:59]
    ds_read_b128 v[112:115], v38 offset:50176
    s_add_u32 s61, s61, 16384
    buffer_load_dwordx4 a[128:131], v1, s[4:7], s61 offen offset:0 sc1
    v_mfma_f32_32x32x16_bf16 v[60:75], v[120:123], a[88:91], v[60:75]
    ds_read_b128 v[116:119], v38 offset:51200
    buffer_load_dwordx4 a[132:135], v1, s[4:7], s61 offen offset:1024 sc1
    s_waitcnt vmcnt(16) lgkmcnt(3)
    v_mfma_f32_32x32x16_bf16 v[44:59], v[124:127], a[92:95], v[44:59]
    ds_read_b128 v[120:123], v38 offset:52224
    buffer_load_dwordx4 v[212:215], v10, s[4:7], s62 offen offset:0 sc1
    buffer_load_dwordx4 v[216:219], v10, s[4:7], s62 offen offset:512 sc1
    v_mfma_f32_32x32x16_bf16 v[60:75], v[128:131], a[92:95], v[60:75]
    ds_read_b128 v[124:127], v38 offset:53248
    buffer_load_dwordx4 v[168:171], v205, s[4:7], s76 offen offset:2048 sc1
    s_waitcnt vmcnt(18) lgkmcnt(3)
    v_mfma_f32_32x32x16_bf16 v[44:59], v[108:111], a[96:99], v[44:59]
    ds_read_b128 v[128:131], v38 offset:54272
    buffer_load_dwordx4 v[172:175], v205, s[4:7], s76 offen offset:3072 sc1
    v_mfma_f32_32x32x16_bf16 v[60:75], v[112:115], a[96:99], v[60:75]
    ds_read_b128 v[108:111], v38 offset:55296
    buffer_load_dwordx4 a[136:139], v1, s[4:7], s61 offen offset:2048 sc1
    s_waitcnt vmcnt(19) lgkmcnt(3)
    v_mfma_f32_32x32x16_bf16 v[44:59], v[116:119], a[100:103], v[44:59]
    ds_read_b128 v[112:115], v38 offset:56320
    buffer_load_dwordx4 a[140:143], v1, s[4:7], s61 offen offset:3072 sc1
    v_mfma_f32_32x32x16_bf16 v[60:75], v[120:123], a[100:103], v[60:75]
    ds_read_b128 v[116:119], v38 offset:57344
    buffer_load_dwordx4 a[144:147], v2, s[4:7], s61 offen offset:0 sc1
    s_waitcnt vmcnt(18) lgkmcnt(3)
    v_mfma_f32_32x32x16_bf16 v[44:59], v[124:127], a[104:107], v[44:59]
    ds_read_b128 v[120:123], v38 offset:58368
    buffer_load_dwordx4 a[148:151], v2, s[4:7], s61 offen offset:1024 sc1
    v_mfma_f32_32x32x16_bf16 v[60:75], v[128:131], a[104:107], v[60:75]
    ds_read_b128 v[124:127], v38 offset:59392
    buffer_load_dwordx4 a[152:155], v2, s[4:7], s61 offen offset:2048 sc1
    s_waitcnt vmcnt(19) lgkmcnt(3)
    v_mfma_f32_32x32x16_bf16 v[44:59], v[108:111], a[108:111], v[44:59]
    ds_read_b128 v[128:131], v38 offset:60416
    buffer_load_dwordx4 a[156:159], v2, s[4:7], s61 offen offset:3072 sc1
    s_waitcnt vmcnt(9)
    v_add_f32 v212, v212, v213
    v_add_f32 v213, v214, v215
    s_waitcnt vmcnt(8)
    v_add_f32 v216, v216, v217
    v_mfma_f32_32x32x16_bf16 v[60:75], v[112:115], a[108:111], v[60:75]
    ds_read_b128 v[108:111], v38 offset:61440
    buffer_load_dwordx4 v[176:179], v1, s[4:7], s77 offen sc1
    v_add_f32 v217, v218, v219
    v_add_f32 v212, v212, v216
    v_add_f32 v213, v213, v217
    s_waitcnt lgkmcnt(3)
    v_mfma_f32_32x32x16_bf16 v[44:59], v[116:119], a[112:115], v[44:59]
    ds_read_b128 v[112:115], v38 offset:62464
    s_add_u32 s70, s48, 23785472
    buffer_store_dwordx4 v[228:231], v151, s[4:7], s70 offen sc1
    v_mov_b32 v214, v212
    v_mov_b32 v215, v213
    v_mov_b32 v134, 0
    v_add_f32 v160, v160, v161
    v_mfma_f32_32x32x16_bf16 v[60:75], v[120:123], a[112:115], v[60:75]
    ds_read_b128 v[116:119], v38 offset:63488
    s_add_u32 m0, s32, 0
    s_add_u32 s60, s37, 98304
    buffer_load_dwordx4 v1, s[4:7], s60 offen offset:0 sc1 lds
    s_barrier
    s_waitcnt lgkmcnt(3)
    v_mfma_f32_32x32x16_bf16 v[44:59], v[124:127], a[116:119], v[44:59]
    ds_read_b128 v[120:123], v38 offset:64512
    buffer_load_dwordx4 v1, s[4:7], s60 offen offset:1024 sc1 lds
    v_permlane32_swap_b32 v212, v214
    v_permlane32_swap_b32 v213, v215
    v_add_f32 v212, v212, v214
    v_add_f32 v213, v213, v215
    v_add_f32 v162, v162, v163
    v_mfma_f32_32x32x16_bf16 v[60:75], v[128:131], a[116:119], v[60:75]
    ds_read_b128 v[124:127], v39 offset:0
    buffer_load_dwordx4 v1, s[4:7], s60 offen offset:2048 sc1 lds
    v_mul_f32 v212, 0x3acccccd, v212
    v_mul_f32 v213, 0x3acccccd, v213
    v_fma_f32 v213, -v212, v212, v213
    v_add_f32 v160, v160, v162
    s_waitcnt lgkmcnt(3)
    v_mfma_f32_32x32x16_bf16 v[44:59], v[108:111], a[120:123], v[44:59]
    ds_read_b128 v[128:131], v39 offset:1024
    buffer_load_dwordx4 v1, s[4:7], s60 offen offset:3072 sc1 lds
    v_max_f32 v213, 0, v213
    v_add_f32 v138, 0x3727c5ac, v213
    v_rsq_f32 v136, v138
    v_mov_b32 v161, v160
    v_mfma_f32_32x32x16_bf16 v[60:75], v[112:115], a[120:123], v[60:75]
    ds_read_b128 v[108:111], v39 offset:2048
    s_add_u32 m0, s32, 16384
    s_add_u32 s60, s37, 114688
    buffer_load_dwordx4 v157, s[4:7], s60 offen offset:0 sc1 lds
    v_cvt_pk_bf16_f32 v214, v212, v212
    s_waitcnt lgkmcnt(3)
    v_mfma_f32_32x32x16_bf16 v[44:59], v[116:119], a[124:127], v[44:59]
    ds_read_b128 v[112:115], v39 offset:3072
    buffer_load_dwordx4 v157, s[4:7], s60 offen offset:1024 sc1 lds
    v_lshlrev_b32 v215, 16, v214
    v_sub_f32 v215, v212, v215
    v_cvt_pk_bf16_f32 v214, v212, v215
    v_cndmask_b32 v132, v214, 0, s[26:27]
    v_mfma_f32_32x32x16_bf16 v[60:75], v[120:123], a[124:127], v[60:75]
    ds_read_b128 v[116:119], v39 offset:4096
    buffer_load_dwordx4 v157, s[4:7], s60 offen offset:2048 sc1 lds
    v_and_b32 v133, 0xffff, v132
    v_mov_b32 v135, 0
    v_mul_f32 v137, 0x3fb8aa3b, v136
    s_waitcnt lgkmcnt(3)
    v_mfma_f32_32x32x16_bf16 v[44:59], v[124:127], a[128:131], v[44:59]
    ds_read_b128 v[120:123], v39 offset:5120
    buffer_load_dwordx4 v157, s[4:7], s60 offen offset:3072 sc1 lds
    s_nop 1
    v_permlane32_swap_b32 v160, v161
    v_add_f32 v160, v160, v161
    v_cvt_pk_bf16_f32 v16, -v160, -v160
    v_mfma_f32_32x32x16_bf16 v[60:75], v[128:131], a[128:131], v[60:75]
    ds_read_b128 v[124:127], v39 offset:6144
    v_and_b32 v161, 0xffff0000, v16
    v_sub_f32 v161, -v160, v161
    v_cvt_pk_bf16_f32 v17, v161, 0
    v_add_f32 v164, v164, v165
    v_add_f32 v166, v166, v167
    s_waitcnt lgkmcnt(3)
    v_mfma_f32_32x32x16_bf16 v[44:59], v[108:111], a[132:135], v[44:59]
    ds_read_b128 v[128:131], v39 offset:7168
    v_add_f32 v164, v164, v166
    v_mov_b32 v165, v164
    s_nop 1
    v_permlane32_swap_b32 v164, v165
    v_add_f32 v164, v164, v165
    v_mfma_f32_32x32x16_bf16 v[60:75], v[112:115], a[132:135], v[60:75]
    ds_read_b128 v[108:111], v39 offset:8192
    v_cvt_pk_bf16_f32 v18, -v164, -v164
    v_and_b32 v165, 0xffff0000, v18
    v_sub_f32 v165, -v164, v165
    v_cvt_pk_bf16_f32 v19, v165, 0
    s_waitcnt vmcnt(17)
    v_add_f32 v168, v168, v169
    s_waitcnt vmcnt(15) lgkmcnt(3)
    v_mfma_f32_32x32x16_bf16 v[44:59], v[116:119], a[136:139], v[44:59]
    ds_read_b128 v[112:115], v39 offset:9216
    v_add_f32 v170, v170, v171
    v_add_f32 v168, v168, v170
    v_mov_b32 v169, v168
    s_nop 1
    v_permlane32_swap_b32 v168, v169
    v_mfma_f32_32x32x16_bf16 v[60:75], v[120:123], a[136:139], v[60:75]
    ds_read_b128 v[116:119], v39 offset:10240
    v_add_f32 v168, v168, v169
    v_cvt_pk_bf16_f32 v20, -v168, -v168
    v_and_b32 v169, 0xffff0000, v20
    v_sub_f32 v169, -v168, v169
    v_cvt_pk_bf16_f32 v21, v169, 0
    s_waitcnt vmcnt(14) lgkmcnt(3)
    v_mfma_f32_32x32x16_bf16 v[44:59], v[124:127], a[140:143], v[44:59]
    ds_read_b128 v[120:123], v39 offset:11264
    v_add_f32 v172, v172, v173
    v_add_f32 v174, v174, v175
    v_add_f32 v172, v172, v174
    v_mov_b32 v173, v172
    s_nop 1
    v_permlane32_swap_b32 v172, v173
    v_mfma_f32_32x32x16_bf16 v[60:75], v[128:131], a[140:143], v[60:75]
    ds_read_b128 v[124:127], v39 offset:12288
    v_add_f32 v172, v172, v173
    v_cvt_pk_bf16_f32 v22, -v172, -v172
    v_and_b32 v173, 0xffff0000, v22
    v_sub_f32 v173, -v172, v173
    v_cvt_pk_bf16_f32 v23, v173, 0
    s_waitcnt vmcnt(13) lgkmcnt(3)
    v_mfma_f32_32x32x16_bf16 v[44:59], v[108:111], a[144:147], v[44:59]
    ds_read_b128 v[128:131], v39 offset:13312
    v_mfma_f32_32x32x16_bf16 v[60:75], v[112:115], a[144:147], v[60:75]
    ds_read_b128 v[108:111], v39 offset:14336
    s_barrier
    s_waitcnt vmcnt(12) lgkmcnt(3)
    v_mfma_f32_32x32x16_bf16 v[44:59], v[116:119], a[148:151], v[44:59]
    ds_read_b128 v[112:115], v39 offset:15360
    v_mfma_f32_32x32x16_bf16 v[60:75], v[120:123], a[148:151], v[60:75]
    ds_read_b128 v[116:119], v39 offset:16384
    s_waitcnt vmcnt(11) lgkmcnt(3)
    v_mfma_f32_32x32x16_bf16 v[44:59], v[124:127], a[152:155], v[44:59]
    ds_read_b128 v[120:123], v39 offset:17408
    v_mfma_f32_32x32x16_bf16 v[60:75], v[128:131], a[152:155], v[60:75]
    ds_read_b128 v[124:127], v39 offset:18432
    s_waitcnt vmcnt(10) lgkmcnt(3)
    v_mfma_f32_32x32x16_bf16 v[44:59], v[108:111], a[156:159], v[44:59]
    ds_read_b128 v[128:131], v39 offset:19456
    v_mfma_f32_32x32x16_bf16 v[60:75], v[112:115], a[156:159], v[60:75]
    ds_read_b128 v[108:111], v39 offset:20480
    v_mfma_f32_32x32x16_bf16 v[44:59], v[16:19], v[132:135], v[44:59]
    v_mfma_f32_32x32x16_bf16 v[60:75], v[18:21], v[132:135], v[60:75]
    s_waitcnt vmcnt(9)
    v_xor_b32 v176, s56, v176
    v_xor_b32 v177, s56, v177
    v_xor_b32 v178, s56, v178
    v_xor_b32 v179, s56, v179
    v_or3_b32 v180, v176, v177, v178
    v_or_b32 v180, v180, v179
    v_cmp_lt_u32 vcc, 15, v180
    s_nop 0
    s_cbranch_vccz sok_8
    s_mov_b32 s31, 0
sre_7:
    buffer_load_dwordx4 v[176:179], v1, s[4:7], s77 offen sc1
    s_add_u32 s31, s31, 1
    s_waitcnt vmcnt(0)
    v_xor_b32 v176, s56, v176
    v_xor_b32 v177, s56, v177
    v_xor_b32 v178, s56, v178
    v_xor_b32 v179, s56, v179
    v_or3_b32 v180, v176, v177, v178
    v_or_b32 v180, v180, v179
    v_cmp_lt_u32 vcc, 15, v180
    s_nop 0
    s_cbranch_vccz sok_8
    s_sleep 16
    s_cmp_lt_u32 s31, 32768
    s_cbranch_scc1 sre_7
    s_endpgm
sok_8:
    v_xor_b32 v176, s25, v176
    v_xor_b32 v177, s25, v177
    v_xor_b32 v178, s25, v178
    v_xor_b32 v179, s25, v179
    v_or3_b32 v180, v176, v177, v178
    v_or_b32 v180, v180, v179
    v_cmp_ne_u32 vcc, 0, v180
    s_lshl_b32 s70, s17, 3
    s_lshr_b64 s[72:73], vcc, s70
    s_and_b32 s72, s72, 0xff
    s_cselect_b32 s24, 0, 1
    s_mov_b32 s74, 0x40000000
    s_cmp_eq_u32 s2, 0
    s_cselect_b32 s70, 22832128, s74
    buffer_store_dword v206, v5, s[4:7], s70 offen sc1
    s_nop 3
    s_branch interleave_layers__linear_kernel_hedgehog__geglu_ffn__prompt_kernel_passb
interleave_layers__linear_kernel_hedgehog__geglu_ffn__prompt_kernel_layer:
    s_nop 1
    s_waitcnt vmcnt(0)
    s_barrier
    ds_read_b128 v[108:111], v38 offset:0
    ds_read_b128 v[112:115], v38 offset:1024
    ds_read_b128 v[116:119], v38 offset:2048
    ds_read_b128 v[120:123], v38 offset:3072
    ds_read_b128 v[124:127], v38 offset:4096
    s_add_u32 s61, s34, 10362880
    s_add_u32 s62, s35, 12984320
    s_add_u32 s63, s36, 22839296
    s_mov_b32 s31, 0
poll_9:
    buffer_load_dword v212, v7, s[4:7], s63 offen sc1
    s_add_u32 s31, s31, 1
    s_waitcnt vmcnt(0)
    v_cmp_eq_u32 vcc, -1, v212
    s_nop 0
    s_cbranch_vccz pok_10
    s_cmp_lt_u32 s31, 32768
    s_cbranch_scc1 poll_9
    s_endpgm
pok_10:
    s_cmp_lg_u32 s24, 0
    s_cbranch_scc1 pfast_11
    buffer_inv sc1
    s_waitcnt vmcnt(0)
pfast_11:
    buffer_load_dwordx4 a[0:3], v1, s[4:7], s61 offen offset:0 sc1
    buffer_load_dwordx4 a[4:7], v1, s[4:7], s61 offen offset:1024 sc1
    buffer_load_dwordx4 a[8:11], v1, s[4:7], s61 offen offset:2048 sc1
    buffer_load_dwordx4 a[12:15], v1, s[4:7], s61 offen offset:3072 sc1
    buffer_load_dwordx4 a[16:19], v2, s[4:7], s61 offen offset:0 sc1
    buffer_load_dwordx4 a[20:23], v2, s[4:7], s61 offen offset:1024 sc1
    buffer_load_dwordx4 a[24:27], v2, s[4:7], s61 offen offset:2048 sc1
    buffer_load_dwordx4 a[28:31], v2, s[4:7], s61 offen offset:3072 sc1
    s_waitcnt vmcnt(7) lgkmcnt(3)
    v_mfma_f32_32x32x16_bf16 v[44:59], v[108:111], a[0:3], 0
    ds_read_b128 v[128:131], v38 offset:5120
    buffer_load_dwordx4 a[32:35], v3, s[4:7], s61 offen offset:0 sc1
    v_mfma_f32_32x32x16_bf16 v[60:75], v[112:115], a[0:3], 0
    ds_read_b128 v[108:111], v38 offset:6144
    buffer_load_dwordx4 a[36:39], v3, s[4:7], s61 offen offset:1024 sc1
    s_waitcnt vmcnt(8) lgkmcnt(3)
    v_mfma_f32_32x32x16_bf16 v[44:59], v[116:119], a[4:7], v[44:59]
    ds_read_b128 v[112:115], v38 offset:7168
    buffer_load_dwordx4 a[40:43], v3, s[4:7], s61 offen offset:2048 sc1
    v_mfma_f32_32x32x16_bf16 v[60:75], v[120:123], a[4:7], v[60:75]
    ds_read_b128 v[116:119], v38 offset:8192
    buffer_load_dwordx4 a[44:47], v3, s[4:7], s61 offen offset:3072 sc1
    s_waitcnt vmcnt(9) lgkmcnt(3)
    v_mfma_f32_32x32x16_bf16 v[44:59], v[124:127], a[8:11], v[44:59]
    ds_read_b128 v[120:123], v38 offset:9216
    buffer_load_dwordx4 a[48:51], v4, s[4:7], s61 offen offset:0 sc1
    v_mfma_f32_32x32x16_bf16 v[60:75], v[128:131], a[8:11], v[60:75]
    ds_read_b128 v[124:127], v38 offset:10240
    buffer_load_dwordx4 a[52:55], v4, s[4:7], s61 offen offset:1024 sc1
    s_waitcnt vmcnt(10) lgkmcnt(3)
    v_mfma_f32_32x32x16_bf16 v[44:59], v[108:111], a[12:15], v[44:59]
    ds_read_b128 v[128:131], v38 offset:11264
    buffer_load_dwordx4 a[56:59], v4, s[4:7], s61 offen offset:2048 sc1
    v_mfma_f32_32x32x16_bf16 v[60:75], v[112:115], a[12:15], v[60:75]
    ds_read_b128 v[108:111], v38 offset:12288
    buffer_load_dwordx4 a[60:63], v4, s[4:7], s61 offen offset:3072 sc1
    s_waitcnt vmcnt(11) lgkmcnt(3)
    v_mfma_f32_32x32x16_bf16 v[44:59], v[116:119], a[16:19], v[44:59]
    ds_read_b128 v[112:115], v38 offset:13312
    s_add_u32 s61, s61, 16384
    buffer_load_dwordx4 a[64:67], v1, s[4:7], s61 offen offset:0 sc1
    v_and_b32 v220, 63, v0
    v_and_b32 v221, 31, v220
    v_lshrrev_b32 v222, 5, v220
    v_mfma_f32_32x32x16_bf16 v[60:75], v[120:123], a[16:19], v[60:75]
    ds_read_b128 v[116:119], v38 offset:14336
    v_and_b32 v223, 1, v220
    v_bfe_u32 v224, v220, 1, 1
    v_lshl_or_b32 v223, v224, 2, v223
    v_bfe_u32 v224, v220, 2, 1
    s_waitcnt vmcnt(11) lgkmcnt(3)
    v_mfma_f32_32x32x16_bf16 v[44:59], v[124:127], a[20:23], v[44:59]
    ds_read_b128 v[120:123], v38 offset:15360
    buffer_load_dwordx4 a[68:71], v1, s[4:7], s61 offen offset:1024 sc1
    v_lshl_or_b32 v223, v224, 1, v223
    s_lshl_b32 s64, s16, 5
    v_add_u32 v225, s64, v221
    v_lshlrev_b32 v225, 7, v225
    v_mfma_f32_32x32x16_bf16 v[60:75], v[128:131], a[20:23], v[60:75]
    ds_read_b128 v[124:127], v38 offset:16384
    v_lshl_add_u32 v225, v223, 4, v225
    v_lshl_add_u32 v225, v222, 14, v225
    v_add_u32 v144, 114688, v225
    v_bfe_u32 v223, v220, 2, 2
    s_waitcnt vmcnt(11) lgkmcnt(3)
    v_mfma_f32_32x32x16_bf16 v[44:59], v[108:111], a[24:27], v[44:59]
    ds_read_b128 v[128:131], v38 offset:17408
    buffer_load_dwordx4 a[72:75], v1, s[4:7], s61 offen offset:2048 sc1
    v_and_b32 v224, 1, v223
    v_lshrrev_b32 v225, 1, v223
    v_lshl_or_b32 v224, v225, 2, v224
    v_lshl_add_u32 v223, v222, 3, v223
    v_mfma_f32_32x32x16_bf16 v[60:75], v[112:115], a[24:27], v[60:75]
    ds_read_b128 v[108:111], v38 offset:18432
    s_lshr_b32 s64, s16, 1
    s_lshl_b32 s64, s64, 14
    s_add_u32 s64, s64, 114688
    v_lshl_add_u32 v223, v223, 7, s64
    s_waitcnt vmcnt(11) lgkmcnt(3)
    v_mfma_f32_32x32x16_bf16 v[44:59], v[116:119], a[28:31], v[44:59]
    ds_read_b128 v[112:115], v38 offset:19456
    buffer_load_dwordx4 a[76:79], v1, s[4:7], s61 offen offset:3072 sc1
    v_bfe_u32 v225, v220, 4, 1
    v_and_b32 v226, 3, v220
    v_lshl_or_b32 v225, v225, 2, v226
    v_lshrrev_b32 v226, 2, v225
    v_mfma_f32_32x32x16_bf16 v[60:75], v[120:123], a[28:31], v[60:75]
    ds_read_b128 v[116:119], v38 offset:20480
    v_and_b32 v227, 1, v225
    v_lshl_or_b32 v226, v226, 1, v227
    s_bitcmp1_b32 s16, 0
    s_cselect_b64 s[66:67], -1, 0
    s_waitcnt vmcnt(11) lgkmcnt(3)
    v_mfma_f32_32x32x16_bf16 v[44:59], v[124:127], a[32:35], v[44:59]
    ds_read_b128 v[120:123], v38 offset:21504
    buffer_load_dwordx4 a[80:83], v2, s[4:7], s61 offen offset:0 sc1
    v_cndmask_b32 v226, v226, 4, s[66:67]
    v_xor_b32 v226, v226, v224
    v_lshl_add_u32 v226, v226, 4, v223
    v_bfe_u32 v227, v225, 1, 1
    v_mfma_f32_32x32x16_bf16 v[60:75], v[128:131], a[32:35], v[60:75]
    ds_read_b128 v[124:127], v38 offset:22528
    v_lshl_add_u32 v145, v227, 3, v226
    v_add_u32 v146, 512, v145
    v_xor_b32 v146, 32, v146
    v_min_u32 v225, 5, v225
    s_waitcnt vmcnt(11) lgkmcnt(3)
    v_mfma_f32_32x32x16_bf16 v[44:59], v[108:111], a[36:39], v[44:59]
    ds_read_b128 v[128:131], v38 offset:23552
    buffer_load_dwordx4 a[84:87], v2, s[4:7], s61 offen offset:1024 sc1
    v_lshrrev_b32 v226, 1, v225
    v_add_u32 v226, 5, v226
    v_xor_b32 v226, v226, v224
    v_lshl_add_u32 v226, v226, 4, v223
    v_mfma_f32_32x32x16_bf16 v[60:75], v[112:115], a[36:39], v[60:75]
    ds_read_b128 v[108:111], v38 offset:24576
    v_and_b32 v227, 1, v225
    v_lshl_add_u32 v147, v227, 3, v226
    v_add_u32 v148, 512, v147
    v_xor_b32 v148, 32, v148
    s_waitcnt vmcnt(11) lgkmcnt(3)
    v_mfma_f32_32x32x16_bf16 v[44:59], v[116:119], a[40:43], v[44:59]
    ds_read_b128 v[112:115], v38 offset:25600
    buffer_load_dwordx4 a[88:91], v2, s[4:7], s61 offen offset:2048 sc1
    v_cndmask_b32 v223, v222, 4, s[66:67]
    s_lshr_b32 s64, s16, 1
    s_mul_i32 s64, s64, 5
    v_add_u32 v223, s64, v223
    v_mfma_f32_32x32x16_bf16 v[60:75], v[120:123], a[40:43], v[60:75]
    ds_read_b128 v[116:119], v38 offset:26624
    v_mad_u32_u24 v223, v223, 21, v221
    v_lshlrev_b32 v223, 4, v223
    v_mov_b32 v227, 0x40000000
    v_cmp_gt_u32 vcc, 21, v221
    s_waitcnt vmcnt(11) lgkmcnt(3)
    v_mfma_f32_32x32x16_bf16 v[44:59], v[124:127], a[44:47], v[44:59]
    ds_read_b128 v[120:123], v38 offset:27648
    buffer_load_dwordx4 a[92:95], v2, s[4:7], s61 offen offset:3072 sc1
    v_cndmask_b32 v223, v227, v223, vcc
    v_add_u32 v224, 672, v223
    v_cndmask_b32 v150, v224, v227, s[66:67]
    s_and_b64 s[66:67], s[66:67], s[26:27]
    v_mfma_f32_32x32x16_bf16 v[60:75], v[128:131], a[44:47], v[60:75]
    ds_read_b128 v[124:127], v38 offset:28672
    v_cndmask_b32 v149, v223, v227, s[66:67]
    v_lshlrev_b32 v223, 4, v0
    v_cmp_gt_u32 vcc, 0xd2, v0
    s_nop 1
    v_cndmask_b32 v151, v227, v223, vcc
    s_waitcnt vmcnt(11) lgkmcnt(3)
    v_mfma_f32_32x32x16_bf16 v[44:59], v[108:111], a[48:51], v[44:59]
    ds_read_b128 v[128:131], v38 offset:29696
    buffer_load_dwordx4 a[96:99], v3, s[4:7], s61 offen offset:0 sc1
    v_mul_u32_u24 v224, 3121, v0
    v_lshrrev_b32 v224, 16, v224
    v_mul_u32_u24 v225, 21, v224
    v_sub_u32 v225, v0, v225
    v_mfma_f32_32x32x16_bf16 v[60:75], v[112:115], a[48:51], v[60:75]
    ds_read_b128 v[108:111], v38 offset:30720
    v_mad_u32_u24 v225, v225, 5, v224
    v_cmp_lt_u32 s[66:67], 4, v224
    v_add_u32 v226, 100, v225
    s_nop 0
    v_cndmask_b32 v225, v225, v226, s[66:67]
    s_waitcnt vmcnt(11) lgkmcnt(3)
    v_mfma_f32_32x32x16_bf16 v[44:59], v[116:119], a[52:55], v[44:59]
    ds_read_b128 v[112:115], v38 offset:31744
    buffer_load_dwordx4 a[100:103], v3, s[4:7], s61 offen offset:1024 sc1
    v_lshlrev_b32 v225, 4, v225
    v_cndmask_b32 v152, v223, v225, vcc
    v_lshrrev_b32 v223, 3, v221
    v_and_b32 v224, 3, v221
    v_mfma_f32_32x32x16_bf16 v[60:75], v[120:123], a[52:55], v[60:75]
    ds_read_b128 v[116:119], v38 offset:32768
    v_lshl_or_b32 v223, v223, 2, v224
    v_mad_u32_u24 v224, v222, 21, v223
    v_mul_u32_u24 v224, 80, v224
    v_bfe_u32 v225, v221, 2, 1
    s_waitcnt vmcnt(11) lgkmcnt(3)
    v_mfma_f32_32x32x16_bf16 v[44:59], v[124:127], a[56:59], v[44:59]
    ds_read_b128 v[120:123], v38 offset:33792
    buffer_load_dwordx4 a[104:107], v3, s[4:7], s61 offen offset:2048 sc1
    v_mov_b32 v226, 3360
    v_cmp_eq_u32 vcc, v225, v222
    s_nop 1
    v_cndmask_b32 v153, v226, v224, vcc
    v_mfma_f32_32x32x16_bf16 v[60:75], v[128:131], a[56:59], v[60:75]
    ds_read_b128 v[124:127], v38 offset:34816
    v_add_u32 v224, 1280, v153
    v_cndmask_b32 v224, v226, v224, vcc
    v_cmp_gt_u32 vcc, 5, v223
    s_nop 1
    v_cndmask_b32 v154, v226, v224, vcc
    s_waitcnt vmcnt(11) lgkmcnt(3)
    v_mfma_f32_32x32x16_bf16 v[44:59], v[108:111], a[60:63], v[44:59]
    ds_read_b128 v[128:131], v38 offset:35840
    buffer_load_dwordx4 a[108:111], v3, s[4:7], s61 offen offset:3072 sc1
    v_bfe_u32 v223, v220, 4, 1
    v_mul_u32_u24 v223, 20480, v223
    v_and_b32 v224, 15, v220
    v_lshl_add_u32 v223, v224, 4, v223
    v_mfma_f32_32x32x16_bf16 v[60:75], v[112:115], a[60:63], v[60:75]
    ds_read_b128 v[108:111], v38 offset:36864
    v_lshl_add_u32 v155, v222, 8, v223
    v_lshl_add_u32 v156, v222, 3, v223
    v_cmp_gt_u32 vcc, 24, v221
    s_nop 1
    v_cndmask_b32 v158, v227, v1, vcc
    s_waitcnt vmcnt(11) lgkmcnt(3)
    v_mfma_f32_32x32x16_bf16 v[44:59], v[116:119], a[64:67], v[44:59]
    ds_read_b128 v[112:115], v38 offset:37888
    buffer_load_dwordx4 a[112:115], v4, s[4:7], s61 offen offset:0 sc1
    s_cmp_lt_u32 s16, 2
    s_cselect_b64 vcc, -1, 0
    v_cndmask_b32 v157, v158, v1, vcc
    v_mfma_f32_32x32x16_bf16 v[60:75], v[120:123], a[64:67], v[60:75]
    ds_read_b128 v[116:119], v38 offset:38912
    s_waitcnt vmcnt(11) lgkmcnt(3)
    v_mfma_f32_32x32x16_bf16 v[44:59], v[124:127], a[68:71], v[44:59]
    ds_read_b128 v[120:123], v38 offset:39936
    buffer_load_dwordx4 a[116:119], v4, s[4:7], s61 offen offset:1024 sc1
    v_mfma_f32_32x32x16_bf16 v[60:75], v[128:131], a[68:71], v[60:75]
    ds_read_b128 v[124:127], v38 offset:40960
    s_waitcnt vmcnt(11) lgkmcnt(3)
    v_mfma_f32_32x32x16_bf16 v[44:59], v[108:111], a[72:75], v[44:59]
    ds_read_b128 v[128:131], v38 offset:41984
    buffer_load_dwordx4 a[120:123], v4, s[4:7], s61 offen offset:2048 sc1
    v_mfma_f32_32x32x16_bf16 v[60:75], v[112:115], a[72:75], v[60:75]
    ds_read_b128 v[108:111], v38 offset:43008
    s_waitcnt vmcnt(11) lgkmcnt(3)
    v_mfma_f32_32x32x16_bf16 v[44:59], v[116:119], a[76:79], v[44:59]
    ds_read_b128 v[112:115], v38 offset:44032
    buffer_load_dwordx4 a[124:127], v4, s[4:7], s61 offen offset:3072 sc1
    v_mfma_f32_32x32x16_bf16 v[60:75], v[120:123], a[76:79], v[60:75]
    ds_read_b128 v[116:119], v38 offset:45056
    s_waitcnt vmcnt(11) lgkmcnt(3)
    v_mfma_f32_32x32x16_bf16 v[44:59], v[124:127], a[80:83], v[44:59]
    ds_read_b128 v[120:123], v38 offset:46080
    s_add_u32 s61, s61, 16384
    buffer_load_dwordx4 a[128:131], v1, s[4:7], s61 offen offset:0 sc1
    v_mfma_f32_32x32x16_bf16 v[60:75], v[128:131], a[80:83], v[60:75]
    ds_read_b128 v[124:127], v38 offset:47104
    s_waitcnt vmcnt(11) lgkmcnt(3)
    v_mfma_f32_32x32x16_bf16 v[44:59], v[108:111], a[84:87], v[44:59]
    ds_read_b128 v[128:131], v38 offset:48128
    buffer_load_dwordx4 a[132:135], v1, s[4:7], s61 offen offset:1024 sc1
    v_mfma_f32_32x32x16_bf16 v[60:75], v[112:115], a[84:87], v[60:75]
    ds_read_b128 v[108:111], v38 offset:49152
    s_waitcnt vmcnt(11) lgkmcnt(3)
    v_mfma_f32_32x32x16_bf16 v[44:59], v[116:119], a[88:91], v[44:59]
    ds_read_b128 v[112:115], v38 offset:50176
    buffer_load_dwordx4 v[212:215], v10, s[4:7], s62 offen offset:0 sc1
    buffer_load_dwordx4 v[216:219], v10, s[4:7], s62 offen offset:512 sc1
    v_mfma_f32_32x32x16_bf16 v[60:75], v[120:123], a[88:91], v[60:75]
    ds_read_b128 v[116:119], v38 offset:51200
    s_waitcnt vmcnt(12) lgkmcnt(3)
    v_mfma_f32_32x32x16_bf16 v[44:59], v[124:127], a[92:95], v[44:59]
    ds_read_b128 v[120:123], v38 offset:52224
    buffer_load_dwordx4 a[136:139], v1, s[4:7], s61 offen offset:2048 sc1
    v_mfma_f32_32x32x16_bf16 v[60:75], v[128:131], a[92:95], v[60:75]
    ds_read_b128 v[124:127], v38 offset:53248
    s_waitcnt vmcnt(12) lgkmcnt(3)
    v_mfma_f32_32x32x16_bf16 v[44:59], v[108:111], a[96:99], v[44:59]
    ds_read_b128 v[128:131], v38 offset:54272
    buffer_load_dwordx4 a[140:143], v1, s[4:7], s61 offen offset:3072 sc1
    v_mfma_f32_32x32x16_bf16 v[60:75], v[112:115], a[96:99], v[60:75]
    ds_read_b128 v[108:111], v38 offset:55296
    s_waitcnt vmcnt(12) lgkmcnt(3)
    v_mfma_f32_32x32x16_bf16 v[44:59], v[116:119], a[100:103], v[44:59]
    ds_read_b128 v[112:115], v38 offset:56320
    buffer_load_dwordx4 a[144:147], v2, s[4:7], s61 offen offset:0 sc1
    v_mfma_f32_32x32x16_bf16 v[60:75], v[120:123], a[100:103], v[60:75]
    ds_read_b128 v[116:119], v38 offset:57344
    s_waitcnt vmcnt(12) lgkmcnt(3)
    v_mfma_f32_32x32x16_bf16 v[44:59], v[124:127], a[104:107], v[44:59]
    ds_read_b128 v[120:123], v38 offset:58368
    buffer_load_dwordx4 a[148:151], v2, s[4:7], s61 offen offset:1024 sc1
    v_mfma_f32_32x32x16_bf16 v[60:75], v[128:131], a[104:107], v[60:75]
    ds_read_b128 v[124:127], v38 offset:59392
    s_waitcnt vmcnt(12) lgkmcnt(3)
    v_mfma_f32_32x32x16_bf16 v[44:59], v[108:111], a[108:111], v[44:59]
    ds_read_b128 v[128:131], v38 offset:60416
    buffer_load_dwordx4 a[152:155], v2, s[4:7], s61 offen offset:2048 sc1
    v_mfma_f32_32x32x16_bf16 v[60:75], v[112:115], a[108:111], v[60:75]
    ds_read_b128 v[108:111], v38 offset:61440
    s_waitcnt vmcnt(12) lgkmcnt(3)
    v_mfma_f32_32x32x16_bf16 v[44:59], v[116:119], a[112:115], v[44:59]
    ds_read_b128 v[112:115], v38 offset:62464
    buffer_load_dwordx4 a[156:159], v2, s[4:7], s61 offen offset:3072 sc1
    v_mfma_f32_32x32x16_bf16 v[60:75], v[120:123], a[112:115], v[60:75]
    ds_read_b128 v[116:119], v38 offset:63488
    s_waitcnt vmcnt(12) lgkmcnt(3)
    v_mfma_f32_32x32x16_bf16 v[44:59], v[124:127], a[116:119], v[44:59]
    ds_read_b128 v[120:123], v38 offset:64512
    s_add_u32 m0, s32, 0
    s_add_u32 s60, s37, 98304
    buffer_load_dwordx4 v1, s[4:7], s60 offen offset:0 sc1 lds
    v_mfma_f32_32x32x16_bf16 v[60:75], v[128:131], a[116:119], v[60:75]
    ds_read_b128 v[124:127], v39 offset:0
    s_waitcnt vmcnt(12) lgkmcnt(3)
    v_mfma_f32_32x32x16_bf16 v[44:59], v[108:111], a[120:123], v[44:59]
    ds_read_b128 v[128:131], v39 offset:1024
    buffer_load_dwordx4 v1, s[4:7], s60 offen offset:1024 sc1 lds
    v_mfma_f32_32x32x16_bf16 v[60:75], v[112:115], a[120:123], v[60:75]
    ds_read_b128 v[108:111], v39 offset:2048
    s_waitcnt vmcnt(12) lgkmcnt(3)
    v_mfma_f32_32x32x16_bf16 v[44:59], v[116:119], a[124:127], v[44:59]
    ds_read_b128 v[112:115], v39 offset:3072
    buffer_load_dwordx4 v1, s[4:7], s60 offen offset:2048 sc1 lds
    v_mfma_f32_32x32x16_bf16 v[60:75], v[120:123], a[124:127], v[60:75]
    ds_read_b128 v[116:119], v39 offset:4096
    s_waitcnt vmcnt(12) lgkmcnt(3)
    v_mfma_f32_32x32x16_bf16 v[44:59], v[124:127], a[128:131], v[44:59]
    ds_read_b128 v[120:123], v39 offset:5120
    buffer_load_dwordx4 v1, s[4:7], s60 offen offset:3072 sc1 lds
    s_waitcnt vmcnt(11)
    v_add_f32 v212, v212, v213
    v_add_f32 v213, v214, v215
    s_waitcnt vmcnt(10)
    v_add_f32 v216, v216, v217
    v_mfma_f32_32x32x16_bf16 v[60:75], v[128:131], a[128:131], v[60:75]
    ds_read_b128 v[124:127], v39 offset:6144
    v_add_f32 v217, v218, v219
    v_add_f32 v212, v212, v216
    v_add_f32 v213, v213, v217
    v_mov_b32 v214, v212
    s_waitcnt lgkmcnt(3)
    v_mfma_f32_32x32x16_bf16 v[44:59], v[108:111], a[132:135], v[44:59]
    ds_read_b128 v[128:131], v39 offset:7168
    s_add_u32 m0, s32, 16384
    s_add_u32 s60, s37, 114688
    buffer_load_dwordx4 v157, s[4:7], s60 offen offset:0 sc1 lds
    v_mov_b32 v215, v213
    v_mov_b32 v134, 0
    v_mfma_f32_32x32x16_bf16 v[60:75], v[112:115], a[132:135], v[60:75]
    ds_read_b128 v[108:111], v39 offset:8192
    v_permlane32_swap_b32 v212, v214
    v_permlane32_swap_b32 v213, v215
    v_add_f32 v212, v212, v214
    v_add_f32 v213, v213, v215
    s_waitcnt vmcnt(10) lgkmcnt(3)
    v_mfma_f32_32x32x16_bf16 v[44:59], v[116:119], a[136:139], v[44:59]
    ds_read_b128 v[112:115], v39 offset:9216
    buffer_load_dwordx4 v157, s[4:7], s60 offen offset:1024 sc1 lds
    v_mul_f32 v212, 0x3acccccd, v212
    v_mul_f32 v213, 0x3acccccd, v213
    v_fma_f32 v213, -v212, v212, v213
    v_max_f32 v213, 0, v213
    v_mfma_f32_32x32x16_bf16 v[60:75], v[120:123], a[136:139], v[60:75]
    ds_read_b128 v[116:119], v39 offset:10240
    v_add_f32 v138, 0x3727c5ac, v213
    v_rsq_f32 v136, v138
    v_cvt_pk_bf16_f32 v214, v212, v212
    s_waitcnt vmcnt(10) lgkmcnt(3)
    v_mfma_f32_32x32x16_bf16 v[44:59], v[124:127], a[140:143], v[44:59]
    ds_read_b128 v[120:123], v39 offset:11264
    buffer_load_dwordx4 v157, s[4:7], s60 offen offset:2048 sc1 lds
    v_lshlrev_b32 v215, 16, v214
    v_sub_f32 v215, v212, v215
    v_cvt_pk_bf16_f32 v214, v212, v215
    v_cndmask_b32 v132, v214, 0, s[26:27]
    v_mfma_f32_32x32x16_bf16 v[60:75], v[128:131], a[140:143], v[60:75]
    ds_read_b128 v[124:127], v39 offset:12288
    v_and_b32 v133, 0xffff, v132
    v_mov_b32 v135, 0
    v_mul_f32 v137, 0x3fb8aa3b, v136
    s_waitcnt vmcnt(10) lgkmcnt(3)
    v_mfma_f32_32x32x16_bf16 v[44:59], v[108:111], a[144:147], v[44:59]
    ds_read_b128 v[128:131], v39 offset:13312
    buffer_load_dwordx4 v157, s[4:7], s60 offen offset:3072 sc1 lds
    v_mfma_f32_32x32x16_bf16 v[60:75], v[112:115], a[144:147], v[60:75]
    ds_read_b128 v[108:111], v39 offset:14336
    s_waitcnt vmcnt(10) lgkmcnt(3)
    v_mfma_f32_32x32x16_bf16 v[44:59], v[116:119], a[148:151], v[44:59]
    ds_read_b128 v[112:115], v39 offset:15360
    v_mfma_f32_32x32x16_bf16 v[60:75], v[120:123], a[148:151], v[60:75]
    ds_read_b128 v[116:119], v39 offset:16384
    s_waitcnt vmcnt(9) lgkmcnt(3)
    v_mfma_f32_32x32x16_bf16 v[44:59], v[124:127], a[152:155], v[44:59]
    ds_read_b128 v[120:123], v39 offset:17408
    v_mfma_f32_32x32x16_bf16 v[60:75], v[128:131], a[152:155], v[60:75]
    ds_read_b128 v[124:127], v39 offset:18432
    s_waitcnt vmcnt(8) lgkmcnt(3)
    v_mfma_f32_32x32x16_bf16 v[44:59], v[108:111], a[156:159], v[44:59]
    ds_read_b128 v[128:131], v39 offset:19456
    v_mfma_f32_32x32x16_bf16 v[60:75], v[112:115], a[156:159], v[60:75]
    ds_read_b128 v[108:111], v39 offset:20480
    v_mfma_f32_32x32x16_bf16 v[44:59], v[16:19], v[132:135], v[44:59]
    v_mfma_f32_32x32x16_bf16 v[60:75], v[18:21], v[132:135], v[60:75]
interleave_layers__linear_kernel_hedgehog__geglu_ffn__prompt_kernel_passb:
    s_waitcnt lgkmcnt(3)
    v_mfma_f32_32x32x16_bf16 v[76:91], v[116:119], a[0:3], 0
    ds_read_b128 v[112:115], v39 offset:21504
    s_add_u32 m0, s32, 32768
    s_add_u32 s60, s37, 131072
    buffer_load_dwordx4 v158, s[4:7], s60 offen offset:0 sc1 lds
    v_mfma_f32_32x32x16_bf16 v[76:91], v[120:123], a[4:7], v[76:91]
    ds_read_b128 v[116:119], v39 offset:22528
    s_waitcnt lgkmcnt(3)
    v_mfma_f32_32x32x16_bf16 v[76:91], v[124:127], a[8:11], v[76:91]
    ds_read_b128 v[120:123], v39 offset:23552
    buffer_load_dwordx4 v158, s[4:7], s60 offen offset:1024 sc1 lds
    v_max3_f32 v228, v44, v45, v46
    v_min3_f32 v229, v44, v45, v46
    v_max3_f32 v228, v228, v47, v48
    v_min3_f32 v229, v229, v47, v48
    v_max3_f32 v228, v228, v49, v50
    v_mfma_f32_32x32x16_bf16 v[76:91], v[128:131], a[12:15], v[76:91]
    ds_read_b128 v[124:127], v39 offset:24576
    v_min3_f32 v229, v229, v49, v50
    v_max3_f32 v228, v228, v51, v52
    v_min3_f32 v229, v229, v51, v52
    v_max3_f32 v228, v228, v53, v54
    v_min3_f32 v229, v229, v53, v54
    s_waitcnt lgkmcnt(3)
    v_mfma_f32_32x32x16_bf16 v[76:91], v[108:111], a[16:19], v[76:91]
    ds_read_b128 v[128:131], v39 offset:25600
    buffer_load_dwordx4 v158, s[4:7], s60 offen offset:2048 sc1 lds
    v_max3_f32 v228, v228, v55, v56
    v_min3_f32 v229, v229, v55, v56
    v_max3_f32 v228, v228, v57, v58
    v_min3_f32 v229, v229, v57, v58
    v_max3_f32 v228, v228, v59, v60
    v_mfma_f32_32x32x16_bf16 v[76:91], v[112:115], a[20:23], v[76:91]
    ds_read_b128 v[108:111], v39 offset:26624
    v_min3_f32 v229, v229, v59, v60
    v_max3_f32 v228, v228, v61, v62
    v_min3_f32 v229, v229, v61, v62
    v_max_f32 v228, v228, v63
    v_min_f32 v229, v229, v63
    s_waitcnt lgkmcnt(3)
    v_mfma_f32_32x32x16_bf16 v[76:91], v[116:119], a[24:27], v[76:91]
    ds_read_b128 v[112:115], v39 offset:27648
    buffer_load_dwordx4 v158, s[4:7], s60 offen offset:3072 sc1 lds
    v_mul_f32 v230, v228, v137
    v_mul_f32 v231, v229, v137
    v_fma_f32 v160, v44, v137, -v230
    v_fma_f32 v44, -v44, v137, v231
    v_mfma_f32_32x32x16_bf16 v[76:91], v[120:123], a[28:31], v[76:91]
    ds_read_b128 v[116:119], v39 offset:28672
    v_exp_f32 v160, v160
    v_exp_f32 v44, v44
    v_fma_f32 v161, v45, v137, -v230
    s_waitcnt lgkmcnt(3)
    v_mfma_f32_32x32x16_bf16 v[76:91], v[124:127], a[32:35], v[76:91]
    ds_read_b128 v[120:123], v39 offset:29696
    s_add_u32 m0, s32, 49152
    s_add_u32 s60, s37, 147456
    buffer_load_dwordx4 v158, s[4:7], s60 offen offset:0 sc1 lds
    v_fma_f32 v45, -v45, v137, v231
    v_exp_f32 v161, v161
    v_mfma_f32_32x32x16_bf16 v[76:91], v[128:131], a[36:39], v[76:91]
    ds_read_b128 v[124:127], v39 offset:30720
    v_exp_f32 v45, v45
    v_fma_f32 v162, v46, v137, -v230
    s_waitcnt vmcnt(9)
    s_barrier
    s_waitcnt lgkmcnt(3)
    v_mfma_f32_32x32x16_bf16 v[76:91], v[108:111], a[40:43], v[76:91]
    ds_read_b128 v[128:131], v39 offset:31744
    buffer_load_dwordx4 v158, s[4:7], s60 offen offset:1024 sc1 lds
    v_fma_f32 v46, -v46, v137, v231
    v_exp_f32 v162, v162
    v_exp_f32 v46, v46
    v_mfma_f32_32x32x16_bf16 v[76:91], v[112:115], a[44:47], v[76:91]
    ds_read_b128 v[108:111], v1 offset:0
    v_add_f32 v232, v160, v161
    v_add_f32 v233, v44, v45
    v_cvt_pk_bf16_f32 v180, v160, v161
    v_fma_f32 v163, v47, v137, -v230
    v_fma_f32 v47, -v47, v137, v231
    s_waitcnt lgkmcnt(3)
    v_mfma_f32_32x32x16_bf16 v[76:91], v[116:119], a[48:51], v[76:91]
    ds_read_b128 v[112:115], v1 offset:1024
    buffer_load_dwordx4 v158, s[4:7], s60 offen offset:2048 sc1 lds
    v_exp_f32 v163, v163
    v_exp_f32 v47, v47
    v_add_f32 v232, v232, v162
    v_mfma_f32_32x32x16_bf16 v[76:91], v[120:123], a[52:55], v[76:91]
    ds_read_b128 v[116:119], v1 offset:2048
    v_add_f32 v233, v233, v46
    v_fma_f32 v164, v48, v137, -v230
    v_fma_f32 v48, -v48, v137, v231
    v_exp_f32 v164, v164
    s_waitcnt lgkmcnt(3)
    v_mfma_f32_32x32x16_bf16 v[76:91], v[124:127], a[56:59], v[76:91]
    ds_read_b128 v[120:123], v1 offset:3072
    buffer_load_dwordx4 v158, s[4:7], s60 offen offset:3072 sc1 lds
    v_exp_f32 v48, v48
    v_add_f32 v232, v232, v163
    v_add_f32 v233, v233, v47
    v_cvt_pk_bf16_f32 v181, v162, v163
    v_mfma_f32_32x32x16_bf16 v[76:91], v[128:131], a[60:63], v[76:91]
    ds_read_b128 v[124:127], v1 offset:4096
    v_fma_f32 v165, v49, v137, -v230
    v_fma_f32 v49, -v49, v137, v231
    v_exp_f32 v165, v165
    s_waitcnt lgkmcnt(3)
    v_mfma_f32_32x32x16_bf16 v[76:91], v[108:111], a[64:67], v[76:91]
    ds_read_b128 v[128:131], v1 offset:5120
    s_add_u32 s69, s39, 0
    buffer_load_dwordx4 a[160:163], v1, s[4:7], s69 offen offset:0 sc1
    v_exp_f32 v49, v49
    v_add_f32 v232, v232, v164
    v_add_f32 v233, v233, v48
    v_mfma_f32_32x32x16_bf16 v[76:91], v[112:115], a[68:71], v[76:91]
    ds_read_b128 v[108:111], v1 offset:6144
    v_fma_f32 v166, v50, v137, -v230
    v_fma_f32 v50, -v50, v137, v231
    v_exp_f32 v166, v166
    s_waitcnt lgkmcnt(3)
    v_mfma_f32_32x32x16_bf16 v[76:91], v[116:119], a[72:75], v[76:91]
    ds_read_b128 v[112:115], v1 offset:7168
    buffer_load_dwordx4 a[164:167], v1, s[4:7], s69 offen offset:1024 sc1
    v_exp_f32 v50, v50
    v_add_f32 v232, v232, v165
    v_add_f32 v233, v233, v49
    v_cvt_pk_bf16_f32 v182, v164, v165
    v_mfma_f32_32x32x16_bf16 v[76:91], v[120:123], a[76:79], v[76:91]
    ds_read_b128 v[116:119], v1 offset:8192
    v_fma_f32 v167, v51, v137, -v230
    v_fma_f32 v51, -v51, v137, v231
    v_exp_f32 v167, v167
    s_waitcnt lgkmcnt(3)
    v_mfma_f32_32x32x16_bf16 v[76:91], v[124:127], a[80:83], v[76:91]
    ds_read_b128 v[120:123], v1 offset:9216
    s_add_u32 m0, s32, 65536
    s_add_u32 s60, s38, 0
    buffer_load_dwordx4 v1, s[8:11], s60 offen offset:0 sc1 lds
    v_exp_f32 v51, v51
    v_add_f32 v232, v232, v166
    v_mfma_f32_32x32x16_bf16 v[76:91], v[128:131], a[84:87], v[76:91]
    ds_read_b128 v[124:127], v1 offset:10240
    v_add_f32 v233, v233, v50
    v_fma_f32 v168, v52, v137, -v230
    v_fma_f32 v52, -v52, v137, v231
    v_exp_f32 v168, v168
    s_waitcnt lgkmcnt(3)
    v_mfma_f32_32x32x16_bf16 v[76:91], v[108:111], a[88:91], v[76:91]
    ds_read_b128 v[128:131], v1 offset:11264
    buffer_load_dwordx4 a[168:171], v1, s[4:7], s69 offen offset:2048 sc1
    v_exp_f32 v52, v52
    v_add_f32 v232, v232, v167
    v_add_f32 v233, v233, v51
    v_cvt_pk_bf16_f32 v183, v166, v167
    v_mfma_f32_32x32x16_bf16 v[76:91], v[112:115], a[92:95], v[76:91]
    ds_read_b128 v[108:111], v1 offset:12288
    v_fma_f32 v169, v53, v137, -v230
    v_fma_f32 v53, -v53, v137, v231
    ds_write_b128 v144, v[180:183]
    v_exp_f32 v169, v169
    s_waitcnt lgkmcnt(4)
    v_mfma_f32_32x32x16_bf16 v[76:91], v[116:119], a[96:99], v[76:91]
    ds_read_b128 v[112:115], v1 offset:13312
    buffer_load_dwordx4 a[172:175], v1, s[4:7], s69 offen offset:3072 sc1
    v_exp_f32 v53, v53
    v_add_f32 v232, v232, v168
    v_add_f32 v233, v233, v52
    v_fma_f32 v170, v54, v137, -v230
    v_mfma_f32_32x32x16_bf16 v[76:91], v[120:123], a[100:103], v[76:91]
    ds_read_b128 v[116:119], v1 offset:14336
    v_fma_f32 v54, -v54, v137, v231
    v_exp_f32 v170, v170
    s_waitcnt vmcnt(13)
    s_barrier
    s_waitcnt lgkmcnt(4)
    v_mfma_f32_32x32x16_bf16 v[76:91], v[124:127], a[104:107], v[76:91]
    ds_read_b128 v[120:123], v1 offset:15360
    buffer_load_dwordx4 v1, s[8:11], s60 offen offset:1024 sc1 lds
    v_exp_f32 v54, v54
    v_add_f32 v232, v232, v169
    v_add_f32 v233, v233, v53
    v_cvt_pk_bf16_f32 v184, v168, v169
    v_mfma_f32_32x32x16_bf16 v[76:91], v[128:131], a[108:111], v[76:91]
    ds_read_b128 v[124:127], v1 offset:16384
    v_fma_f32 v171, v55, v137, -v230
    v_fma_f32 v55, -v55, v137, v231
    v_exp_f32 v171, v171
    s_waitcnt lgkmcnt(3)
    v_mfma_f32_32x32x16_bf16 v[76:91], v[108:111], a[112:115], v[76:91]
    ds_read_b128 v[128:131], v1 offset:17408
    buffer_load_dwordx4 a[176:179], v2, s[4:7], s69 offen offset:0 sc1
    v_exp_f32 v55, v55
    v_add_f32 v232, v232, v170
    v_add_f32 v233, v233, v54
    v_fma_f32 v172, v56, v137, -v230
    v_mfma_f32_32x32x16_bf16 v[76:91], v[112:115], a[116:119], v[76:91]
    ds_read_b128 v[108:111], v1 offset:18432
    v_fma_f32 v56, -v56, v137, v231
    v_exp_f32 v172, v172
    v_exp_f32 v56, v56
    s_waitcnt lgkmcnt(3)
    v_mfma_f32_32x32x16_bf16 v[76:91], v[116:119], a[120:123], v[76:91]
    ds_read_b128 v[112:115], v1 offset:19456
    buffer_load_dwordx4 a[180:183], v2, s[4:7], s69 offen offset:1024 sc1
    v_add_f32 v232, v232, v171
    v_add_f32 v233, v233, v55
    v_cvt_pk_bf16_f32 v185, v170, v171
    v_fma_f32 v173, v57, v137, -v230
    v_fma_f32 v57, -v57, v137, v231
    v_mfma_f32_32x32x16_bf16 v[76:91], v[120:123], a[124:127], v[76:91]
    ds_read_b128 v[116:119], v1 offset:20480
    v_exp_f32 v173, v173
    v_exp_f32 v57, v57
    v_add_f32 v232, v232, v172
    s_waitcnt lgkmcnt(3)
    v_mfma_f32_32x32x16_bf16 v[76:91], v[124:127], a[128:131], v[76:91]
    ds_read_b128 v[120:123], v1 offset:21504
    buffer_load_dwordx4 v1, s[8:11], s60 offen offset:2048 sc1 lds
    v_add_f32 v233, v233, v56
    v_fma_f32 v174, v58, v137, -v230
    v_fma_f32 v58, -v58, v137, v231
    v_exp_f32 v174, v174
    v_mfma_f32_32x32x16_bf16 v[76:91], v[128:131], a[132:135], v[76:91]
    ds_read_b128 v[124:127], v1 offset:22528
    v_exp_f32 v58, v58
    v_add_f32 v232, v232, v173
    v_add_f32 v233, v233, v57
    v_cvt_pk_bf16_f32 v186, v172, v173
    s_waitcnt lgkmcnt(3)
    v_mfma_f32_32x32x16_bf16 v[76:91], v[108:111], a[136:139], v[76:91]
    ds_read_b128 v[128:131], v1 offset:23552
    buffer_load_dwordx4 a[184:187], v2, s[4:7], s69 offen offset:2048 sc1
    v_fma_f32 v175, v59, v137, -v230
    v_fma_f32 v59, -v59, v137, v231
    v_exp_f32 v175, v175
    v_mfma_f32_32x32x16_bf16 v[76:91], v[112:115], a[140:143], v[76:91]
    v_exp_f32 v59, v59
    v_add_f32 v232, v232, v174
    v_add_f32 v233, v233, v58
    v_fma_f32 v176, v60, v137, -v230
    v_fma_f32 v60, -v60, v137, v231
    s_waitcnt lgkmcnt(2)
    v_mfma_f32_32x32x16_bf16 v[76:91], v[116:119], a[144:147], v[76:91]
    buffer_load_dwordx4 a[188:191], v2, s[4:7], s69 offen offset:3072 sc1
    v_exp_f32 v176, v176
    v_exp_f32 v60, v60
    v_add_f32 v232, v232, v175
    v_add_f32 v233, v233, v59
    v_mfma_f32_32x32x16_bf16 v[76:91], v[120:123], a[148:151], v[76:91]
    v_cvt_pk_bf16_f32 v187, v174, v175
    v_fma_f32 v177, v61, v137, -v230
    v_fma_f32 v61, -v61, v137, v231
    v_xor_b32 v213, 16, v144
    ds_write_b128 v213, v[184:187]
    s_waitcnt lgkmcnt(1)
    v_mfma_f32_32x32x16_bf16 v[76:91], v[124:127], a[152:155], v[76:91]
    buffer_load_dwordx4 v1, s[8:11], s60 offen offset:3072 sc1 lds
    v_exp_f32 v177, v177
    v_exp_f32 v61, v61
    v_add_f32 v232, v232, v176
    v_add_f32 v233, v233, v60
    v_mfma_f32_32x32x16_bf16 v[76:91], v[128:131], a[156:159], v[76:91]
    v_fma_f32 v178, v62, v137, -v230
    v_fma_f32 v62, -v62, v137, v231
    v_exp_f32 v178, v178
    v_exp_f32 v62, v62
    v_add_f32 v232, v232, v177
    v_mfma_f32_32x32x16_bf16 v[76:91], v[20:23], v[132:135], v[76:91]
    buffer_load_dwordx4 a[192:195], v3, s[4:7], s69 offen offset:0 sc1
    v_add_f32 v233, v233, v61
    v_cvt_pk_bf16_f32 v188, v176, v177
    v_fma_f32 v179, v63, v137, -v230
    v_fma_f32 v63, -v63, v137, v231
    v_exp_f32 v179, v179
    v_exp_f32 v63, v63
    v_add_f32 v232, v232, v178
    v_add_f32 v233, v233, v62
    v_add_f32 v232, v232, v179
    v_add_f32 v233, v233, v63
    v_cvt_pk_bf16_f32 v189, v178, v179
    v_rcp_f32 v233, v233
    v_rcp_f32 v228, v232
    v_mul_f32 v233, v233, v232
    v_mul_f32 v44, v44, v233
    v_mul_f32 v45, v45, v233
    v_mul_f32 v46, v46, v233
    v_mul_f32 v47, v47, v233
    v_cvt_pk_bf16_f32 v190, v44, v45
    buffer_load_dwordx4 a[196:199], v3, s[4:7], s69 offen offset:1024 sc1
    v_mul_f32 v48, v48, v233
    v_mul_f32 v49, v49, v233
    v_cvt_pk_bf16_f32 v191, v46, v47
    v_xor_b32 v212, 32, v144
    ds_write_b128 v212, v[188:191]
    v_mul_f32 v50, v50, v233
    v_mul_f32 v51, v51, v233
    v_cvt_pk_bf16_f32 v192, v48, v49
    v_mul_f32 v52, v52, v233
    v_mul_f32 v53, v53, v233
    v_cvt_pk_bf16_f32 v193, v50, v51
    v_mul_f32 v54, v54, v233
    v_mul_f32 v55, v55, v233
    v_cvt_pk_bf16_f32 v194, v52, v53
    v_mul_f32 v56, v56, v233
    s_add_u32 m0, s32, 81920
    s_add_u32 s60, s38, 16384
    buffer_load_dwordx4 v1, s[8:11], s60 offen offset:0 sc1 lds
    v_mul_f32 v57, v57, v233
    v_cvt_pk_bf16_f32 v195, v54, v55
    v_xor_b32 v213, 48, v144
    ds_write_b128 v213, v[192:195]
    v_mul_f32 v58, v58, v233
    v_mul_f32 v59, v59, v233
    v_cvt_pk_bf16_f32 v196, v56, v57
    v_mul_f32 v60, v60, v233
    v_mul_f32 v61, v61, v233
    v_cvt_pk_bf16_f32 v197, v58, v59
    v_mul_f32 v62, v62, v233
    v_mul_f32 v63, v63, v233
    v_cvt_pk_bf16_f32 v198, v60, v61
    v_cvt_pk_bf16_f32 v199, v62, v63
    v_xor_b32 v212, 64, v144
    ds_write_b128 v212, v[196:199]
    buffer_load_dwordx4 a[200:203], v3, s[4:7], s69 offen offset:2048 sc1
    v_mul_f32 v229, v228, v136
    v_cvt_pk_bf16_f32 v210, v228, 0
    v_mov_b32 v211, 0
    v_mul_f32 v64, v64, v229
    v_mul_f32 v65, v65, v229
    v_cvt_pk_bf16_f32 v200, v64, v65
    v_mul_f32 v66, v66, v229
    v_mul_f32 v67, v67, v229
    v_cvt_pk_bf16_f32 v201, v66, v67
    v_mul_f32 v68, v68, v229
    v_mul_f32 v69, v69, v229
    v_cvt_pk_bf16_f32 v202, v68, v69
    v_mul_f32 v70, v70, v229
    v_mul_f32 v71, v71, v229
    buffer_load_dwordx4 a[204:207], v3, s[4:7], s69 offen offset:3072 sc1
    v_cvt_pk_bf16_f32 v203, v70, v71
    v_xor_b32 v213, 80, v144
    ds_write_b128 v213, v[200:203]
    v_mul_f32 v72, v72, v229
    v_mul_f32 v73, v73, v229
    v_cvt_pk_bf16_f32 v204, v72, v73
    v_mul_f32 v74, v74, v229
    v_mul_f32 v75, v75, v229
    v_cvt_pk_bf16_f32 v205, v74, v75
    v_pk_mul_f32 v[76:77], v[76:77], v[228:229] op_sel:[0,1] op_sel_hi:[1,1]
    v_pk_mul_f32 v[78:79], v[78:79], v[228:229] op_sel:[0,1] op_sel_hi:[1,1]
    v_pk_mul_f32 v[80:81], v[80:81], v[228:229] op_sel:[0,1] op_sel_hi:[1,1]
    v_pk_mul_f32 v[82:83], v[82:83], v[228:229] op_sel:[0,1] op_sel_hi:[1,1]
    v_cvt_pk_bf16_f32 v206, v76, v77
    v_cvt_pk_bf16_f32 v207, v78, v79
    v_cvt_pk_bf16_f32 v208, v80, v81
    v_cvt_pk_bf16_f32 v209, v82, v83
    v_xor_b32 v212, 96, v144
    ds_write_b128 v212, v[204:207]
    v_xor_b32 v213, 112, v144
    ds_write_b128 v213, v[208:211]
    buffer_load_dwordx4 v1, s[8:11], s60 offen offset:1024 sc1 lds
    s_waitcnt vmcnt(18)
    s_waitcnt lgkmcnt(0)
    s_barrier
    ds_read_b64_tr_b16 v[44:45], v145 offset:0
    ds_read_b64_tr_b16 v[46:47], v146 offset:0
    ds_read_b64_tr_b16 v[48:49], v147 offset:0
    ds_read_b64_tr_b16 v[50:51], v148 offset:0
    ds_read_b64_tr_b16 v[52:53], v145 offset:2048
    ds_read_b64_tr_b16 v[54:55], v146 offset:2048
    ds_read_b64_tr_b16 v[56:57], v147 offset:2048
    ds_read_b64_tr_b16 v[58:59], v148 offset:2048
    buffer_load_dwordx4 a[208:211], v4, s[4:7], s69 offen offset:0 sc1
    ds_read_b64_tr_b16 v[60:61], v145 offset:4096
    ds_read_b64_tr_b16 v[62:63], v146 offset:4096
    ds_read_b64_tr_b16 v[64:65], v147 offset:4096
    ds_read_b64_tr_b16 v[66:67], v148 offset:4096
    ds_read_b64_tr_b16 v[68:69], v145 offset:6144
    ds_read_b64_tr_b16 v[70:71], v146 offset:6144
    ds_read_b64_tr_b16 v[72:73], v147 offset:6144
    ds_read_b64_tr_b16 v[74:75], v148 offset:6144
    buffer_load_dwordx4 a[212:215], v4, s[4:7], s69 offen offset:1024 sc1
    s_waitcnt lgkmcnt(12)
    v_mfma_f32_32x32x16_bf16 v[160:175], v[44:47], v[48:51], 0
    ds_read_b64_tr_b16 v[212:213], v145 offset:8192
    ds_read_b64_tr_b16 v[214:215], v146 offset:8192
    ds_read_b64_tr_b16 v[216:217], v147 offset:8192
    ds_read_b64_tr_b16 v[218:219], v148 offset:8192
    s_waitcnt lgkmcnt(12)
    v_mfma_f32_32x32x16_bf16 v[160:175], v[52:55], v[56:59], v[160:175]
    ds_read_b64_tr_b16 v[220:221], v145 offset:10240
    ds_read_b64_tr_b16 v[222:223], v146 offset:10240
    ds_read_b64_tr_b16 v[224:225], v147 offset:10240
    ds_read_b64_tr_b16 v[226:227], v148 offset:10240
    buffer_load_dwordx4 v1, s[8:11], s60 offen offset:2048 sc1 lds
    s_waitcnt lgkmcnt(12)
    v_mfma_f32_32x32x16_bf16 v[160:175], v[60:63], v[64:67], v[160:175]
    ds_read_b64_tr_b16 v[228:229], v145 offset:12288
    ds_read_b64_tr_b16 v[230:231], v146 offset:12288
    ds_read_b64_tr_b16 v[232:233], v147 offset:12288
    ds_read_b64_tr_b16 v[234:235], v148 offset:12288
    s_waitcnt lgkmcnt(12)
    v_mfma_f32_32x32x16_bf16 v[160:175], v[68:71], v[72:75], v[160:175]
    ds_read_b64_tr_b16 v[236:237], v145 offset:14336
    ds_read_b64_tr_b16 v[238:239], v146 offset:14336
    ds_read_b64_tr_b16 v[240:241], v147 offset:14336
    ds_read_b64_tr_b16 v[242:243], v148 offset:14336
    buffer_load_dwordx4 a[216:219], v4, s[4:7], s69 offen offset:2048 sc1
    s_waitcnt lgkmcnt(12)
    v_mfma_f32_32x32x16_bf16 v[160:175], v[212:215], v[216:219], v[160:175]
    s_waitcnt lgkmcnt(8)
    v_mfma_f32_32x32x16_bf16 v[160:175], v[220:223], v[224:227], v[160:175]
    s_waitcnt lgkmcnt(4)
    v_mfma_f32_32x32x16_bf16 v[160:175], v[228:231], v[232:235], v[160:175]
    s_waitcnt lgkmcnt(0)
    v_mfma_f32_32x32x16_bf16 v[160:175], v[236:239], v[240:243], v[160:175]
    ds_read_b128 v[108:111], v1 offset:24576
    ds_read_b128 v[112:115], v1 offset:25600
    ds_read_b128 v[116:119], v1 offset:26624
    ds_read_b128 v[120:123], v1 offset:27648
    ds_read_b128 v[124:127], v1 offset:28672
    s_add_u32 s64, s48, 22896640
    s_nop 5
    v_cvt_pk_bf16_f32 v244, v160, v161
    v_cvt_pk_bf16_f32 v245, v162, v163
    v_cvt_pk_bf16_f32 v246, v164, v165
    v_cvt_pk_bf16_f32 v247, v166, v167
    v_cvt_pk_bf16_f32 v248, v168, v169
    v_cvt_pk_bf16_f32 v249, v170, v171
    v_cvt_pk_bf16_f32 v250, v172, v173
    v_cvt_pk_bf16_f32 v251, v174, v175
    buffer_store_dwordx4 v[244:247], v149, s[4:7], s64 offen sc1
    buffer_store_dwordx4 v[248:251], v150, s[4:7], s64 offen sc1
    v_and_b32 v208, 31, v0
    v_lshlrev_b32 v208, 4, v208
    s_mul_i32 s65, s20, 3584
    s_add_u32 s65, s65, 5718016
    s_cmp_lt_u32 s20, 15
    s_cselect_b32 s68, s65, 0x40000000
    s_waitcnt lgkmcnt(3)
    v_mfma_f32_32x32x16_bf16 v[92:107], v[108:111], a[0:3], 0
    ds_read_b128 v[128:131], v1 offset:29696
    buffer_load_dwordx4 v[180:183], v208, s[4:7], s65 offen offset:0 sc1
    v_mfma_f32_32x32x16_bf16 v[92:107], v[112:115], a[4:7], v[92:107]
    ds_read_b128 v[108:111], v1 offset:30720
    buffer_load_dwordx4 v[184:187], v208, s[4:7], s65 offen offset:512 sc1
    s_waitcnt lgkmcnt(3)
    v_mfma_f32_32x32x16_bf16 v[92:107], v[116:119], a[8:11], v[92:107]
    ds_read_b128 v[112:115], v1 offset:31744
    buffer_load_dwordx4 v[188:191], v208, s[4:7], s65 offen offset:1024 sc1
    v_mfma_f32_32x32x16_bf16 v[92:107], v[120:123], a[12:15], v[92:107]
    ds_read_b128 v[116:119], v1 offset:32768
    buffer_load_dwordx4 v[192:195], v208, s[4:7], s68 offen offset:1536 sc1
    s_waitcnt lgkmcnt(3)
    v_mfma_f32_32x32x16_bf16 v[92:107], v[124:127], a[16:19], v[92:107]
    ds_read_b128 v[120:123], v1 offset:33792
    buffer_load_dwordx4 v[196:199], v208, s[4:7], s68 offen offset:2048 sc1
    v_mfma_f32_32x32x16_bf16 v[92:107], v[128:131], a[20:23], v[92:107]
    ds_read_b128 v[124:127], v1 offset:34816
    buffer_load_dwordx4 v[200:203], v208, s[4:7], s68 offen offset:2560 sc1
    s_waitcnt lgkmcnt(3)
    v_mfma_f32_32x32x16_bf16 v[92:107], v[108:111], a[24:27], v[92:107]
    ds_read_b128 v[128:131], v1 offset:35840
    buffer_load_dwordx4 v[204:207], v208, s[4:7], s68 offen offset:3072 sc1
    v_mfma_f32_32x32x16_bf16 v[92:107], v[112:115], a[28:31], v[92:107]
    ds_read_b128 v[108:111], v1 offset:36864
    buffer_load_dwordx4 a[220:223], v4, s[4:7], s69 offen offset:3072 sc1
    s_waitcnt lgkmcnt(3)
    v_mfma_f32_32x32x16_bf16 v[92:107], v[116:119], a[32:35], v[92:107]
    ds_read_b128 v[112:115], v1 offset:37888
    v_mfma_f32_32x32x16_bf16 v[92:107], v[120:123], a[36:39], v[92:107]
    ds_read_b128 v[116:119], v1 offset:38912
    buffer_load_dwordx4 v1, s[8:11], s60 offen offset:3072 sc1 lds
    s_waitcnt lgkmcnt(3)
    v_mfma_f32_32x32x16_bf16 v[92:107], v[124:127], a[40:43], v[92:107]
    ds_read_b128 v[120:123], v1 offset:39936
    v_mfma_f32_32x32x16_bf16 v[92:107], v[128:131], a[44:47], v[92:107]
    ds_read_b128 v[124:127], v1 offset:40960
    s_add_u32 s69, s39, 16384
    buffer_load_dwordx4 a[224:227], v1, s[4:7], s69 offen offset:0 sc1
    s_waitcnt lgkmcnt(3)
    v_mfma_f32_32x32x16_bf16 v[92:107], v[108:111], a[48:51], v[92:107]
    ds_read_b128 v[128:131], v1 offset:41984
    v_mfma_f32_32x32x16_bf16 v[92:107], v[112:115], a[52:55], v[92:107]
    ds_read_b128 v[108:111], v1 offset:43008
    buffer_load_dwordx4 a[228:231], v1, s[4:7], s69 offen offset:1024 sc1
    s_waitcnt lgkmcnt(3)
    v_mfma_f32_32x32x16_bf16 v[92:107], v[116:119], a[56:59], v[92:107]
    ds_read_b128 v[112:115], v1 offset:44032
    v_mfma_f32_32x32x16_bf16 v[92:107], v[120:123], a[60:63], v[92:107]
    ds_read_b128 v[116:119], v1 offset:45056
    s_add_u32 m0, s32, 98304
    s_add_u32 s60, s38, 32768
    buffer_load_dwordx4 v1, s[8:11], s60 offen offset:0 sc1 lds
    s_waitcnt lgkmcnt(3)
    v_mfma_f32_32x32x16_bf16 v[92:107], v[124:127], a[64:67], v[92:107]
    ds_read_b128 v[120:123], v1 offset:46080
    v_mfma_f32_32x32x16_bf16 v[92:107], v[128:131], a[68:71], v[92:107]
    ds_read_b128 v[124:127], v1 offset:47104
    buffer_load_dwordx4 a[232:235], v1, s[4:7], s69 offen offset:2048 sc1
    s_waitcnt lgkmcnt(3)
    v_mfma_f32_32x32x16_bf16 v[92:107], v[108:111], a[72:75], v[92:107]
    ds_read_b128 v[128:131], v1 offset:48128
    v_mfma_f32_32x32x16_bf16 v[92:107], v[112:115], a[76:79], v[92:107]
    ds_read_b128 v[108:111], v1 offset:49152
    buffer_load_dwordx4 a[236:239], v1, s[4:7], s69 offen offset:3072 sc1
    s_waitcnt lgkmcnt(3)
    v_mfma_f32_32x32x16_bf16 v[92:107], v[116:119], a[80:83], v[92:107]
    ds_read_b128 v[112:115], v1 offset:50176
    v_mfma_f32_32x32x16_bf16 v[92:107], v[120:123], a[84:87], v[92:107]
    ds_read_b128 v[116:119], v1 offset:51200
    buffer_load_dwordx4 v1, s[8:11], s60 offen offset:1024 sc1 lds
    s_waitcnt lgkmcnt(3)
    v_mfma_f32_32x32x16_bf16 v[92:107], v[124:127], a[88:91], v[92:107]
    ds_read_b128 v[120:123], v1 offset:52224
    v_mfma_f32_32x32x16_bf16 v[92:107], v[128:131], a[92:95], v[92:107]
    ds_read_b128 v[124:127], v1 offset:53248
    buffer_load_dwordx4 a[240:243], v2, s[4:7], s69 offen offset:0 sc1
    s_waitcnt lgkmcnt(3)
    v_mfma_f32_32x32x16_bf16 v[92:107], v[108:111], a[96:99], v[92:107]
    ds_read_b128 v[128:131], v1 offset:54272
    v_mfma_f32_32x32x16_bf16 v[92:107], v[112:115], a[100:103], v[92:107]
    ds_read_b128 v[108:111], v1 offset:55296
    buffer_load_dwordx4 a[244:247], v2, s[4:7], s69 offen offset:1024 sc1
    s_waitcnt lgkmcnt(3)
    v_mfma_f32_32x32x16_bf16 v[92:107], v[116:119], a[104:107], v[92:107]
    ds_read_b128 v[112:115], v1 offset:56320
    s_waitcnt vmcnt(16)
    v_add_f32 v180, v180, v181
    v_add_f32 v182, v182, v183
    v_add_f32 v180, v180, v182
    v_cvt_pk_bf16_f32 v24, -v180, -v180
    v_mfma_f32_32x32x16_bf16 v[92:107], v[120:123], a[108:111], v[92:107]
    ds_read_b128 v[116:119], v1 offset:57344
    buffer_load_dwordx4 v1, s[8:11], s60 offen offset:2048 sc1 lds
    v_and_b32 v181, 0xffff0000, v24
    v_sub_f32 v181, -v180, v181
    v_cvt_pk_bf16_f32 v25, v181, 0
    s_waitcnt lgkmcnt(3)
    v_mfma_f32_32x32x16_bf16 v[92:107], v[124:127], a[112:115], v[92:107]
    ds_read_b128 v[120:123], v1 offset:58368
    s_waitcnt vmcnt(16)
    v_add_f32 v184, v184, v185
    v_add_f32 v186, v186, v187
    v_add_f32 v184, v184, v186
    v_cvt_pk_bf16_f32 v26, -v184, -v184
    v_mfma_f32_32x32x16_bf16 v[92:107], v[128:131], a[116:119], v[92:107]
    ds_read_b128 v[124:127], v1 offset:59392
    buffer_load_dwordx4 a[248:251], v2, s[4:7], s69 offen offset:2048 sc1
    v_and_b32 v185, 0xffff0000, v26
    v_sub_f32 v185, -v184, v185
    v_cvt_pk_bf16_f32 v27, v185, 0
    s_waitcnt lgkmcnt(3)
    v_mfma_f32_32x32x16_bf16 v[92:107], v[108:111], a[120:123], v[92:107]
    ds_read_b128 v[128:131], v1 offset:60416
    s_waitcnt vmcnt(16)
    v_add_f32 v188, v188, v189
    v_add_f32 v190, v190, v191
    v_add_f32 v188, v188, v190
    v_cvt_pk_bf16_f32 v28, -v188, -v188
    v_mfma_f32_32x32x16_bf16 v[92:107], v[112:115], a[124:127], v[92:107]
    ds_read_b128 v[108:111], v1 offset:61440
    buffer_load_dwordx4 a[252:255], v2, s[4:7], s69 offen offset:3072 sc1
    v_and_b32 v189, 0xffff0000, v28
    v_sub_f32 v189, -v188, v189
    v_cvt_pk_bf16_f32 v29, v189, 0
    s_waitcnt lgkmcnt(3)
    v_mfma_f32_32x32x16_bf16 v[92:107], v[116:119], a[128:131], v[92:107]
    ds_read_b128 v[112:115], v1 offset:62464
    s_waitcnt vmcnt(16)
    v_add_f32 v192, v192, v193
    v_add_f32 v194, v194, v195
    v_add_f32 v192, v192, v194
    v_cvt_pk_bf16_f32 v30, -v192, -v192
    v_mfma_f32_32x32x16_bf16 v[92:107], v[120:123], a[132:135], v[92:107]
    ds_read_b128 v[116:119], v1 offset:63488
    buffer_load_dwordx4 v1, s[8:11], s60 offen offset:3072 sc1 lds
    v_and_b32 v193, 0xffff0000, v30
    v_sub_f32 v193, -v192, v193
    v_cvt_pk_bf16_f32 v31, v193, 0
    s_waitcnt lgkmcnt(3)
    v_mfma_f32_32x32x16_bf16 v[92:107], v[124:127], a[136:139], v[92:107]
    ds_read_b128 v[120:123], v1 offset:64512
    s_waitcnt vmcnt(16)
    v_add_f32 v196, v196, v197
    v_add_f32 v198, v198, v199
    v_add_f32 v196, v196, v198
    v_cvt_pk_bf16_f32 v32, -v196, -v196
    v_mfma_f32_32x32x16_bf16 v[92:107], v[128:131], a[140:143], v[92:107]
    buffer_load_dwordx4 v[252:255], v3, s[4:7], s69 offen offset:0 sc1
    v_and_b32 v197, 0xffff0000, v32
    v_sub_f32 v197, -v196, v197
    v_cvt_pk_bf16_f32 v33, v197, 0
    s_waitcnt vmcnt(16)
    v_add_f32 v200, v200, v201
    s_waitcnt lgkmcnt(2)
    v_mfma_f32_32x32x16_bf16 v[92:107], v[108:111], a[144:147], v[92:107]
    v_add_f32 v202, v202, v203
    v_add_f32 v200, v200, v202
    v_cvt_pk_bf16_f32 v34, -v200, -v200
    v_and_b32 v201, 0xffff0000, v34
    v_sub_f32 v201, -v200, v201
    v_cvt_pk_bf16_f32 v35, v201, 0
    v_mfma_f32_32x32x16_bf16 v[92:107], v[112:115], a[148:151], v[92:107]
    s_waitcnt vmcnt(15)
    v_add_f32 v204, v204, v205
    v_add_f32 v206, v206, v207
    v_add_f32 v204, v204, v206
    v_cvt_pk_bf16_f32 v36, -v204, -v204
    s_waitcnt lgkmcnt(0)
    v_mfma_f32_32x32x16_bf16 v[92:107], v[116:119], a[152:155], v[92:107]
    v_and_b32 v205, 0xffff0000, v36
    v_sub_f32 v205, -v204, v205
    v_cvt_pk_bf16_f32 v37, v205, 0
    v_mfma_f32_32x32x16_bf16 v[92:107], v[120:123], a[156:159], v[92:107]
    v_mfma_f32_32x32x16_bf16 v[92:107], v[22:25], v[132:135], v[92:107]
    v_max3_f32 v246, v84, v85, v86
    v_min3_f32 v247, v84, v85, v86
    v_max3_f32 v246, v246, v87, v88
    v_min3_f32 v247, v247, v87, v88
    v_max3_f32 v246, v246, v89, v90
    v_min3_f32 v247, v247, v89, v90
    s_nop 5
    v_max3_f32 v246, v246, v91, v92
    v_min3_f32 v247, v247, v91, v92
    v_max3_f32 v246, v246, v93, v94
    s_add_u32 s64, s47, 22896640
    buffer_load_dwordx4 v[180:183], v151, s[4:7], s64 offen sc1
    v_min3_f32 v247, v247, v93, v94
    v_max3_f32 v246, v246, v95, v96
    v_min3_f32 v247, v247, v95, v96
    v_max3_f32 v246, v246, v97, v98
    v_min3_f32 v247, v247, v97, v98
    v_max3_f32 v246, v246, v99, v100
    v_min3_f32 v247, v247, v99, v100
    v_max3_f32 v246, v246, v101, v102
    v_min3_f32 v247, v247, v101, v102
    s_add_u32 s64, s47, 22900096
    buffer_load_dwordx4 v[184:187], v151, s[4:7], s64 offen sc1
    v_max_f32 v246, v246, v103
    v_min_f32 v247, v247, v103
    v_mul_f32 v248, v246, v137
    v_mul_f32 v249, v247, v137
    v_pk_fma_f32 v[160:161], v[84:85], v[136:137], v[248:249] op_sel:[0,1,0] op_sel_hi:[1,1,0] neg_lo:[0,0,1] neg_hi:[0,0,1]
    v_pk_fma_f32 v[84:85], v[84:85], v[136:137], v[248:249] op_sel:[0,1,1] op_sel_hi:[1,1,1] neg_lo:[1,0,0] neg_hi:[1,0,0]
    v_exp_f32 v160, v160
    v_exp_f32 v161, v161
    v_exp_f32 v84, v84
    s_add_u32 s64, s47, 22903552
    buffer_load_dwordx4 v[188:191], v151, s[4:7], s64 offen sc1
    v_exp_f32 v85, v85
    v_pk_fma_f32 v[162:163], v[86:87], v[136:137], v[248:249] op_sel:[0,1,0] op_sel_hi:[1,1,0] neg_lo:[0,0,1] neg_hi:[0,0,1]
    v_pk_fma_f32 v[86:87], v[86:87], v[136:137], v[248:249] op_sel:[0,1,1] op_sel_hi:[1,1,1] neg_lo:[1,0,0] neg_hi:[1,0,0]
    v_exp_f32 v162, v162
    v_exp_f32 v163, v163
    v_exp_f32 v86, v86
    v_exp_f32 v87, v87
    v_cvt_pk_bf16_f32 v44, v160, v161
    v_pk_fma_f32 v[164:165], v[88:89], v[136:137], v[248:249] op_sel:[0,1,0] op_sel_hi:[1,1,0] neg_lo:[0,0,1] neg_hi:[0,0,1]
    s_add_u32 s64, s47, 22907008
    buffer_load_dwordx4 v[192:195], v151, s[4:7], s64 offen sc1
    v_pk_fma_f32 v[88:89], v[88:89], v[136:137], v[248:249] op_sel:[0,1,1] op_sel_hi:[1,1,1] neg_lo:[1,0,0] neg_hi:[1,0,0]
    v_exp_f32 v164, v164
    v_exp_f32 v165, v165
    v_exp_f32 v88, v88
    v_exp_f32 v89, v89
    v_pk_add_f32 v[246:247], v[160:161], v[162:163]
    v_pk_add_f32 v[62:63], v[84:85], v[86:87]
    v_cvt_pk_bf16_f32 v45, v162, v163
    v_pk_fma_f32 v[166:167], v[90:91], v[136:137], v[248:249] op_sel:[0,1,0] op_sel_hi:[1,1,0] neg_lo:[0,0,1] neg_hi:[0,0,1]
    s_add_u32 s64, s47, 22910464
    buffer_load_dwordx4 v[196:199], v151, s[4:7], s64 offen sc1
    v_pk_fma_f32 v[90:91], v[90:91], v[136:137], v[248:249] op_sel:[0,1,1] op_sel_hi:[1,1,1] neg_lo:[1,0,0] neg_hi:[1,0,0]
    v_exp_f32 v166, v166
    v_exp_f32 v167, v167
    v_exp_f32 v90, v90
    v_exp_f32 v91, v91
    v_pk_add_f32 v[246:247], v[246:247], v[164:165]
    v_pk_add_f32 v[62:63], v[62:63], v[88:89]
    v_cvt_pk_bf16_f32 v46, v164, v165
    v_pk_fma_f32 v[168:169], v[92:93], v[136:137], v[248:249] op_sel:[0,1,0] op_sel_hi:[1,1,0] neg_lo:[0,0,1] neg_hi:[0,0,1]
    s_add_u32 s64, s47, 22913920
    buffer_load_dwordx4 v[200:203], v151, s[4:7], s64 offen sc1
    v_pk_fma_f32 v[92:93], v[92:93], v[136:137], v[248:249] op_sel:[0,1,1] op_sel_hi:[1,1,1] neg_lo:[1,0,0] neg_hi:[1,0,0]
    v_exp_f32 v168, v168
    v_exp_f32 v169, v169
    v_exp_f32 v92, v92
    v_exp_f32 v93, v93
    v_pk_add_f32 v[246:247], v[246:247], v[166:167]
    v_pk_add_f32 v[62:63], v[62:63], v[90:91]
    v_cvt_pk_bf16_f32 v47, v166, v167
    v_pk_fma_f32 v[170:171], v[94:95], v[136:137], v[248:249] op_sel:[0,1,0] op_sel_hi:[1,1,0] neg_lo:[0,0,1] neg_hi:[0,0,1]
    s_add_u32 s64, s47, 22917376
    buffer_load_dwordx4 v[204:207], v151, s[4:7], s64 offen sc1
    v_pk_fma_f32 v[94:95], v[94:95], v[136:137], v[248:249] op_sel:[0,1,1] op_sel_hi:[1,1,1] neg_lo:[1,0,0] neg_hi:[1,0,0]
    v_exp_f32 v170, v170
    v_exp_f32 v171, v171
    v_exp_f32 v94, v94
    v_exp_f32 v95, v95
    v_pk_add_f32 v[246:247], v[246:247], v[168:169]
    v_pk_add_f32 v[62:63], v[62:63], v[92:93]
    v_cvt_pk_bf16_f32 v48, v168, v169
    v_pk_fma_f32 v[172:173], v[96:97], v[136:137], v[248:249] op_sel:[0,1,0] op_sel_hi:[1,1,0] neg_lo:[0,0,1] neg_hi:[0,0,1]
    s_add_u32 s64, s47, 22920832
    buffer_load_dwordx4 v[208:211], v151, s[4:7], s64 offen sc1
    v_pk_fma_f32 v[96:97], v[96:97], v[136:137], v[248:249] op_sel:[0,1,1] op_sel_hi:[1,1,1] neg_lo:[1,0,0] neg_hi:[1,0,0]
    v_exp_f32 v172, v172
    v_exp_f32 v173, v173
    v_exp_f32 v96, v96
    v_exp_f32 v97, v97
    v_pk_add_f32 v[246:247], v[246:247], v[170:171]
    v_pk_add_f32 v[62:63], v[62:63], v[94:95]
    v_cvt_pk_bf16_f32 v49, v170, v171
    v_pk_fma_f32 v[174:175], v[98:99], v[136:137], v[248:249] op_sel:[0,1,0] op_sel_hi:[1,1,0] neg_lo:[0,0,1] neg_hi:[0,0,1]
    s_add_u32 s64, s47, 22924288
    buffer_load_dwordx4 v[212:215], v151, s[4:7], s64 offen sc1
    v_pk_fma_f32 v[98:99], v[98:99], v[136:137], v[248:249] op_sel:[0,1,1] op_sel_hi:[1,1,1] neg_lo:[1,0,0] neg_hi:[1,0,0]
    v_exp_f32 v174, v174
    v_exp_f32 v175, v175
    v_exp_f32 v98, v98
    v_exp_f32 v99, v99
    v_pk_add_f32 v[246:247], v[246:247], v[172:173]
    v_pk_add_f32 v[62:63], v[62:63], v[96:97]
    v_cvt_pk_bf16_f32 v50, v172, v173
    v_pk_fma_f32 v[176:177], v[100:101], v[136:137], v[248:249] op_sel:[0,1,0] op_sel_hi:[1,1,0] neg_lo:[0,0,1] neg_hi:[0,0,1]
    s_add_u32 s64, s47, 22927744
    buffer_load_dwordx4 v[216:219], v151, s[4:7], s64 offen sc1
    v_pk_fma_f32 v[100:101], v[100:101], v[136:137], v[248:249] op_sel:[0,1,1] op_sel_hi:[1,1,1] neg_lo:[1,0,0] neg_hi:[1,0,0]
    v_exp_f32 v176, v176
    v_exp_f32 v177, v177
    v_exp_f32 v100, v100
    v_exp_f32 v101, v101
    v_pk_add_f32 v[246:247], v[246:247], v[174:175]
    v_pk_add_f32 v[62:63], v[62:63], v[98:99]
    v_cvt_pk_bf16_f32 v51, v174, v175
    v_pk_fma_f32 v[178:179], v[102:103], v[136:137], v[248:249] op_sel:[0,1,0] op_sel_hi:[1,1,0] neg_lo:[0,0,1] neg_hi:[0,0,1]
    s_add_u32 s64, s47, 22931200
    buffer_load_dwordx4 v[220:223], v151, s[4:7], s64 offen sc1
    v_pk_fma_f32 v[102:103], v[102:103], v[136:137], v[248:249] op_sel:[0,1,1] op_sel_hi:[1,1,1] neg_lo:[1,0,0] neg_hi:[1,0,0]
    v_exp_f32 v178, v178
    v_exp_f32 v179, v179
    v_exp_f32 v102, v102
    v_exp_f32 v103, v103
    v_pk_add_f32 v[246:247], v[246:247], v[176:177]
    v_pk_add_f32 v[62:63], v[62:63], v[100:101]
    v_cvt_pk_bf16_f32 v52, v176, v177
    v_pk_add_f32 v[246:247], v[246:247], v[178:179]
    s_add_u32 s64, s47, 22934656
    buffer_load_dwordx4 v[224:227], v151, s[4:7], s64 offen sc1
    v_pk_add_f32 v[62:63], v[62:63], v[102:103]
    v_add_f32 v250, v246, v247
    v_add_f32 v251, v62, v63
    v_rcp_f32 v251, v251
    v_cvt_pk_bf16_f32 v53, v178, v179
    v_mul_f32 v251, v251, v250
    v_pk_mul_f32 v[84:85], v[84:85], v[250:251] op_sel:[0,1] op_sel_hi:[1,1]
    v_pk_mul_f32 v[86:87], v[86:87], v[250:251] op_sel:[0,1] op_sel_hi:[1,1]
    v_cvt_pk_bf16_f32 v54, v84, v85
    s_add_u32 s64, s47, 22938112
    buffer_load_dwordx4 v[228:231], v151, s[4:7], s64 offen sc1
    v_pk_mul_f32 v[88:89], v[88:89], v[250:251] op_sel:[0,1] op_sel_hi:[1,1]
    v_cvt_pk_bf16_f32 v55, v86, v87
    v_pk_mul_f32 v[90:91], v[90:91], v[250:251] op_sel:[0,1] op_sel_hi:[1,1]
    v_cvt_pk_bf16_f32 v56, v88, v89
    v_pk_mul_f32 v[92:93], v[92:93], v[250:251] op_sel:[0,1] op_sel_hi:[1,1]
    v_cvt_pk_bf16_f32 v57, v90, v91
    v_pk_mul_f32 v[94:95], v[94:95], v[250:251] op_sel:[0,1] op_sel_hi:[1,1]
    v_cvt_pk_bf16_f32 v58, v92, v93
    v_pk_mul_f32 v[96:97], v[96:97], v[250:251] op_sel:[0,1] op_sel_hi:[1,1]
    s_add_u32 s64, s47, 22941568
    buffer_load_dwordx4 v[232:235], v151, s[4:7], s64 offen sc1
    v_cvt_pk_bf16_f32 v59, v94, v95
    v_pk_mul_f32 v[98:99], v[98:99], v[250:251] op_sel:[0,1] op_sel_hi:[1,1]
    v_cvt_pk_bf16_f32 v60, v96, v97
    v_pk_mul_f32 v[100:101], v[100:101], v[250:251] op_sel:[0,1] op_sel_hi:[1,1]
    v_cvt_pk_bf16_f32 v61, v98, v99
    v_pk_mul_f32 v[102:103], v[102:103], v[250:251] op_sel:[0,1] op_sel_hi:[1,1]
    v_cvt_pk_bf16_f32 v62, v100, v101
    v_cvt_pk_bf16_f32 v63, v102, v103
    s_add_u32 s64, s47, 22945024
    buffer_load_dwordx4 v[236:239], v151, s[4:7], s64 offen sc1
    s_add_u32 s64, s47, 22948480
    buffer_load_dwordx4 v[240:243], v151, s[4:7], s64 offen sc1
    v_mul_f32 v251, 0x358637bd, v250
    s_mov_b32 s31, 0
gsum_14:
    s_nop 0
    s_waitcnt vmcnt(15)
    v_lshlrev_b32 v64, 16, v180
    v_and_b32 v65, 0xffff0000, v180
    v_lshlrev_b32 v66, 16, v181
    v_and_b32 v67, 0xffff0000, v181
    v_lshlrev_b32 v68, 16, v182
    v_and_b32 v69, 0xffff0000, v182
    v_lshlrev_b32 v70, 16, v183
    v_and_b32 v71, 0xffff0000, v183
    s_waitcnt vmcnt(14)
    v_dot2c_f32_bf16 v64, s28, v184
    v_dot2c_f32_bf16 v65, s29, v184
    v_dot2c_f32_bf16 v66, s28, v185
    v_dot2c_f32_bf16 v67, s29, v185
    v_dot2c_f32_bf16 v68, s28, v186
    v_dot2c_f32_bf16 v69, s29, v186
    v_dot2c_f32_bf16 v70, s28, v187
    v_dot2c_f32_bf16 v71, s29, v187
    s_waitcnt vmcnt(13)
    v_dot2c_f32_bf16 v64, s28, v188
    v_dot2c_f32_bf16 v65, s29, v188
    v_dot2c_f32_bf16 v66, s28, v189
    v_dot2c_f32_bf16 v67, s29, v189
    v_dot2c_f32_bf16 v68, s28, v190
    v_dot2c_f32_bf16 v69, s29, v190
    v_dot2c_f32_bf16 v70, s28, v191
    v_dot2c_f32_bf16 v71, s29, v191
    s_waitcnt vmcnt(12)
    v_dot2c_f32_bf16 v64, s28, v192
    v_dot2c_f32_bf16 v65, s29, v192
    v_dot2c_f32_bf16 v66, s28, v193
    v_dot2c_f32_bf16 v67, s29, v193
    v_dot2c_f32_bf16 v68, s28, v194
    v_dot2c_f32_bf16 v69, s29, v194
    v_dot2c_f32_bf16 v70, s28, v195
    v_dot2c_f32_bf16 v71, s29, v195
    s_waitcnt vmcnt(11)
    v_dot2c_f32_bf16 v64, s28, v196
    v_dot2c_f32_bf16 v65, s29, v196
    v_dot2c_f32_bf16 v66, s28, v197
    v_dot2c_f32_bf16 v67, s29, v197
    v_dot2c_f32_bf16 v68, s28, v198
    v_dot2c_f32_bf16 v69, s29, v198
    v_dot2c_f32_bf16 v70, s28, v199
    v_dot2c_f32_bf16 v71, s29, v199
    s_waitcnt vmcnt(10)
    v_dot2c_f32_bf16 v64, s28, v200
    v_dot2c_f32_bf16 v65, s29, v200
    v_dot2c_f32_bf16 v66, s28, v201
    v_dot2c_f32_bf16 v67, s29, v201
    v_dot2c_f32_bf16 v68, s28, v202
    v_dot2c_f32_bf16 v69, s29, v202
    v_dot2c_f32_bf16 v70, s28, v203
    v_dot2c_f32_bf16 v71, s29, v203
    s_waitcnt vmcnt(9)
    v_dot2c_f32_bf16 v64, s28, v204
    v_dot2c_f32_bf16 v65, s29, v204
    v_dot2c_f32_bf16 v66, s28, v205
    v_dot2c_f32_bf16 v67, s29, v205
    v_dot2c_f32_bf16 v68, s28, v206
    v_dot2c_f32_bf16 v69, s29, v206
    v_dot2c_f32_bf16 v70, s28, v207
    v_dot2c_f32_bf16 v71, s29, v207
    s_waitcnt vmcnt(8)
    v_dot2c_f32_bf16 v64, s28, v208
    v_dot2c_f32_bf16 v65, s29, v208
    v_dot2c_f32_bf16 v66, s28, v209
    v_dot2c_f32_bf16 v67, s29, v209
    v_dot2c_f32_bf16 v68, s28, v210
    v_dot2c_f32_bf16 v69, s29, v210
    v_dot2c_f32_bf16 v70, s28, v211
    v_dot2c_f32_bf16 v71, s29, v211
    s_waitcnt vmcnt(7)
    v_dot2c_f32_bf16 v64, s28, v212
    v_dot2c_f32_bf16 v65, s29, v212
    v_dot2c_f32_bf16 v66, s28, v213
    v_dot2c_f32_bf16 v67, s29, v213
    v_dot2c_f32_bf16 v68, s28, v214
    v_dot2c_f32_bf16 v69, s29, v214
    v_dot2c_f32_bf16 v70, s28, v215
    v_dot2c_f32_bf16 v71, s29, v215
    s_waitcnt vmcnt(6)
    v_dot2c_f32_bf16 v64, s28, v216
    v_dot2c_f32_bf16 v65, s29, v216
    v_dot2c_f32_bf16 v66, s28, v217
    v_dot2c_f32_bf16 v67, s29, v217
    v_dot2c_f32_bf16 v68, s28, v218
    v_dot2c_f32_bf16 v69, s29, v218
    v_dot2c_f32_bf16 v70, s28, v219
    v_dot2c_f32_bf16 v71, s29, v219
    s_waitcnt vmcnt(5)
    v_dot2c_f32_bf16 v64, s28, v220
    v_dot2c_f32_bf16 v65, s29, v220
    v_dot2c_f32_bf16 v66, s28, v221
    v_dot2c_f32_bf16 v67, s29, v221
    v_dot2c_f32_bf16 v68, s28, v222
    v_dot2c_f32_bf16 v69, s29, v222
    v_dot2c_f32_bf16 v70, s28, v223
    v_dot2c_f32_bf16 v71, s29, v223
    s_waitcnt vmcnt(4)
    v_dot2c_f32_bf16 v64, s28, v224
    v_dot2c_f32_bf16 v65, s29, v224
    v_dot2c_f32_bf16 v66, s28, v225
    v_dot2c_f32_bf16 v67, s29, v225
    v_dot2c_f32_bf16 v68, s28, v226
    v_dot2c_f32_bf16 v69, s29, v226
    v_dot2c_f32_bf16 v70, s28, v227
    v_dot2c_f32_bf16 v71, s29, v227
    s_waitcnt vmcnt(3)
    v_dot2c_f32_bf16 v64, s28, v228
    v_dot2c_f32_bf16 v65, s29, v228
    v_dot2c_f32_bf16 v66, s28, v229
    v_dot2c_f32_bf16 v67, s29, v229
    v_dot2c_f32_bf16 v68, s28, v230
    v_dot2c_f32_bf16 v69, s29, v230
    v_dot2c_f32_bf16 v70, s28, v231
    v_dot2c_f32_bf16 v71, s29, v231
    s_waitcnt vmcnt(2)
    v_dot2c_f32_bf16 v64, s28, v232
    v_dot2c_f32_bf16 v65, s29, v232
    v_dot2c_f32_bf16 v66, s28, v233
    v_dot2c_f32_bf16 v67, s29, v233
    v_dot2c_f32_bf16 v68, s28, v234
    v_dot2c_f32_bf16 v69, s29, v234
    v_dot2c_f32_bf16 v70, s28, v235
    v_dot2c_f32_bf16 v71, s29, v235
    s_waitcnt vmcnt(1)
    v_dot2c_f32_bf16 v64, s28, v236
    v_dot2c_f32_bf16 v65, s29, v236
    v_dot2c_f32_bf16 v66, s28, v237
    v_dot2c_f32_bf16 v67, s29, v237
    v_dot2c_f32_bf16 v68, s28, v238
    v_dot2c_f32_bf16 v69, s29, v238
    v_dot2c_f32_bf16 v70, s28, v239
    v_dot2c_f32_bf16 v71, s29, v239
    s_waitcnt vmcnt(0)
    v_dot2c_f32_bf16 v64, s28, v240
    v_dot2c_f32_bf16 v65, s29, v240
    v_dot2c_f32_bf16 v66, s28, v241
    v_dot2c_f32_bf16 v67, s29, v241
    v_dot2c_f32_bf16 v68, s28, v242
    v_dot2c_f32_bf16 v69, s29, v242
    v_dot2c_f32_bf16 v70, s28, v243
    v_dot2c_f32_bf16 v71, s29, v243
    v_add_f32 v72, v64, v66
    s_nop 0
    v_add_f32 v73, v68, v70
    v_cmp_u_f32 vcc, v72, v73
    s_nop 0
    s_cbranch_vccz gok_13
    s_add_u32 s31, s31, 1
    s_cmp_ge_u32 s31, 4096
    s_cbranch_scc1 gok_13
    s_add_u32 s64, s47, 22896640
    buffer_load_dwordx4 v[180:183], v151, s[4:7], s64 offen sc1
    s_add_u32 s64, s47, 22900096
    buffer_load_dwordx4 v[184:187], v151, s[4:7], s64 offen sc1
    s_add_u32 s64, s47, 22903552
    buffer_load_dwordx4 v[188:191], v151, s[4:7], s64 offen sc1
    s_add_u32 s64, s47, 22907008
    buffer_load_dwordx4 v[192:195], v151, s[4:7], s64 offen sc1
    s_add_u32 s64, s47, 22910464
    buffer_load_dwordx4 v[196:199], v151, s[4:7], s64 offen sc1
    s_add_u32 s64, s47, 22913920
    buffer_load_dwordx4 v[200:203], v151, s[4:7], s64 offen sc1
    s_add_u32 s64, s47, 22917376
    buffer_load_dwordx4 v[204:207], v151, s[4:7], s64 offen sc1
    s_add_u32 s64, s47, 22920832
    buffer_load_dwordx4 v[208:211], v151, s[4:7], s64 offen sc1
    s_add_u32 s64, s47, 22924288
    buffer_load_dwordx4 v[212:215], v151, s[4:7], s64 offen sc1
    s_add_u32 s64, s47, 22927744
    buffer_load_dwordx4 v[216:219], v151, s[4:7], s64 offen sc1
    s_add_u32 s64, s47, 22931200
    buffer_load_dwordx4 v[220:223], v151, s[4:7], s64 offen sc1
    s_add_u32 s64, s47, 22934656
    buffer_load_dwordx4 v[224:227], v151, s[4:7], s64 offen sc1
    s_add_u32 s64, s47, 22938112
    buffer_load_dwordx4 v[228:231], v151, s[4:7], s64 offen sc1
    s_add_u32 s64, s47, 22941568
    buffer_load_dwordx4 v[232:235], v151, s[4:7], s64 offen sc1
    s_add_u32 s64, s47, 22945024
    buffer_load_dwordx4 v[236:239], v151, s[4:7], s64 offen sc1
    s_add_u32 s64, s47, 22948480
    buffer_load_dwordx4 v[240:243], v151, s[4:7], s64 offen sc1
    s_waitcnt vmcnt(0)
    s_branch gsum_14
gok_13:
    v_cvt_pk_bf16_f32 v72, v64, v65
    v_cvt_pk_bf16_f32 v73, v66, v67
    v_cvt_pk_bf16_f32 v74, v68, v69
    v_cvt_pk_bf16_f32 v75, v70, v71
    ds_write_b128 v152, v[72:75] offset:16384
    s_waitcnt lgkmcnt(0)
    s_barrier
    ds_read_b128 v[180:183], v153 offset:16384
    ds_read_b128 v[184:187], v154 offset:16384
    ds_read_b128 v[188:191], v153 offset:16400
    ds_read_b128 v[192:195], v154 offset:16400
    ds_read_b128 v[196:199], v153 offset:16416
    ds_read_b128 v[200:203], v154 offset:16416
    ds_read_b128 v[204:207], v153 offset:16432
    ds_read_b128 v[208:211], v154 offset:16432
    ds_read_b128 v[212:215], v153 offset:16448
    ds_read_b128 v[216:219], v154 offset:16448
    s_add_u32 m0, s32, 114688
    s_add_u32 s60, s38, 49152
    buffer_load_dwordx4 v1, s[8:11], s60 offen offset:0 sc1 lds
    buffer_load_dwordx4 v1, s[8:11], s60 offen offset:1024 sc1 lds
    buffer_load_dwordx4 v1, s[8:11], s60 offen offset:2048 sc1 lds
    buffer_load_dwordx4 v1, s[8:11], s60 offen offset:3072 sc1 lds
    s_add_u32 s64, s44, 13115392
    s_add_u32 s65, s45, 22872064
    s_waitcnt lgkmcnt(8)
    v_mfma_f32_32x32x16_bf16 v[80:95], v[184:187], v[44:47], 0
    v_mfma_f32_32x32x16_bf16 v[64:79], v[180:183], v[44:47], 0
    s_waitcnt lgkmcnt(6)
    v_mfma_f32_32x32x16_bf16 v[80:95], v[192:195], v[48:51], v[80:95]
    v_mfma_f32_32x32x16_bf16 v[64:79], v[188:191], v[48:51], v[64:79]
    s_waitcnt lgkmcnt(4)
    v_mfma_f32_32x32x16_bf16 v[80:95], v[200:203], v[52:55], v[80:95]
    v_mfma_f32_32x32x16_bf16 v[64:79], v[196:199], v[52:55], v[64:79]
    s_waitcnt lgkmcnt(2)
    v_mfma_f32_32x32x16_bf16 v[80:95], v[208:211], v[56:59], v[80:95]
    v_mfma_f32_32x32x16_bf16 v[64:79], v[204:207], v[56:59], v[64:79]
    s_waitcnt lgkmcnt(0)
    v_mfma_f32_32x32x16_bf16 v[80:95], v[216:219], v[60:63], v[80:95]
    v_mfma_f32_32x32x16_bf16 v[64:79], v[212:215], v[60:63], v[64:79]
    s_nop 10
    v_add_f32 v244, v251, v84
    v_rcp_f32 v244, v244
    s_nop 0
    v_pk_mul_f32 v[80:81], v[80:81], v[244:245] op_sel_hi:[1,0]
    v_pk_mul_f32 v[82:83], v[82:83], v[244:245] op_sel_hi:[1,0]
    v_pk_mul_f32 v[64:65], v[64:65], v[244:245] op_sel_hi:[1,0]
    v_pk_mul_f32 v[66:67], v[66:67], v[244:245] op_sel_hi:[1,0]
    v_pk_mul_f32 v[68:69], v[68:69], v[244:245] op_sel_hi:[1,0]
    v_pk_mul_f32 v[70:71], v[70:71], v[244:245] op_sel_hi:[1,0]
    v_pk_mul_f32 v[72:73], v[72:73], v[244:245] op_sel_hi:[1,0]
    v_pk_mul_f32 v[74:75], v[74:75], v[244:245] op_sel_hi:[1,0]
    v_pk_mul_f32 v[76:77], v[76:77], v[244:245] op_sel_hi:[1,0]
    v_pk_mul_f32 v[78:79], v[78:79], v[244:245] op_sel_hi:[1,0]
    v_cvt_pk_bf16_f32 v160, v64, v65
    v_cvt_pk_bf16_f32 v161, v66, v67
    v_cvt_pk_bf16_f32 v162, v68, v69
    v_cvt_pk_bf16_f32 v163, v70, v71
    v_cvt_pk_bf16_f32 v164, v72, v73
    v_cvt_pk_bf16_f32 v165, v74, v75
    v_cvt_pk_bf16_f32 v166, v76, v77
    v_cvt_pk_bf16_f32 v167, v78, v79
    v_cvt_pk_bf16_f32 v168, v80, v81
    v_cvt_pk_bf16_f32 v169, v82, v83
    buffer_store_dwordx4 v[160:163], v155, s[4:7], s64 offen sc1
    buffer_store_dwordx4 v[164:167], v155, s[4:7], s64 offen offset:512 sc1
    buffer_store_dwordx2 v[168:169], v156, s[4:7], s64 offen offset:1024 sc1
    s_waitcnt vmcnt(0)
    s_cmp_lg_u32 s24, 0
    s_cbranch_scc1 pubf_15
    buffer_wbl2 sc1
    s_waitcnt vmcnt(0)
    buffer_store_dword v6, v5, s[4:7], s65 offen sc1
    s_branch pubd_16
pubf_15:
    buffer_store_dword v6, v5, s[4:7], s65 offen
pubd_16:
    s_cmp_eq_u32 s23, 0
    s_cselect_b32 s37, s37, 0x40000000
    s_add_u32 s61, s42, 12984320
    v_add_u32 v116, s61, v14
    s_add_u32 s61, s43, 22847488
    v_writelane_b32 v116, s61, 63
    s_add_u32 s62, s16, 1
    s_and_b32 s62, s62, 3
    s_mul_i32 s62, s62, 20480
    s_add_u32 s73, s62, s52
    s_add_u32 s62, s16, 2
    s_and_b32 s62, s62, 3
    s_mul_i32 s62, s62, 20480
    s_add_u32 s74, s62, s52
    s_add_u32 s62, s16, 3
    s_and_b32 s62, s62, 3
    s_mul_i32 s62, s62, 20480
    s_add_u32 s75, s62, s52
    s_add_u32 s62, s16, 4
    s_and_b32 s62, s62, 3
    s_mul_i32 s62, s62, 20480
    s_add_u32 s76, s62, s52
    s_add_u32 s63, s49, 22872064
    s_barrier
    s_mov_b32 s31, 0
poll_17:
    buffer_load_dword v114, v8, s[4:7], s63 offen sc1
    s_add_u32 s31, s31, 1
    s_waitcnt vmcnt(0)
    v_cmp_eq_u32 vcc, -1, v114
    s_nop 0
    s_cbranch_vccz pok_18
    s_cmp_lt_u32 s31, 32768
    s_cbranch_scc1 poll_17
    s_endpgm
pok_18:
    s_cmp_lg_u32 s24, 0
    s_cbranch_scc1 pfast_19
    buffer_inv sc1
    s_waitcnt vmcnt(0)
pfast_19:
    buffer_load_dwordx4 a[0:3], v1, s[4:7], s73 offen offset:0 sc1
    buffer_load_dwordx4 a[4:7], v1, s[4:7], s73 offen offset:1024 sc1
    buffer_load_dwordx4 a[8:11], v1, s[4:7], s73 offen offset:2048 sc1
    buffer_load_dwordx4 a[12:15], v1, s[4:7], s73 offen offset:3072 sc1
    buffer_load_dwordx4 a[16:19], v2, s[4:7], s73 offen offset:0 sc1
    buffer_load_dwordx4 a[20:23], v1, s[4:7], s74 offen offset:0 sc1
    buffer_load_dwordx4 a[24:27], v1, s[4:7], s74 offen offset:1024 sc1
    buffer_load_dwordx4 a[28:31], v1, s[4:7], s74 offen offset:2048 sc1
    s_waitcnt vmcnt(7)
    v_mfma_f32_16x16x32_bf16 v[44:47], a[160:163], a[0:3], 0
    v_mfma_f32_16x16x32_bf16 v[48:51], a[164:167], a[0:3], 0
    v_mfma_f32_16x16x32_bf16 v[52:55], a[168:171], a[0:3], 0
    v_mfma_f32_16x16x32_bf16 v[56:59], a[172:175], a[0:3], 0
    buffer_load_dwordx4 a[32:35], v1, s[4:7], s74 offen offset:3072 sc1
    v_mfma_f32_16x16x32_bf16 v[60:63], a[176:179], a[0:3], 0
    s_waitcnt vmcnt(7)
    v_mfma_f32_16x16x32_bf16 v[44:47], a[180:183], a[4:7], v[44:47]
    v_mfma_f32_16x16x32_bf16 v[48:51], a[184:187], a[4:7], v[48:51]
    v_mfma_f32_16x16x32_bf16 v[52:55], a[188:191], a[4:7], v[52:55]
    buffer_load_dwordx4 a[36:39], v2, s[4:7], s74 offen offset:0 sc1
    v_mfma_f32_16x16x32_bf16 v[56:59], a[192:195], a[4:7], v[56:59]
    v_mfma_f32_16x16x32_bf16 v[60:63], a[196:199], a[4:7], v[60:63]
    s_waitcnt vmcnt(7)
    v_mfma_f32_16x16x32_bf16 v[44:47], a[200:203], a[8:11], v[44:47]
    v_mfma_f32_16x16x32_bf16 v[48:51], a[204:207], a[8:11], v[48:51]
    buffer_load_dwordx4 a[40:43], v1, s[4:7], s75 offen offset:0 sc1
    v_mfma_f32_16x16x32_bf16 v[52:55], a[208:211], a[8:11], v[52:55]
    v_mfma_f32_16x16x32_bf16 v[56:59], a[212:215], a[8:11], v[56:59]
    v_mfma_f32_16x16x32_bf16 v[60:63], a[216:219], a[8:11], v[60:63]
    s_waitcnt vmcnt(7)
    v_mfma_f32_16x16x32_bf16 v[44:47], a[220:223], a[12:15], v[44:47]
    s_add_u32 s61, s41, 10362880
    buffer_load_dwordx4 v[104:107], v12, s[4:7], s61 offen sc1
    buffer_load_dwordx4 v[108:111], v12, s[4:7], s61 offen offset:2048 sc1
    buffer_load_dwordx2 v[112:113], v13, s[4:7], s61 offen sc1
    buffer_load_dword v117, v116, s[4:7], 0 offen sc1
    v_mfma_f32_16x16x32_bf16 v[48:51], a[224:227], a[12:15], v[48:51]
    v_mfma_f32_16x16x32_bf16 v[52:55], a[228:231], a[12:15], v[52:55]
    v_mfma_f32_16x16x32_bf16 v[56:59], a[232:235], a[12:15], v[56:59]
    v_mfma_f32_16x16x32_bf16 v[60:63], a[236:239], a[12:15], v[60:63]
    buffer_load_dwordx4 a[44:47], v1, s[4:7], s75 offen offset:1024 sc1
    s_waitcnt vmcnt(11)
    v_mfma_f32_16x16x32_bf16 v[44:47], a[240:243], a[16:19], v[44:47]
    v_mfma_f32_16x16x32_bf16 v[48:51], a[244:247], a[16:19], v[48:51]
    v_mfma_f32_16x16x32_bf16 v[52:55], a[248:251], a[16:19], v[52:55]
    v_mfma_f32_16x16x32_bf16 v[56:59], a[252:255], a[16:19], v[56:59]
    buffer_load_dwordx4 a[48:51], v1, s[4:7], s75 offen offset:2048 sc1
    v_mfma_f32_16x16x32_bf16 v[60:63], v[252:255], a[16:19], v[60:63]
    s_waitcnt vmcnt(11)
    v_mfma_f32_16x16x32_bf16 v[64:67], a[160:163], a[20:23], 0
    v_mfma_f32_16x16x32_bf16 v[68:71], a[164:167], a[20:23], 0
    ds_write_b128 v40, v[44:47] offset:0
    v_mfma_f32_16x16x32_bf16 v[72:75], a[168:171], a[20:23], 0
    buffer_load_dwordx4 a[52:55], v1, s[4:7], s75 offen offset:3072 sc1
    v_mfma_f32_16x16x32_bf16 v[76:79], a[172:175], a[20:23], 0
    v_mfma_f32_16x16x32_bf16 v[80:83], a[176:179], a[20:23], 0
    s_waitcnt vmcnt(11)
    v_mfma_f32_16x16x32_bf16 v[64:67], a[180:183], a[24:27], v[64:67]
    ds_write_b128 v40, v[48:51] offset:1024
    v_mfma_f32_16x16x32_bf16 v[68:71], a[184:187], a[24:27], v[68:71]
    buffer_load_dwordx4 a[56:59], v2, s[4:7], s75 offen offset:0 sc1
    v_mfma_f32_16x16x32_bf16 v[72:75], a[188:191], a[24:27], v[72:75]
    v_mfma_f32_16x16x32_bf16 v[76:79], a[192:195], a[24:27], v[76:79]
    v_mfma_f32_16x16x32_bf16 v[80:83], a[196:199], a[24:27], v[80:83]
    ds_write_b128 v40, v[52:55] offset:2048
    s_waitcnt vmcnt(11)
    v_mfma_f32_16x16x32_bf16 v[64:67], a[200:203], a[28:31], v[64:67]
    buffer_load_dwordx4 a[60:63], v1, s[4:7], s76 offen offset:0 sc1
    v_mfma_f32_16x16x32_bf16 v[68:71], a[204:207], a[28:31], v[68:71]
    v_mfma_f32_16x16x32_bf16 v[72:75], a[208:211], a[28:31], v[72:75]
    v_mfma_f32_16x16x32_bf16 v[76:79], a[212:215], a[28:31], v[76:79]
    ds_write_b128 v40, v[56:59] offset:3072
    v_mfma_f32_16x16x32_bf16 v[80:83], a[216:219], a[28:31], v[80:83]
    buffer_load_dwordx4 a[64:67], v1, s[4:7], s76 offen offset:1024 sc1
    s_waitcnt vmcnt(12)
    v_mfma_f32_16x16x32_bf16 v[64:67], a[220:223], a[32:35], v[64:67]
    v_mfma_f32_16x16x32_bf16 v[68:71], a[224:227], a[32:35], v[68:71]
    v_mfma_f32_16x16x32_bf16 v[72:75], a[228:231], a[32:35], v[72:75]
    ds_write_b128 v40, v[60:63] offset:4096
    v_mfma_f32_16x16x32_bf16 v[76:79], a[232:235], a[32:35], v[76:79]
    buffer_load_dwordx4 a[68:71], v1, s[4:7], s76 offen offset:2048 sc1
    v_mfma_f32_16x16x32_bf16 v[80:83], a[236:239], a[32:35], v[80:83]
    s_waitcnt vmcnt(12)
    v_mfma_f32_16x16x32_bf16 v[64:67], a[240:243], a[36:39], v[64:67]
    v_mfma_f32_16x16x32_bf16 v[68:71], a[244:247], a[36:39], v[68:71]
    v_mfma_f32_16x16x32_bf16 v[72:75], a[248:251], a[36:39], v[72:75]
    buffer_load_dwordx4 a[72:75], v1, s[4:7], s76 offen offset:3072 sc1
    v_mfma_f32_16x16x32_bf16 v[76:79], a[252:255], a[36:39], v[76:79]
    v_mfma_f32_16x16x32_bf16 v[80:83], v[252:255], a[36:39], v[80:83]
    s_waitcnt vmcnt(12)
    v_mfma_f32_16x16x32_bf16 v[44:47], a[160:163], a[40:43], 0
    v_mfma_f32_16x16x32_bf16 v[48:51], a[164:167], a[40:43], 0
    ds_write_b128 v41, v[64:67] offset:5120
    buffer_load_dwordx4 a[76:79], v2, s[4:7], s76 offen offset:0 sc1
    v_mfma_f32_16x16x32_bf16 v[52:55], a[168:171], a[40:43], 0
    v_mfma_f32_16x16x32_bf16 v[56:59], a[172:175], a[40:43], 0
    v_mfma_f32_16x16x32_bf16 v[60:63], a[176:179], a[40:43], 0
    s_waitcnt vmcnt(8)
    v_mfma_f32_16x16x32_bf16 v[44:47], a[180:183], a[44:47], v[44:47]
    ds_write_b128 v41, v[68:71] offset:6144
    s_add_u32 m0, s32, 131072
    s_add_u32 s60, s38, 65536
    buffer_load_dwordx4 v1, s[8:11], s60 offen offset:0 sc1 lds
    v_mfma_f32_16x16x32_bf16 v[48:51], a[184:187], a[44:47], v[48:51]
    v_mfma_f32_16x16x32_bf16 v[52:55], a[188:191], a[44:47], v[52:55]
    v_mfma_f32_16x16x32_bf16 v[56:59], a[192:195], a[44:47], v[56:59]
    v_mfma_f32_16x16x32_bf16 v[60:63], a[196:199], a[44:47], v[60:63]
    ds_write_b128 v41, v[72:75] offset:7168
    buffer_load_dwordx4 v1, s[8:11], s60 offen offset:1024 sc1 lds
    s_waitcnt vmcnt(9)
    v_mfma_f32_16x16x32_bf16 v[44:47], a[200:203], a[48:51], v[44:47]
    v_lshlrev_b32 v84, 16, v104
    v_and_b32 v85, 0xffff0000, v104
    v_mfma_f32_16x16x32_bf16 v[48:51], a[204:207], a[48:51], v[48:51]
    v_lshlrev_b32 v86, 16, v105
    v_and_b32 v87, 0xffff0000, v105
    v_mfma_f32_16x16x32_bf16 v[52:55], a[208:211], a[48:51], v[52:55]
    v_lshlrev_b32 v88, 16, v106
    v_and_b32 v89, 0xffff0000, v106
    v_mfma_f32_16x16x32_bf16 v[56:59], a[212:215], a[48:51], v[56:59]
    ds_write_b128 v41, v[76:79] offset:8192
    buffer_load_dwordx4 v1, s[8:11], s60 offen offset:2048 sc1 lds
    v_mfma_f32_16x16x32_bf16 v[60:63], a[216:219], a[48:51], v[60:63]
    v_lshlrev_b32 v90, 16, v107
    v_and_b32 v91, 0xffff0000, v107
    s_waitcnt vmcnt(9)
    v_mfma_f32_16x16x32_bf16 v[44:47], a[220:223], a[52:55], v[44:47]
    v_lshlrev_b32 v92, 16, v108
    v_and_b32 v93, 0xffff0000, v108
    v_mfma_f32_16x16x32_bf16 v[48:51], a[224:227], a[52:55], v[48:51]
    v_lshlrev_b32 v94, 16, v109
    v_and_b32 v95, 0xffff0000, v109
    v_mfma_f32_16x16x32_bf16 v[52:55], a[228:231], a[52:55], v[52:55]
    ds_write_b128 v41, v[80:83] offset:9216
    buffer_load_dwordx4 v1, s[8:11], s60 offen offset:3072 sc1 lds
    v_mfma_f32_16x16x32_bf16 v[56:59], a[232:235], a[52:55], v[56:59]
    v_lshlrev_b32 v96, 16, v110
    v_and_b32 v97, 0xffff0000, v110
    v_mfma_f32_16x16x32_bf16 v[60:63], a[236:239], a[52:55], v[60:63]
    v_lshlrev_b32 v98, 16, v111
    v_and_b32 v99, 0xffff0000, v111
    s_waitcnt vmcnt(9)
    v_mfma_f32_16x16x32_bf16 v[44:47], a[240:243], a[56:59], v[44:47]
    v_lshlrev_b32 v100, 16, v112
    v_and_b32 v101, 0xffff0000, v112
    v_mfma_f32_16x16x32_bf16 v[48:51], a[244:247], a[56:59], v[48:51]
    s_add_u32 m0, s32, 147456
    s_add_u32 s60, s38, 81920
    buffer_load_dwordx4 v1, s[8:11], s60 offen offset:0 sc1 lds
    v_mfma_f32_16x16x32_bf16 v[52:55], a[248:251], a[56:59], v[52:55]
    v_lshlrev_b32 v102, 16, v113
    v_and_b32 v103, 0xffff0000, v113
    v_mfma_f32_16x16x32_bf16 v[56:59], a[252:255], a[56:59], v[56:59]
    v_mfma_f32_16x16x32_bf16 v[60:63], v[252:255], a[56:59], v[60:63]
    s_waitcnt vmcnt(9)
    v_mfma_f32_16x16x32_bf16 v[64:67], a[160:163], a[60:63], 0
    buffer_load_dwordx4 v1, s[8:11], s60 offen offset:1024 sc1 lds
    v_mfma_f32_16x16x32_bf16 v[68:71], a[164:167], a[60:63], 0
    ds_write_b128 v42, v[44:47] offset:10240
    v_mfma_f32_16x16x32_bf16 v[72:75], a[168:171], a[60:63], 0
    v_mfma_f32_16x16x32_bf16 v[76:79], a[172:175], a[60:63], 0
    ds_write_b128 v42, v[48:51] offset:11264
    v_mfma_f32_16x16x32_bf16 v[80:83], a[176:179], a[60:63], 0
    buffer_load_dwordx4 v1, s[8:11], s60 offen offset:2048 sc1 lds
    s_waitcnt vmcnt(10)
    v_mfma_f32_16x16x32_bf16 v[64:67], a[180:183], a[64:67], v[64:67]
    ds_write_b128 v42, v[52:55] offset:12288
    v_mfma_f32_16x16x32_bf16 v[68:71], a[184:187], a[64:67], v[68:71]
    v_mfma_f32_16x16x32_bf16 v[72:75], a[188:191], a[64:67], v[72:75]
    ds_write_b128 v42, v[56:59] offset:13312
    v_mfma_f32_16x16x32_bf16 v[76:79], a[192:195], a[64:67], v[76:79]
    buffer_load_dwordx4 v1, s[8:11], s60 offen offset:3072 sc1 lds
    v_mfma_f32_16x16x32_bf16 v[80:83], a[196:199], a[64:67], v[80:83]
    ds_write_b128 v42, v[60:63] offset:14336
    s_waitcnt lgkmcnt(0)
    s_barrier
    s_waitcnt vmcnt(10)
    v_mfma_f32_16x16x32_bf16 v[64:67], a[200:203], a[68:71], v[64:67]
    ds_read_b128 v[104:107], v15 offset:0
    ds_read_b128 v[108:111], v15 offset:1024
    v_mfma_f32_16x16x32_bf16 v[68:71], a[204:207], a[68:71], v[68:71]
    ds_read_b128 v[112:115], v15 offset:2048
    ds_read_b128 v[116:119], v15 offset:3072
    v_mfma_f32_16x16x32_bf16 v[72:75], a[208:211], a[68:71], v[72:75]
    s_add_u32 s69, s40, 0
    s_cmp_lt_u32 s16, 2
    s_cselect_b32 s70, s69, 0x40000000
    buffer_load_dwordx4 v[144:147], v1, s[4:7], s70 offen offset:0 sc1
    v_mfma_f32_16x16x32_bf16 v[76:79], a[212:215], a[68:71], v[76:79]
    ds_read_b128 v[120:123], v15 offset:4096
    ds_read_b128 v[124:127], v15 offset:5120
    v_mfma_f32_16x16x32_bf16 v[80:83], a[216:219], a[68:71], v[80:83]
    ds_read_b128 v[128:131], v15 offset:6144
    ds_read_b128 v[132:135], v15 offset:7168
    s_waitcnt vmcnt(10)
    v_mfma_f32_16x16x32_bf16 v[64:67], a[220:223], a[72:75], v[64:67]
    ds_read_b128 v[136:139], v15 offset:8192
    ds_read_b128 v[140:143], v15 offset:9216
    v_mfma_f32_16x16x32_bf16 v[68:71], a[224:227], a[72:75], v[68:71]
    ds_read_b128 v[44:47], v15 offset:10240
    ds_read_b128 v[48:51], v15 offset:11264
    v_mfma_f32_16x16x32_bf16 v[72:75], a[228:231], a[72:75], v[72:75]
    ds_read_b128 v[52:55], v15 offset:12288
    ds_read_b128 v[56:59], v15 offset:13312
    v_mfma_f32_16x16x32_bf16 v[76:79], a[232:235], a[72:75], v[76:79]
    ds_read_b128 v[60:63], v15 offset:14336
    v_mfma_f32_16x16x32_bf16 v[80:83], a[236:239], a[72:75], v[80:83]
    s_waitcnt vmcnt(9)
    v_mfma_f32_16x16x32_bf16 v[64:67], a[240:243], a[76:79], v[64:67]
    v_mfma_f32_16x16x32_bf16 v[68:71], a[244:247], a[76:79], v[68:71]
    v_mfma_f32_16x16x32_bf16 v[72:75], a[248:251], a[76:79], v[72:75]
    v_mfma_f32_16x16x32_bf16 v[76:79], a[252:255], a[76:79], v[76:79]
    v_mfma_f32_16x16x32_bf16 v[80:83], v[252:255], a[76:79], v[80:83]
    s_waitcnt lgkmcnt(14)
    v_pk_add_f32 v[84:85], v[84:85], v[104:105]
    v_pk_add_f32 v[86:87], v[86:87], v[106:107]
    s_waitcnt lgkmcnt(13)
    v_pk_add_f32 v[88:89], v[88:89], v[108:109]
    v_pk_add_f32 v[90:91], v[90:91], v[110:111]
    s_waitcnt lgkmcnt(12)
    v_pk_add_f32 v[92:93], v[92:93], v[112:113]
    v_pk_add_f32 v[94:95], v[94:95], v[114:115]
    s_waitcnt lgkmcnt(11)
    v_pk_add_f32 v[96:97], v[96:97], v[116:117]
    v_pk_add_f32 v[98:99], v[98:99], v[118:119]
    s_waitcnt lgkmcnt(10)
    v_pk_add_f32 v[100:101], v[100:101], v[120:121]
    v_pk_add_f32 v[102:103], v[102:103], v[122:123]
    s_waitcnt lgkmcnt(9)
    v_pk_add_f32 v[84:85], v[84:85], v[124:125]
    v_pk_add_f32 v[86:87], v[86:87], v[126:127]
    s_waitcnt lgkmcnt(8)
    v_pk_add_f32 v[88:89], v[88:89], v[128:129]
    v_pk_add_f32 v[90:91], v[90:91], v[130:131]
    s_waitcnt lgkmcnt(7)
    v_pk_add_f32 v[92:93], v[92:93], v[132:133]
    v_pk_add_f32 v[94:95], v[94:95], v[134:135]
    s_waitcnt lgkmcnt(6)
    v_pk_add_f32 v[96:97], v[96:97], v[136:137]
    v_pk_add_f32 v[98:99], v[98:99], v[138:139]
    s_waitcnt lgkmcnt(5)
    v_pk_add_f32 v[100:101], v[100:101], v[140:141]
    v_pk_add_f32 v[102:103], v[102:103], v[142:143]
    s_waitcnt lgkmcnt(4)
    v_pk_add_f32 v[84:85], v[84:85], v[44:45]
    v_pk_add_f32 v[86:87], v[86:87], v[46:47]
    s_waitcnt lgkmcnt(3)
    v_pk_add_f32 v[88:89], v[88:89], v[48:49]
    v_pk_add_f32 v[90:91], v[90:91], v[50:51]
    s_waitcnt lgkmcnt(2)
    v_pk_add_f32 v[92:93], v[92:93], v[52:53]
    v_pk_add_f32 v[94:95], v[94:95], v[54:55]
    s_waitcnt lgkmcnt(1)
    v_pk_add_f32 v[96:97], v[96:97], v[56:57]
    v_pk_add_f32 v[98:99], v[98:99], v[58:59]
    s_waitcnt lgkmcnt(0)
    v_pk_add_f32 v[100:101], v[100:101], v[60:61]
    v_pk_add_f32 v[102:103], v[102:103], v[62:63]
    v_pk_add_f32 v[84:85], v[84:85], v[64:65]
    v_pk_add_f32 v[86:87], v[86:87], v[66:67]
    v_pk_add_f32 v[88:89], v[88:89], v[68:69]
    v_pk_add_f32 v[90:91], v[90:91], v[70:71]
    v_pk_add_f32 v[92:93], v[92:93], v[72:73]
    v_pk_add_f32 v[94:95], v[94:95], v[74:75]
    v_pk_add_f32 v[96:97], v[96:97], v[76:77]
    v_pk_add_f32 v[98:99], v[98:99], v[78:79]
    v_pk_add_f32 v[100:101], v[100:101], v[80:81]
    v_pk_add_f32 v[102:103], v[102:103], v[82:83]
    v_cvt_pk_bf16_f32 v104, v84, v85
    v_cvt_pk_bf16_f32 v105, v86, v87
    v_cvt_pk_bf16_f32 v106, v88, v89
    v_cvt_pk_bf16_f32 v107, v90, v91
    v_cvt_pk_bf16_f32 v108, v92, v93
    v_cvt_pk_bf16_f32 v109, v94, v95
    v_cvt_pk_bf16_f32 v110, v96, v97
    v_cvt_pk_bf16_f32 v111, v98, v99
    v_cvt_pk_bf16_f32 v112, v100, v101
    v_cvt_pk_bf16_f32 v113, v102, v103
    s_add_u32 s61, s41, 10362880
    s_add_u32 s62, s42, 12984320
    s_add_u32 s63, s43, 22847488
    buffer_store_dwordx4 v[104:107], v12, s[4:7], s61 offen
    buffer_store_dwordx4 v[108:111], v12, s[4:7], s61 offen offset:2048
    buffer_store_dwordx2 v[112:113], v13, s[4:7], s61 offen
    v_dot2_f32_bf16 v116, s30, v104, 0
    v_dot2_f32_bf16 v117, v104, v104, 0
    v_dot2_f32_bf16 v118, s30, v105, 0
    v_dot2_f32_bf16 v119, v105, v105, 0
    v_dot2c_f32_bf16 v116, s30, v106
    v_dot2c_f32_bf16 v117, v106, v106
    v_dot2c_f32_bf16 v118, s30, v107
    v_dot2c_f32_bf16 v119, v107, v107
    v_dot2c_f32_bf16 v116, s30, v108
    v_dot2c_f32_bf16 v117, v108, v108
    v_dot2c_f32_bf16 v118, s30, v109
    v_dot2c_f32_bf16 v119, v109, v109
    v_dot2c_f32_bf16 v116, s30, v110
    v_dot2c_f32_bf16 v117, v110, v110
    v_dot2c_f32_bf16 v118, s30, v111
    v_dot2c_f32_bf16 v119, v111, v111
    v_dot2c_f32_bf16 v116, s30, v112
    v_dot2c_f32_bf16 v117, v112, v112
    v_dot2c_f32_bf16 v118, s30, v113
    v_dot2c_f32_bf16 v119, v113, v113
    s_nop 2
    v_pk_add_f32 v[116:117], v[116:117], v[118:119]
    s_nop 1
    v_permlane32_swap_b32 v116, v117
    v_add_f32 v116, v116, v117
    v_mov_b32 v117, v116
    s_nop 1
    v_permlane16_swap_b32 v116, v117
    v_add_f32 v116, v116, v117
    buffer_store_dword v116, v14, s[4:7], s62 offen
    s_waitcnt vmcnt(0)
    s_cmp_lg_u32 s24, 0
    s_cbranch_scc1 pubf_20
    buffer_wbl2 sc1
    s_waitcnt vmcnt(0)
    buffer_store_dword v6, v5, s[4:7], s63 offen sc1
    s_branch pubd_21
pubf_20:
    buffer_store_dword v6, v5, s[4:7], s63 offen
pubd_21:
    s_barrier
    ds_read_b128 v[92:95], v38 offset:0
    ds_read_b128 v[96:99], v38 offset:1024
    ds_read_b128 v[100:103], v38 offset:2048
    ds_read_b128 v[104:107], v38 offset:3072
    ds_read_b128 v[108:111], v38 offset:4096
    s_add_u32 s61, s34, 10362880
    s_add_u32 s62, s35, 12984320
    s_add_u32 s63, s36, 22847488
    s_mov_b32 s31, 0
poll_22:
    buffer_load_dword v116, v7, s[4:7], s63 offen sc1
    s_add_u32 s31, s31, 1
    s_waitcnt vmcnt(0)
    v_cmp_eq_u32 vcc, -1, v116
    s_nop 0
    s_cbranch_vccz pok_23
    s_cmp_lt_u32 s31, 32768
    s_cbranch_scc1 poll_22
    s_endpgm
pok_23:
    s_cmp_lg_u32 s24, 0
    s_cbranch_scc1 pfast_24
    buffer_inv sc1
    s_waitcnt vmcnt(0)
pfast_24:
    buffer_load_dwordx4 a[0:3], v1, s[4:7], s61 offen offset:0 sc1
    buffer_load_dwordx4 a[4:7], v1, s[4:7], s61 offen offset:1024 sc1
    buffer_load_dwordx4 a[8:11], v1, s[4:7], s61 offen offset:2048 sc1
    buffer_load_dwordx4 a[12:15], v1, s[4:7], s61 offen offset:3072 sc1
    buffer_load_dwordx4 a[16:19], v2, s[4:7], s61 offen offset:0 sc1
    buffer_load_dwordx4 a[20:23], v2, s[4:7], s61 offen offset:1024 sc1
    buffer_load_dwordx4 a[24:27], v2, s[4:7], s61 offen offset:2048 sc1
    buffer_load_dwordx4 a[28:31], v2, s[4:7], s61 offen offset:3072 sc1
    s_waitcnt vmcnt(7) lgkmcnt(3)
    v_mfma_f32_32x32x16_bf16 v[44:59], v[92:95], a[0:3], 0
    ds_read_b128 v[112:115], v38 offset:5120
    buffer_load_dwordx4 a[32:35], v3, s[4:7], s61 offen offset:0 sc1
    v_mfma_f32_32x32x16_bf16 v[60:75], v[96:99], a[0:3], 0
    ds_read_b128 v[92:95], v38 offset:6144
    buffer_load_dwordx4 a[36:39], v3, s[4:7], s61 offen offset:1024 sc1
    s_waitcnt vmcnt(8) lgkmcnt(3)
    v_mfma_f32_32x32x16_bf16 v[44:59], v[100:103], a[4:7], v[44:59]
    ds_read_b128 v[96:99], v38 offset:7168
    buffer_load_dwordx4 a[40:43], v3, s[4:7], s61 offen offset:2048 sc1
    v_mfma_f32_32x32x16_bf16 v[60:75], v[104:107], a[4:7], v[60:75]
    ds_read_b128 v[100:103], v38 offset:8192
    buffer_load_dwordx4 a[44:47], v3, s[4:7], s61 offen offset:3072 sc1
    s_waitcnt vmcnt(9) lgkmcnt(3)
    v_mfma_f32_32x32x16_bf16 v[44:59], v[108:111], a[8:11], v[44:59]
    ds_read_b128 v[104:107], v38 offset:9216
    buffer_load_dwordx4 a[48:51], v4, s[4:7], s61 offen offset:0 sc1
    v_mfma_f32_32x32x16_bf16 v[60:75], v[112:115], a[8:11], v[60:75]
    ds_read_b128 v[108:111], v38 offset:10240
    buffer_load_dwordx4 a[52:55], v4, s[4:7], s61 offen offset:1024 sc1
    s_waitcnt vmcnt(10) lgkmcnt(3)
    v_mfma_f32_32x32x16_bf16 v[44:59], v[92:95], a[12:15], v[44:59]
    ds_read_b128 v[112:115], v38 offset:11264
    buffer_load_dwordx4 a[56:59], v4, s[4:7], s61 offen offset:2048 sc1
    v_mfma_f32_32x32x16_bf16 v[60:75], v[96:99], a[12:15], v[60:75]
    ds_read_b128 v[92:95], v38 offset:12288
    buffer_load_dwordx4 a[60:63], v4, s[4:7], s61 offen offset:3072 sc1
    s_waitcnt vmcnt(11) lgkmcnt(3)
    v_mfma_f32_32x32x16_bf16 v[44:59], v[100:103], a[16:19], v[44:59]
    ds_read_b128 v[96:99], v38 offset:13312
    s_add_u32 s61, s61, 16384
    buffer_load_dwordx4 a[64:67], v1, s[4:7], s61 offen offset:0 sc1
    v_mfma_f32_32x32x16_bf16 v[60:75], v[104:107], a[16:19], v[60:75]
    ds_read_b128 v[100:103], v38 offset:14336
    s_waitcnt vmcnt(11) lgkmcnt(3)
    v_mfma_f32_32x32x16_bf16 v[44:59], v[108:111], a[20:23], v[44:59]
    ds_read_b128 v[104:107], v38 offset:15360
    buffer_load_dwordx4 a[68:71], v1, s[4:7], s61 offen offset:1024 sc1
    v_mfma_f32_32x32x16_bf16 v[60:75], v[112:115], a[20:23], v[60:75]
    ds_read_b128 v[108:111], v38 offset:16384
    s_waitcnt vmcnt(11) lgkmcnt(3)
    v_mfma_f32_32x32x16_bf16 v[44:59], v[92:95], a[24:27], v[44:59]
    ds_read_b128 v[112:115], v38 offset:17408
    buffer_load_dwordx4 a[72:75], v1, s[4:7], s61 offen offset:2048 sc1
    v_mfma_f32_32x32x16_bf16 v[60:75], v[96:99], a[24:27], v[60:75]
    ds_read_b128 v[92:95], v38 offset:18432
    s_waitcnt vmcnt(11) lgkmcnt(3)
    v_mfma_f32_32x32x16_bf16 v[44:59], v[100:103], a[28:31], v[44:59]
    ds_read_b128 v[96:99], v38 offset:19456
    buffer_load_dwordx4 a[76:79], v1, s[4:7], s61 offen offset:3072 sc1
    v_mfma_f32_32x32x16_bf16 v[60:75], v[104:107], a[28:31], v[60:75]
    ds_read_b128 v[100:103], v38 offset:20480
    s_waitcnt vmcnt(11) lgkmcnt(3)
    v_mfma_f32_32x32x16_bf16 v[44:59], v[108:111], a[32:35], v[44:59]
    ds_read_b128 v[104:107], v38 offset:21504
    buffer_load_dwordx4 a[80:83], v2, s[4:7], s61 offen offset:0 sc1
    v_mfma_f32_32x32x16_bf16 v[60:75], v[112:115], a[32:35], v[60:75]
    ds_read_b128 v[108:111], v38 offset:22528
    s_waitcnt vmcnt(11) lgkmcnt(3)
    v_mfma_f32_32x32x16_bf16 v[44:59], v[92:95], a[36:39], v[44:59]
    ds_read_b128 v[112:115], v38 offset:23552
    buffer_load_dwordx4 a[84:87], v2, s[4:7], s61 offen offset:1024 sc1
    v_mfma_f32_32x32x16_bf16 v[60:75], v[96:99], a[36:39], v[60:75]
    ds_read_b128 v[92:95], v38 offset:24576
    s_waitcnt vmcnt(11) lgkmcnt(3)
    v_mfma_f32_32x32x16_bf16 v[44:59], v[100:103], a[40:43], v[44:59]
    ds_read_b128 v[96:99], v38 offset:25600
    buffer_load_dwordx4 a[88:91], v2, s[4:7], s61 offen offset:2048 sc1
    v_mfma_f32_32x32x16_bf16 v[60:75], v[104:107], a[40:43], v[60:75]
    ds_read_b128 v[100:103], v38 offset:26624
    s_waitcnt vmcnt(11) lgkmcnt(3)
    v_mfma_f32_32x32x16_bf16 v[44:59], v[108:111], a[44:47], v[44:59]
    ds_read_b128 v[104:107], v38 offset:27648
    buffer_load_dwordx4 a[92:95], v2, s[4:7], s61 offen offset:3072 sc1
    v_mfma_f32_32x32x16_bf16 v[60:75], v[112:115], a[44:47], v[60:75]
    ds_read_b128 v[108:111], v38 offset:28672
    s_waitcnt vmcnt(11) lgkmcnt(3)
    v_mfma_f32_32x32x16_bf16 v[44:59], v[92:95], a[48:51], v[44:59]
    ds_read_b128 v[112:115], v38 offset:29696
    buffer_load_dwordx4 a[96:99], v3, s[4:7], s61 offen offset:0 sc1
    v_mfma_f32_32x32x16_bf16 v[60:75], v[96:99], a[48:51], v[60:75]
    ds_read_b128 v[92:95], v38 offset:30720
    s_waitcnt vmcnt(11) lgkmcnt(3)
    v_mfma_f32_32x32x16_bf16 v[44:59], v[100:103], a[52:55], v[44:59]
    ds_read_b128 v[96:99], v38 offset:31744
    buffer_load_dwordx4 a[100:103], v3, s[4:7], s61 offen offset:1024 sc1
    v_mfma_f32_32x32x16_bf16 v[60:75], v[104:107], a[52:55], v[60:75]
    ds_read_b128 v[100:103], v38 offset:32768
    s_waitcnt vmcnt(11) lgkmcnt(3)
    v_mfma_f32_32x32x16_bf16 v[44:59], v[108:111], a[56:59], v[44:59]
    ds_read_b128 v[104:107], v38 offset:33792
    buffer_load_dwordx4 a[104:107], v3, s[4:7], s61 offen offset:2048 sc1
    v_mfma_f32_32x32x16_bf16 v[60:75], v[112:115], a[56:59], v[60:75]
    ds_read_b128 v[108:111], v38 offset:34816
    s_waitcnt vmcnt(11) lgkmcnt(3)
    v_mfma_f32_32x32x16_bf16 v[44:59], v[92:95], a[60:63], v[44:59]
    ds_read_b128 v[112:115], v38 offset:35840
    buffer_load_dwordx4 a[108:111], v3, s[4:7], s61 offen offset:3072 sc1
    v_mfma_f32_32x32x16_bf16 v[60:75], v[96:99], a[60:63], v[60:75]
    ds_read_b128 v[92:95], v38 offset:36864
    s_waitcnt vmcnt(11) lgkmcnt(3)
    v_mfma_f32_32x32x16_bf16 v[44:59], v[100:103], a[64:67], v[44:59]
    ds_read_b128 v[96:99], v38 offset:37888
    buffer_load_dwordx4 a[112:115], v4, s[4:7], s61 offen offset:0 sc1
    v_mfma_f32_32x32x16_bf16 v[60:75], v[104:107], a[64:67], v[60:75]
    ds_read_b128 v[100:103], v38 offset:38912
    s_waitcnt vmcnt(11) lgkmcnt(3)
    v_mfma_f32_32x32x16_bf16 v[44:59], v[108:111], a[68:71], v[44:59]
    ds_read_b128 v[104:107], v38 offset:39936
    buffer_load_dwordx4 a[116:119], v4, s[4:7], s61 offen offset:1024 sc1
    v_mfma_f32_32x32x16_bf16 v[60:75], v[112:115], a[68:71], v[60:75]
    ds_read_b128 v[108:111], v38 offset:40960
    s_waitcnt vmcnt(11) lgkmcnt(3)
    v_mfma_f32_32x32x16_bf16 v[44:59], v[92:95], a[72:75], v[44:59]
    ds_read_b128 v[112:115], v38 offset:41984
    buffer_load_dwordx4 a[120:123], v4, s[4:7], s61 offen offset:2048 sc1
    v_mfma_f32_32x32x16_bf16 v[60:75], v[96:99], a[72:75], v[60:75]
    ds_read_b128 v[92:95], v38 offset:43008
    s_waitcnt vmcnt(11) lgkmcnt(3)
    v_mfma_f32_32x32x16_bf16 v[44:59], v[100:103], a[76:79], v[44:59]
    ds_read_b128 v[96:99], v38 offset:44032
    buffer_load_dwordx4 a[124:127], v4, s[4:7], s61 offen offset:3072 sc1
    v_mfma_f32_32x32x16_bf16 v[60:75], v[104:107], a[76:79], v[60:75]
    ds_read_b128 v[100:103], v38 offset:45056
    s_waitcnt vmcnt(11) lgkmcnt(3)
    v_mfma_f32_32x32x16_bf16 v[44:59], v[108:111], a[80:83], v[44:59]
    ds_read_b128 v[104:107], v38 offset:46080
    s_add_u32 s61, s61, 16384
    buffer_load_dwordx4 a[128:131], v1, s[4:7], s61 offen offset:0 sc1
    v_mfma_f32_32x32x16_bf16 v[60:75], v[112:115], a[80:83], v[60:75]
    ds_read_b128 v[108:111], v38 offset:47104
    s_waitcnt vmcnt(11) lgkmcnt(3)
    v_mfma_f32_32x32x16_bf16 v[44:59], v[92:95], a[84:87], v[44:59]
    ds_read_b128 v[112:115], v38 offset:48128
    buffer_load_dwordx4 a[132:135], v1, s[4:7], s61 offen offset:1024 sc1
    v_mfma_f32_32x32x16_bf16 v[60:75], v[96:99], a[84:87], v[60:75]
    ds_read_b128 v[92:95], v38 offset:49152
    s_waitcnt vmcnt(11) lgkmcnt(3)
    v_mfma_f32_32x32x16_bf16 v[44:59], v[100:103], a[88:91], v[44:59]
    ds_read_b128 v[96:99], v38 offset:50176
    buffer_load_dwordx4 v[116:119], v10, s[4:7], s62 offen offset:0 sc1
    buffer_load_dwordx4 v[120:123], v10, s[4:7], s62 offen offset:512 sc1
    v_mfma_f32_32x32x16_bf16 v[60:75], v[104:107], a[88:91], v[60:75]
    ds_read_b128 v[100:103], v38 offset:51200
    s_waitcnt vmcnt(12) lgkmcnt(3)
    v_mfma_f32_32x32x16_bf16 v[44:59], v[108:111], a[92:95], v[44:59]
    ds_read_b128 v[104:107], v38 offset:52224
    buffer_load_dwordx4 a[136:139], v1, s[4:7], s61 offen offset:2048 sc1
    v_mfma_f32_32x32x16_bf16 v[60:75], v[112:115], a[92:95], v[60:75]
    ds_read_b128 v[108:111], v38 offset:53248
    s_waitcnt vmcnt(12) lgkmcnt(3)
    v_mfma_f32_32x32x16_bf16 v[44:59], v[92:95], a[96:99], v[44:59]
    ds_read_b128 v[112:115], v38 offset:54272
    buffer_load_dwordx4 a[140:143], v1, s[4:7], s61 offen offset:3072 sc1
    v_mfma_f32_32x32x16_bf16 v[60:75], v[96:99], a[96:99], v[60:75]
    ds_read_b128 v[92:95], v38 offset:55296
    s_waitcnt vmcnt(12) lgkmcnt(3)
    v_mfma_f32_32x32x16_bf16 v[44:59], v[100:103], a[100:103], v[44:59]
    ds_read_b128 v[96:99], v38 offset:56320
    buffer_load_dwordx4 a[144:147], v2, s[4:7], s61 offen offset:0 sc1
    v_mfma_f32_32x32x16_bf16 v[60:75], v[104:107], a[100:103], v[60:75]
    ds_read_b128 v[100:103], v38 offset:57344
    s_waitcnt vmcnt(12) lgkmcnt(3)
    v_mfma_f32_32x32x16_bf16 v[44:59], v[108:111], a[104:107], v[44:59]
    ds_read_b128 v[104:107], v38 offset:58368
    buffer_load_dwordx4 a[148:151], v2, s[4:7], s61 offen offset:1024 sc1
    v_mfma_f32_32x32x16_bf16 v[60:75], v[112:115], a[104:107], v[60:75]
    ds_read_b128 v[108:111], v38 offset:59392
    s_waitcnt vmcnt(12) lgkmcnt(3)
    v_mfma_f32_32x32x16_bf16 v[44:59], v[92:95], a[108:111], v[44:59]
    ds_read_b128 v[112:115], v38 offset:60416
    buffer_load_dwordx4 a[152:155], v2, s[4:7], s61 offen offset:2048 sc1
    v_mfma_f32_32x32x16_bf16 v[60:75], v[96:99], a[108:111], v[60:75]
    ds_read_b128 v[92:95], v38 offset:61440
    s_waitcnt vmcnt(12) lgkmcnt(3)
    v_mfma_f32_32x32x16_bf16 v[44:59], v[100:103], a[112:115], v[44:59]
    ds_read_b128 v[96:99], v38 offset:62464
    buffer_load_dwordx4 a[156:159], v2, s[4:7], s61 offen offset:3072 sc1
    v_mfma_f32_32x32x16_bf16 v[60:75], v[104:107], a[112:115], v[60:75]
    ds_read_b128 v[100:103], v38 offset:63488
    s_waitcnt vmcnt(12) lgkmcnt(3)
    v_mfma_f32_32x32x16_bf16 v[44:59], v[108:111], a[116:119], v[44:59]
    ds_read_b128 v[104:107], v38 offset:64512
    s_add_u32 m0, s32, 0
    s_add_u32 s60, s38, 98304
    buffer_load_dwordx4 v1, s[8:11], s60 offen offset:0 sc1 lds
    v_mfma_f32_32x32x16_bf16 v[60:75], v[112:115], a[116:119], v[60:75]
    ds_read_b128 v[108:111], v39 offset:0
    s_waitcnt vmcnt(12) lgkmcnt(3)
    v_mfma_f32_32x32x16_bf16 v[44:59], v[92:95], a[120:123], v[44:59]
    ds_read_b128 v[112:115], v39 offset:1024
    buffer_load_dwordx4 v1, s[8:11], s60 offen offset:1024 sc1 lds
    v_mfma_f32_32x32x16_bf16 v[60:75], v[96:99], a[120:123], v[60:75]
    ds_read_b128 v[92:95], v39 offset:2048
    s_waitcnt vmcnt(12) lgkmcnt(3)
    v_mfma_f32_32x32x16_bf16 v[44:59], v[100:103], a[124:127], v[44:59]
    ds_read_b128 v[96:99], v39 offset:3072
    buffer_load_dwordx4 v1, s[8:11], s60 offen offset:2048 sc1 lds
    s_waitcnt vmcnt(10)
    v_add_f32 v116, v116, v117
    v_add_f32 v117, v118, v119
    s_waitcnt vmcnt(9)
    v_add_f32 v120, v120, v121
    v_mfma_f32_32x32x16_bf16 v[60:75], v[104:107], a[124:127], v[60:75]
    ds_read_b128 v[100:103], v39 offset:4096
    v_add_f32 v121, v122, v123
    v_add_f32 v116, v116, v120
    v_add_f32 v117, v117, v121
    v_mov_b32 v118, v116
    s_waitcnt lgkmcnt(3)
    v_mfma_f32_32x32x16_bf16 v[44:59], v[108:111], a[128:131], v[44:59]
    ds_read_b128 v[104:107], v39 offset:5120
    buffer_load_dwordx4 v1, s[8:11], s60 offen offset:3072 sc1 lds
    v_mov_b32 v119, v117
    v_mov_b32 v134, 0
    v_permlane32_swap_b32 v116, v118
    v_permlane32_swap_b32 v117, v119
    v_mfma_f32_32x32x16_bf16 v[60:75], v[112:115], a[128:131], v[60:75]
    ds_read_b128 v[108:111], v39 offset:6144
    v_add_f32 v116, v116, v118
    v_add_f32 v117, v117, v119
    v_mul_f32 v116, 0x3acccccd, v116
    v_mul_f32 v117, 0x3acccccd, v117
    s_waitcnt lgkmcnt(3)
    v_mfma_f32_32x32x16_bf16 v[44:59], v[92:95], a[132:135], v[44:59]
    ds_read_b128 v[112:115], v39 offset:7168
    s_add_u32 m0, s32, 16384
    s_add_u32 s60, s38, 114688
    buffer_load_dwordx4 v1, s[8:11], s60 offen offset:0 sc1 lds
    v_fma_f32 v117, -v116, v116, v117
    v_max_f32 v117, 0, v117
    v_mfma_f32_32x32x16_bf16 v[60:75], v[96:99], a[132:135], v[60:75]
    ds_read_b128 v[92:95], v39 offset:8192
    v_add_f32 v138, 0x3727c5ac, v117
    v_rsq_f32 v136, v138
    v_cvt_pk_bf16_f32 v118, v116, v116
    s_waitcnt vmcnt(10) lgkmcnt(3)
    v_mfma_f32_32x32x16_bf16 v[44:59], v[100:103], a[136:139], v[44:59]
    ds_read_b128 v[96:99], v39 offset:9216
    buffer_load_dwordx4 v1, s[8:11], s60 offen offset:1024 sc1 lds
    v_lshlrev_b32 v119, 16, v118
    v_sub_f32 v119, v116, v119
    v_cvt_pk_bf16_f32 v118, v116, v119
    v_cndmask_b32 v132, v118, 0, s[26:27]
    v_mfma_f32_32x32x16_bf16 v[60:75], v[104:107], a[136:139], v[60:75]
    ds_read_b128 v[100:103], v39 offset:10240
    v_and_b32 v133, 0xffff, v132
    v_mov_b32 v135, 0
    v_mul_f32 v139, 0xc0135761, v136
    v_mul_f32 v140, v136, v136
    s_waitcnt vmcnt(10) lgkmcnt(3)
    v_mfma_f32_32x32x16_bf16 v[44:59], v[108:111], a[140:143], v[44:59]
    ds_read_b128 v[104:107], v39 offset:11264
    buffer_load_dwordx4 v1, s[8:11], s60 offen offset:2048 sc1 lds
    v_mul_f32 v140, v140, v136
    v_mul_f32 v140, 0xbdd2d3e8, v140
    v_mfma_f32_32x32x16_bf16 v[60:75], v[112:115], a[140:143], v[60:75]
    ds_read_b128 v[108:111], v39 offset:12288
    s_waitcnt vmcnt(10) lgkmcnt(3)
    v_mfma_f32_32x32x16_bf16 v[44:59], v[92:95], a[144:147], v[44:59]
    ds_read_b128 v[112:115], v39 offset:13312
    buffer_load_dwordx4 v1, s[8:11], s60 offen offset:3072 sc1 lds
    v_mfma_f32_32x32x16_bf16 v[60:75], v[96:99], a[144:147], v[60:75]
    ds_read_b128 v[92:95], v39 offset:14336
    s_waitcnt vmcnt(10) lgkmcnt(3)
    v_mfma_f32_32x32x16_bf16 v[44:59], v[100:103], a[148:151], v[44:59]
    ds_read_b128 v[96:99], v39 offset:15360
    buffer_load_dwordx4 v[148:151], v1, s[4:7], s70 offen offset:1024 sc1
    v_mfma_f32_32x32x16_bf16 v[60:75], v[104:107], a[148:151], v[60:75]
    ds_read_b128 v[100:103], v39 offset:16384
    s_waitcnt vmcnt(10) lgkmcnt(3)
    v_mfma_f32_32x32x16_bf16 v[44:59], v[108:111], a[152:155], v[44:59]
    ds_read_b128 v[104:107], v39 offset:17408
    buffer_load_dwordx4 v[152:155], v1, s[4:7], s70 offen offset:2048 sc1
    v_mfma_f32_32x32x16_bf16 v[60:75], v[112:115], a[152:155], v[60:75]
    ds_read_b128 v[108:111], v39 offset:18432
    s_waitcnt vmcnt(10) lgkmcnt(3)
    v_mfma_f32_32x32x16_bf16 v[44:59], v[92:95], a[156:159], v[44:59]
    ds_read_b128 v[112:115], v39 offset:19456
    s_add_u32 m0, s32, 32768
    s_add_u32 s60, s38, 131072
    buffer_load_dwordx4 v1, s[8:11], s60 offen offset:0 sc1 lds
    v_mfma_f32_32x32x16_bf16 v[60:75], v[96:99], a[156:159], v[60:75]
    ds_read_b128 v[92:95], v39 offset:20480
    v_mfma_f32_32x32x16_bf16 v[44:59], v[24:27], v[132:135], v[44:59]
    buffer_load_dwordx4 v[156:159], v1, s[4:7], s70 offen offset:3072 sc1
    v_mfma_f32_32x32x16_bf16 v[60:75], v[26:29], v[132:135], v[60:75]
    s_waitcnt lgkmcnt(3)
    v_mfma_f32_32x32x16_bf16 v[76:91], v[100:103], a[0:3], 0
    ds_read_b128 v[96:99], v39 offset:21504
    buffer_load_dwordx4 v1, s[8:11], s60 offen offset:1024 sc1 lds
    v_mfma_f32_32x32x16_bf16 v[76:91], v[104:107], a[4:7], v[76:91]
    ds_read_b128 v[100:103], v39 offset:22528
    s_waitcnt lgkmcnt(3)
    v_mfma_f32_32x32x16_bf16 v[76:91], v[108:111], a[8:11], v[76:91]
    ds_read_b128 v[104:107], v39 offset:23552
    buffer_load_dwordx4 v[160:163], v2, s[4:7], s70 offen offset:0 sc1
    v_mfma_f32_32x32x16_bf16 v[76:91], v[112:115], a[12:15], v[76:91]
    ds_read_b128 v[108:111], v39 offset:24576
    v_mul_f32 v116, v44, v44
    v_mul_f32 v117, v45, v45
    v_mul_f32 v118, v46, v46
    v_mul_f32 v119, v47, v47
    s_waitcnt lgkmcnt(3)
    v_mfma_f32_32x32x16_bf16 v[76:91], v[92:95], a[16:19], v[76:91]
    ds_read_b128 v[112:115], v39 offset:25600
    buffer_load_dwordx4 v1, s[8:11], s60 offen offset:2048 sc1 lds
    v_mul_f32 v120, v48, v48
    v_mul_f32 v121, v49, v49
    v_mul_f32 v122, v50, v50
    v_mul_f32 v123, v51, v51
    v_mfma_f32_32x32x16_bf16 v[76:91], v[96:99], a[20:23], v[76:91]
    ds_read_b128 v[92:95], v39 offset:26624
    v_fma_f32 v116, v116, v140, v139
    v_fma_f32 v117, v117, v140, v139
    v_fma_f32 v118, v118, v140, v139
    v_fma_f32 v119, v119, v140, v139
    s_waitcnt lgkmcnt(3)
    v_mfma_f32_32x32x16_bf16 v[76:91], v[100:103], a[24:27], v[76:91]
    ds_read_b128 v[96:99], v39 offset:27648
    buffer_load_dwordx4 v[164:167], v2, s[4:7], s69 offen offset:1024 sc1
    v_fma_f32 v120, v120, v140, v139
    v_fma_f32 v121, v121, v140, v139
    v_fma_f32 v122, v122, v140, v139
    v_fma_f32 v123, v123, v140, v139
    v_mfma_f32_32x32x16_bf16 v[76:91], v[104:107], a[28:31], v[76:91]
    ds_read_b128 v[100:103], v39 offset:28672
    v_mul_f32 v116, v116, v44
    v_mul_f32 v117, v117, v45
    v_mul_f32 v118, v118, v46
    v_mul_f32 v119, v119, v47
    s_waitcnt lgkmcnt(3)
    v_mfma_f32_32x32x16_bf16 v[76:91], v[108:111], a[32:35], v[76:91]
    ds_read_b128 v[104:107], v39 offset:29696
    buffer_load_dwordx4 v1, s[8:11], s60 offen offset:3072 sc1 lds
    v_mul_f32 v120, v120, v48
    v_mul_f32 v121, v121, v49
    v_mul_f32 v122, v122, v50
    v_mul_f32 v123, v123, v51
    v_mfma_f32_32x32x16_bf16 v[76:91], v[112:115], a[36:39], v[76:91]
    ds_read_b128 v[108:111], v39 offset:30720
    v_exp_f32 v116, v116
    s_waitcnt vmcnt(13)
    s_barrier
    s_waitcnt lgkmcnt(3)
    v_mfma_f32_32x32x16_bf16 v[76:91], v[92:95], a[40:43], v[76:91]
    ds_read_b128 v[112:115], v39 offset:31744
    buffer_load_dwordx4 v[168:171], v2, s[4:7], s69 offen offset:2048 sc1
    v_mul_f32 v52, v52, v44
    v_exp_f32 v117, v117
    v_mul_f32 v53, v53, v45
    v_mfma_f32_32x32x16_bf16 v[76:91], v[96:99], a[44:47], v[76:91]
    ds_read_b128 v[92:95], v1 offset:0
    v_exp_f32 v118, v118
    v_mul_f32 v54, v54, v46
    s_waitcnt lgkmcnt(3)
    v_mfma_f32_32x32x16_bf16 v[76:91], v[100:103], a[48:51], v[76:91]
    ds_read_b128 v[96:99], v1 offset:1024
    s_add_u32 m0, s32, 49152
    s_add_u32 s60, s38, 147456
    buffer_load_dwordx4 v1, s[8:11], s60 offen offset:0 sc1 lds
    v_exp_f32 v119, v119
    v_mfma_f32_32x32x16_bf16 v[76:91], v[104:107], a[52:55], v[76:91]
    ds_read_b128 v[100:103], v1 offset:2048
    v_mul_f32 v55, v55, v47
    v_exp_f32 v120, v120
    v_mul_f32 v56, v56, v48
    s_waitcnt lgkmcnt(3)
    v_mfma_f32_32x32x16_bf16 v[76:91], v[108:111], a[56:59], v[76:91]
    ds_read_b128 v[104:107], v1 offset:3072
    buffer_load_dwordx4 v[172:175], v2, s[4:7], s69 offen offset:3072 sc1
    v_exp_f32 v121, v121
    v_mul_f32 v57, v57, v49
    v_mfma_f32_32x32x16_bf16 v[76:91], v[112:115], a[60:63], v[76:91]
    ds_read_b128 v[108:111], v1 offset:4096
    v_exp_f32 v122, v122
    v_mul_f32 v58, v58, v50
    s_waitcnt lgkmcnt(3)
    v_mfma_f32_32x32x16_bf16 v[76:91], v[92:95], a[64:67], v[76:91]
    ds_read_b128 v[112:115], v1 offset:5120
    buffer_load_dwordx4 v1, s[8:11], s60 offen offset:1024 sc1 lds
    v_exp_f32 v123, v123
    v_mul_f32 v59, v59, v51
    v_fma_f32 v116, v116, v138, v138
    v_mfma_f32_32x32x16_bf16 v[76:91], v[96:99], a[68:71], v[76:91]
    ds_read_b128 v[92:95], v1 offset:6144
    v_fma_f32 v117, v117, v138, v138
    v_rcp_f32 v116, v116
    v_fma_f32 v118, v118, v138, v138
    s_waitcnt lgkmcnt(3)
    v_mfma_f32_32x32x16_bf16 v[76:91], v[100:103], a[72:75], v[76:91]
    ds_read_b128 v[96:99], v1 offset:7168
    buffer_load_dwordx4 v[176:179], v3, s[4:7], s69 offen offset:0 sc1
    v_rcp_f32 v117, v117
    v_fma_f32 v119, v119, v138, v138
    v_mfma_f32_32x32x16_bf16 v[76:91], v[104:107], a[76:79], v[76:91]
    ds_read_b128 v[100:103], v1 offset:8192
    v_rcp_f32 v118, v118
    v_fma_f32 v120, v120, v138, v138
    s_waitcnt lgkmcnt(3)
    v_mfma_f32_32x32x16_bf16 v[76:91], v[108:111], a[80:83], v[76:91]
    ds_read_b128 v[104:107], v1 offset:9216
    buffer_load_dwordx4 v1, s[8:11], s60 offen offset:2048 sc1 lds
    v_rcp_f32 v119, v119
    v_fma_f32 v121, v121, v138, v138
    v_mfma_f32_32x32x16_bf16 v[76:91], v[112:115], a[84:87], v[76:91]
    ds_read_b128 v[108:111], v1 offset:10240
    v_rcp_f32 v120, v120
    v_fma_f32 v122, v122, v138, v138
    s_waitcnt lgkmcnt(3)
    v_mfma_f32_32x32x16_bf16 v[76:91], v[92:95], a[88:91], v[76:91]
    ds_read_b128 v[112:115], v1 offset:11264
    buffer_load_dwordx4 v[180:183], v3, s[4:7], s69 offen offset:1024 sc1
    v_rcp_f32 v121, v121
    v_fma_f32 v123, v123, v138, v138
    v_mfma_f32_32x32x16_bf16 v[76:91], v[96:99], a[92:95], v[76:91]
    ds_read_b128 v[92:95], v1 offset:12288
    v_rcp_f32 v122, v122
    v_rcp_f32 v123, v123
    s_waitcnt lgkmcnt(3)
    v_mfma_f32_32x32x16_bf16 v[76:91], v[100:103], a[96:99], v[76:91]
    ds_read_b128 v[96:99], v1 offset:13312
    buffer_load_dwordx4 v1, s[8:11], s60 offen offset:3072 sc1 lds
    s_add_u32 s65, s46, 15736832
    v_mul_f32 v116, v116, v52
    v_mul_f32 v117, v117, v53
    v_cvt_pk_bf16_f32 v124, v116, v117
    v_mfma_f32_32x32x16_bf16 v[76:91], v[104:107], a[100:103], v[76:91]
    ds_read_b128 v[100:103], v1 offset:14336
    v_mul_f32 v118, v118, v54
    v_mul_f32 v119, v119, v55
    s_waitcnt vmcnt(17)
    s_barrier
    s_waitcnt lgkmcnt(3)
    v_mfma_f32_32x32x16_bf16 v[76:91], v[108:111], a[104:107], v[76:91]
    ds_read_b128 v[104:107], v1 offset:15360
    buffer_load_dwordx4 v[184:187], v3, s[4:7], s69 offen offset:2048 sc1
    v_cvt_pk_bf16_f32 v125, v118, v119
    v_mul_f32 v120, v120, v56
    v_mul_f32 v121, v121, v57
    v_cvt_pk_bf16_f32 v126, v120, v121
    v_mfma_f32_32x32x16_bf16 v[76:91], v[112:115], a[108:111], v[76:91]
    ds_read_b128 v[108:111], v1 offset:16384
    v_mul_f32 v122, v122, v58
    v_mul_f32 v123, v123, v59
    v_cvt_pk_bf16_f32 v127, v122, v123
    v_mul_f32 v116, v60, v60
    s_waitcnt lgkmcnt(3)
    v_mfma_f32_32x32x16_bf16 v[76:91], v[92:95], a[112:115], v[76:91]
    ds_read_b128 v[112:115], v1 offset:17408
    buffer_store_dwordx4 v[124:127], v11, s[4:7], s65 offen sc1
    v_mul_f32 v117, v61, v61
    v_mul_f32 v118, v62, v62
    v_mul_f32 v119, v63, v63
    v_mul_f32 v120, v64, v64
    v_mfma_f32_32x32x16_bf16 v[76:91], v[96:99], a[116:119], v[76:91]
    ds_read_b128 v[92:95], v1 offset:18432
    v_mul_f32 v121, v65, v65
    v_mul_f32 v122, v66, v66
    v_mul_f32 v123, v67, v67
    v_fma_f32 v116, v116, v140, v139
    s_waitcnt lgkmcnt(3)
    v_mfma_f32_32x32x16_bf16 v[76:91], v[100:103], a[120:123], v[76:91]
    ds_read_b128 v[96:99], v1 offset:19456
    s_add_u32 m0, s32, 65536
    s_add_u32 s60, s38, 163840
    buffer_load_dwordx4 v1, s[8:11], s60 offen offset:0 sc1 lds
    v_fma_f32 v117, v117, v140, v139
    v_fma_f32 v118, v118, v140, v139
    v_mfma_f32_32x32x16_bf16 v[76:91], v[104:107], a[124:127], v[76:91]
    ds_read_b128 v[100:103], v1 offset:20480
    v_fma_f32 v119, v119, v140, v139
    v_fma_f32 v120, v120, v140, v139
    v_fma_f32 v121, v121, v140, v139
    v_fma_f32 v122, v122, v140, v139
    s_waitcnt lgkmcnt(3)
    v_mfma_f32_32x32x16_bf16 v[76:91], v[108:111], a[128:131], v[76:91]
    ds_read_b128 v[104:107], v1 offset:21504
    buffer_load_dwordx4 v1, s[8:11], s60 offen offset:1024 sc1 lds
    v_fma_f32 v123, v123, v140, v139
    v_mul_f32 v116, v116, v60
    v_mul_f32 v117, v117, v61
    v_mul_f32 v118, v118, v62
    v_mfma_f32_32x32x16_bf16 v[76:91], v[112:115], a[132:135], v[76:91]
    ds_read_b128 v[108:111], v1 offset:22528
    v_mul_f32 v119, v119, v63
    v_mul_f32 v120, v120, v64
    v_mul_f32 v121, v121, v65
    v_mul_f32 v122, v122, v66
    s_waitcnt lgkmcnt(3)
    v_mfma_f32_32x32x16_bf16 v[76:91], v[92:95], a[136:139], v[76:91]
    ds_read_b128 v[112:115], v1 offset:23552
    buffer_load_dwordx4 v[188:191], v3, s[4:7], s69 offen offset:3072 sc1
    v_mul_f32 v123, v123, v67
    v_exp_f32 v116, v116
    v_mul_f32 v68, v68, v60
    v_mfma_f32_32x32x16_bf16 v[76:91], v[96:99], a[140:143], v[76:91]
    ds_read_b128 v[92:95], v1 offset:24576
    v_exp_f32 v117, v117
    v_mul_f32 v69, v69, v61
    s_waitcnt lgkmcnt(3)
    v_mfma_f32_32x32x16_bf16 v[76:91], v[100:103], a[144:147], v[76:91]
    ds_read_b128 v[96:99], v1 offset:25600
    buffer_load_dwordx4 v1, s[8:11], s60 offen offset:2048 sc1 lds
    v_exp_f32 v118, v118
    v_mul_f32 v70, v70, v62
    v_mfma_f32_32x32x16_bf16 v[76:91], v[104:107], a[148:151], v[76:91]
    ds_read_b128 v[100:103], v1 offset:26624
    v_exp_f32 v119, v119
    v_mul_f32 v71, v71, v63
    s_waitcnt lgkmcnt(3)
    v_mfma_f32_32x32x16_bf16 v[76:91], v[108:111], a[152:155], v[76:91]
    ds_read_b128 v[104:107], v1 offset:27648
    buffer_load_dwordx4 v[192:195], v4, s[4:7], s69 offen offset:0 sc1
    v_exp_f32 v120, v120
    v_mul_f32 v72, v72, v64
    v_mfma_f32_32x32x16_bf16 v[76:91], v[112:115], a[156:159], v[76:91]
    ds_read_b128 v[108:111], v1 offset:28672
    v_exp_f32 v121, v121
    v_mul_f32 v73, v73, v65
    v_exp_f32 v122, v122
    v_mfma_f32_32x32x16_bf16 v[76:91], v[28:31], v[132:135], v[76:91]
    buffer_load_dwordx4 v1, s[8:11], s60 offen offset:3072 sc1 lds
    v_mul_f32 v74, v74, v66
    v_exp_f32 v123, v123
    v_mul_f32 v75, v75, v67
    s_waitcnt lgkmcnt(3)
    v_mfma_f32_32x32x16_bf16 v[44:59], v[92:95], a[0:3], 0
    ds_read_b128 v[112:115], v1 offset:29696
    v_fma_f32 v116, v116, v138, v138
    v_fma_f32 v117, v117, v138, v138
    v_rcp_f32 v116, v116
    v_fma_f32 v118, v118, v138, v138
    v_mfma_f32_32x32x16_bf16 v[44:59], v[96:99], a[4:7], v[44:59]
    ds_read_b128 v[92:95], v1 offset:30720
    buffer_load_dwordx4 v[196:199], v4, s[4:7], s69 offen offset:1024 sc1
    s_waitcnt vmcnt(17)
    s_barrier
    s_waitcnt lgkmcnt(3)
    v_mfma_f32_32x32x16_bf16 v[44:59], v[100:103], a[8:11], v[44:59]
    ds_read_b128 v[96:99], v1 offset:31744
    v_rcp_f32 v117, v117
    v_fma_f32 v119, v119, v138, v138
    v_rcp_f32 v118, v118
    v_mfma_f32_32x32x16_bf16 v[44:59], v[104:107], a[12:15], v[44:59]
    ds_read_b128 v[100:103], v1 offset:32768
    s_add_u32 m0, s32, 81920
    s_add_u32 s60, s38, 180224
    buffer_load_dwordx4 v1, s[8:11], s60 offen offset:0 sc1 lds
    v_fma_f32 v120, v120, v138, v138
    s_waitcnt lgkmcnt(3)
    v_mfma_f32_32x32x16_bf16 v[44:59], v[108:111], a[16:19], v[44:59]
    ds_read_b128 v[104:107], v1 offset:33792
    v_rcp_f32 v119, v119
    v_fma_f32 v121, v121, v138, v138
    v_rcp_f32 v120, v120
    v_mfma_f32_32x32x16_bf16 v[44:59], v[112:115], a[20:23], v[44:59]
    ds_read_b128 v[108:111], v1 offset:34816
    buffer_load_dwordx4 v[200:203], v4, s[4:7], s69 offen offset:2048 sc1
    v_fma_f32 v122, v122, v138, v138
    v_rcp_f32 v121, v121
    s_waitcnt lgkmcnt(3)
    v_mfma_f32_32x32x16_bf16 v[44:59], v[92:95], a[24:27], v[44:59]
    ds_read_b128 v[112:115], v1 offset:35840
    v_fma_f32 v123, v123, v138, v138
    v_rcp_f32 v122, v122
    v_rcp_f32 v123, v123
    v_mfma_f32_32x32x16_bf16 v[44:59], v[96:99], a[28:31], v[44:59]
    ds_read_b128 v[92:95], v1 offset:36864
    buffer_load_dwordx4 v1, s[8:11], s60 offen offset:1024 sc1 lds
    s_add_u32 s65, s46, 15737344
    v_mul_f32 v116, v116, v68
    v_mul_f32 v117, v117, v69
    s_waitcnt lgkmcnt(3)
    v_mfma_f32_32x32x16_bf16 v[44:59], v[100:103], a[32:35], v[44:59]
    ds_read_b128 v[96:99], v1 offset:37888
    v_cvt_pk_bf16_f32 v128, v116, v117
    v_mul_f32 v118, v118, v70
    v_mul_f32 v119, v119, v71
    v_cvt_pk_bf16_f32 v129, v118, v119
    v_mul_f32 v120, v120, v72
    v_mfma_f32_32x32x16_bf16 v[44:59], v[104:107], a[36:39], v[44:59]
    ds_read_b128 v[100:103], v1 offset:38912
    buffer_load_dwordx4 v[204:207], v4, s[4:7], s69 offen offset:3072 sc1
    v_mul_f32 v121, v121, v73
    v_cvt_pk_bf16_f32 v130, v120, v121
    v_mul_f32 v122, v122, v74
    s_waitcnt lgkmcnt(3)
    v_mfma_f32_32x32x16_bf16 v[44:59], v[108:111], a[40:43], v[44:59]
    ds_read_b128 v[104:107], v1 offset:39936
    v_mul_f32 v123, v123, v75
    v_cvt_pk_bf16_f32 v131, v122, v123
    v_mul_f32 v116, v76, v76
    v_mul_f32 v117, v77, v77
    v_mul_f32 v118, v78, v78
    v_mfma_f32_32x32x16_bf16 v[44:59], v[112:115], a[44:47], v[44:59]
    ds_read_b128 v[108:111], v1 offset:40960
    buffer_store_dwordx4 v[128:131], v11, s[4:7], s65 offen sc1
    v_mul_f32 v119, v79, v79
    v_mul_f32 v120, v80, v80
    v_mul_f32 v121, v81, v81
    s_waitcnt lgkmcnt(3)
    v_mfma_f32_32x32x16_bf16 v[44:59], v[92:95], a[48:51], v[44:59]
    ds_read_b128 v[112:115], v1 offset:41984
    v_mul_f32 v122, v82, v82
    v_mul_f32 v123, v83, v83
    v_fma_f32 v116, v116, v140, v139
    v_fma_f32 v117, v117, v140, v139
    v_fma_f32 v118, v118, v140, v139
    v_mfma_f32_32x32x16_bf16 v[44:59], v[96:99], a[52:55], v[44:59]
    ds_read_b128 v[92:95], v1 offset:43008
    buffer_load_dwordx4 v1, s[8:11], s60 offen offset:2048 sc1 lds
    v_fma_f32 v119, v119, v140, v139
    v_fma_f32 v120, v120, v140, v139
    v_fma_f32 v121, v121, v140, v139
    s_waitcnt lgkmcnt(3)
    v_mfma_f32_32x32x16_bf16 v[44:59], v[100:103], a[56:59], v[44:59]
    ds_read_b128 v[96:99], v1 offset:44032
    v_fma_f32 v122, v122, v140, v139
    v_fma_f32 v123, v123, v140, v139
    v_mul_f32 v116, v116, v76
    v_mul_f32 v117, v117, v77
    v_mul_f32 v118, v118, v78
    v_mfma_f32_32x32x16_bf16 v[44:59], v[104:107], a[60:63], v[44:59]
    ds_read_b128 v[100:103], v1 offset:45056
    buffer_load_dwordx4 v1, s[8:11], s60 offen offset:3072 sc1 lds
    v_mul_f32 v119, v119, v79
    v_mul_f32 v120, v120, v80
    v_mul_f32 v121, v121, v81
    s_waitcnt lgkmcnt(3)
    v_mfma_f32_32x32x16_bf16 v[44:59], v[108:111], a[64:67], v[44:59]
    ds_read_b128 v[104:107], v1 offset:46080
    v_mul_f32 v122, v122, v82
    v_mul_f32 v123, v123, v83
    v_exp_f32 v116, v116
    v_mul_f32 v84, v84, v76
    v_mfma_f32_32x32x16_bf16 v[44:59], v[112:115], a[68:71], v[44:59]
    ds_read_b128 v[108:111], v1 offset:47104
    s_add_u32 s69, s40, 16384
    buffer_load_dwordx4 v[208:211], v1, s[4:7], s69 offen offset:0 sc1
    s_waitcnt vmcnt(17)
    s_barrier
    s_waitcnt lgkmcnt(3)
    v_mfma_f32_32x32x16_bf16 v[44:59], v[92:95], a[72:75], v[44:59]
    ds_read_b128 v[112:115], v1 offset:48128
    v_exp_f32 v117, v117
    v_mul_f32 v85, v85, v77
    v_exp_f32 v118, v118
    v_mfma_f32_32x32x16_bf16 v[44:59], v[96:99], a[76:79], v[44:59]
    ds_read_b128 v[92:95], v1 offset:49152
    s_add_u32 m0, s32, 98304
    s_add_u32 s60, s38, 196608
    buffer_load_dwordx4 v1, s[8:11], s60 offen offset:0 sc1 lds
    v_mul_f32 v86, v86, v78
    s_waitcnt lgkmcnt(3)
    v_mfma_f32_32x32x16_bf16 v[44:59], v[100:103], a[80:83], v[44:59]
    ds_read_b128 v[96:99], v1 offset:50176
    v_exp_f32 v119, v119
    v_mul_f32 v87, v87, v79
    v_exp_f32 v120, v120
    v_mfma_f32_32x32x16_bf16 v[44:59], v[104:107], a[84:87], v[44:59]
    ds_read_b128 v[100:103], v1 offset:51200
    buffer_load_dwordx4 v[212:215], v1, s[4:7], s69 offen offset:1024 sc1
    v_mul_f32 v88, v88, v80
    v_exp_f32 v121, v121
    s_waitcnt lgkmcnt(3)
    v_mfma_f32_32x32x16_bf16 v[44:59], v[108:111], a[88:91], v[44:59]
    ds_read_b128 v[104:107], v1 offset:52224
    v_mul_f32 v89, v89, v81
    v_exp_f32 v122, v122
    v_mul_f32 v90, v90, v82
    v_mfma_f32_32x32x16_bf16 v[44:59], v[112:115], a[92:95], v[44:59]
    ds_read_b128 v[108:111], v1 offset:53248
    buffer_load_dwordx4 v1, s[8:11], s60 offen offset:1024 sc1 lds
    v_exp_f32 v123, v123
    v_mul_f32 v91, v91, v83
    s_waitcnt lgkmcnt(3)
    v_mfma_f32_32x32x16_bf16 v[44:59], v[92:95], a[96:99], v[44:59]
    ds_read_b128 v[112:115], v1 offset:54272
    v_fma_f32 v116, v116, v138, v138
    v_fma_f32 v117, v117, v138, v138
    v_rcp_f32 v116, v116
    v_fma_f32 v118, v118, v138, v138
    v_mfma_f32_32x32x16_bf16 v[44:59], v[96:99], a[100:103], v[44:59]
    ds_read_b128 v[92:95], v1 offset:55296
    buffer_load_dwordx4 v[216:219], v1, s[4:7], s69 offen offset:2048 sc1
    v_rcp_f32 v117, v117
    v_fma_f32 v119, v119, v138, v138
    s_waitcnt lgkmcnt(3)
    v_mfma_f32_32x32x16_bf16 v[44:59], v[100:103], a[104:107], v[44:59]
    ds_read_b128 v[96:99], v1 offset:56320
    v_rcp_f32 v118, v118
    v_fma_f32 v120, v120, v138, v138
    v_rcp_f32 v119, v119
    v_mfma_f32_32x32x16_bf16 v[44:59], v[104:107], a[108:111], v[44:59]
    ds_read_b128 v[100:103], v1 offset:57344
    buffer_load_dwordx4 v1, s[8:11], s60 offen offset:2048 sc1 lds
    v_fma_f32 v121, v121, v138, v138
    v_rcp_f32 v120, v120
    s_waitcnt lgkmcnt(3)
    v_mfma_f32_32x32x16_bf16 v[44:59], v[108:111], a[112:115], v[44:59]
    ds_read_b128 v[104:107], v1 offset:58368
    v_fma_f32 v122, v122, v138, v138
    v_rcp_f32 v121, v121
    v_fma_f32 v123, v123, v138, v138
    v_mfma_f32_32x32x16_bf16 v[44:59], v[112:115], a[116:119], v[44:59]
    ds_read_b128 v[108:111], v1 offset:59392
    buffer_load_dwordx4 v[220:223], v1, s[4:7], s69 offen offset:3072 sc1
    v_rcp_f32 v122, v122
    s_waitcnt lgkmcnt(3)
    v_mfma_f32_32x32x16_bf16 v[44:59], v[92:95], a[120:123], v[44:59]
    ds_read_b128 v[112:115], v1 offset:60416
    v_rcp_f32 v123, v123
    s_add_u32 s65, s46, 15737856
    v_mul_f32 v116, v116, v84
    v_mul_f32 v117, v117, v85
    v_mfma_f32_32x32x16_bf16 v[44:59], v[96:99], a[124:127], v[44:59]
    ds_read_b128 v[92:95], v1 offset:61440
    buffer_load_dwordx4 v1, s[8:11], s60 offen offset:3072 sc1 lds
    v_cvt_pk_bf16_f32 v124, v116, v117
    v_mul_f32 v118, v118, v86
    v_mul_f32 v119, v119, v87
    s_waitcnt lgkmcnt(3)
    v_mfma_f32_32x32x16_bf16 v[44:59], v[100:103], a[128:131], v[44:59]
    ds_read_b128 v[96:99], v1 offset:62464
    v_cvt_pk_bf16_f32 v125, v118, v119
    v_mul_f32 v120, v120, v88
    v_mul_f32 v121, v121, v89
    v_cvt_pk_bf16_f32 v126, v120, v121
    v_mul_f32 v122, v122, v90
    v_mfma_f32_32x32x16_bf16 v[44:59], v[104:107], a[132:135], v[44:59]
    ds_read_b128 v[100:103], v1 offset:63488
    buffer_load_dwordx4 v[224:227], v2, s[4:7], s69 offen offset:0 sc1
    v_mul_f32 v123, v123, v91
    s_waitcnt vmcnt(17)
    s_barrier
    s_waitcnt lgkmcnt(3)
    v_mfma_f32_32x32x16_bf16 v[44:59], v[108:111], a[136:139], v[44:59]
    ds_read_b128 v[104:107], v1 offset:64512
    v_cvt_pk_bf16_f32 v127, v122, v123
    v_mfma_f32_32x32x16_bf16 v[44:59], v[112:115], a[140:143], v[44:59]
    ds_read_b128 v[108:111], v38 offset:0
    buffer_store_dwordx4 v[124:127], v11, s[4:7], s65 offen sc1
    s_waitcnt lgkmcnt(3)
    v_mfma_f32_32x32x16_bf16 v[44:59], v[92:95], a[144:147], v[44:59]
    ds_read_b128 v[112:115], v38 offset:1024
    v_mfma_f32_32x32x16_bf16 v[44:59], v[96:99], a[148:151], v[44:59]
    ds_read_b128 v[92:95], v38 offset:2048
    s_add_u32 m0, s32, 114688
    s_add_u32 s60, s38, 212992
    buffer_load_dwordx4 v1, s[8:11], s60 offen offset:0 sc1 lds
    s_waitcnt lgkmcnt(3)
    v_mfma_f32_32x32x16_bf16 v[44:59], v[100:103], a[152:155], v[44:59]
    ds_read_b128 v[96:99], v38 offset:3072
    v_mfma_f32_32x32x16_bf16 v[44:59], v[104:107], a[156:159], v[44:59]
    ds_read_b128 v[100:103], v38 offset:4096
    s_add_u32 s68, s45, 22880256
    buffer_load_dword v141, v5, s[4:7], s68 offen sc1
    s_add_u32 s68, s45, 22888448
    buffer_load_dword v141, v5, s[4:7], s68 offen sc1
    v_mfma_f32_32x32x16_bf16 v[44:59], v[30:33], v[132:135], v[44:59]
    s_waitcnt lgkmcnt(3)
    v_mfma_f32_32x32x16_bf16 v[60:75], v[108:111], a[0:3], 0
    ds_read_b128 v[104:107], v38 offset:5120
    buffer_load_dwordx4 v1, s[8:11], s60 offen offset:1024 sc1 lds
    v_mfma_f32_32x32x16_bf16 v[60:75], v[112:115], a[4:7], v[60:75]
    ds_read_b128 v[108:111], v38 offset:6144
    s_waitcnt lgkmcnt(3)
    v_mfma_f32_32x32x16_bf16 v[60:75], v[92:95], a[8:11], v[60:75]
    ds_read_b128 v[112:115], v38 offset:7168
    buffer_load_dwordx4 v[228:231], v2, s[4:7], s69 offen offset:1024 sc1
    v_mfma_f32_32x32x16_bf16 v[60:75], v[96:99], a[12:15], v[60:75]
    ds_read_b128 v[92:95], v38 offset:8192
    v_mul_f32 v116, v44, v44
    v_mul_f32 v117, v45, v45
    v_mul_f32 v118, v46, v46
    v_mul_f32 v119, v47, v47
    s_waitcnt lgkmcnt(3)
    v_mfma_f32_32x32x16_bf16 v[60:75], v[100:103], a[16:19], v[60:75]
    ds_read_b128 v[96:99], v38 offset:9216
    buffer_load_dwordx4 v1, s[8:11], s60 offen offset:2048 sc1 lds
    v_mul_f32 v120, v48, v48
    v_mul_f32 v121, v49, v49
    v_mul_f32 v122, v50, v50
    v_mul_f32 v123, v51, v51
    v_mfma_f32_32x32x16_bf16 v[60:75], v[104:107], a[20:23], v[60:75]
    ds_read_b128 v[100:103], v38 offset:10240
    v_fma_f32 v116, v116, v140, v139
    v_fma_f32 v117, v117, v140, v139
    v_fma_f32 v118, v118, v140, v139
    v_fma_f32 v119, v119, v140, v139
    s_waitcnt lgkmcnt(3)
    v_mfma_f32_32x32x16_bf16 v[60:75], v[108:111], a[24:27], v[60:75]
    ds_read_b128 v[104:107], v38 offset:11264
    buffer_load_dwordx4 v[232:235], v2, s[4:7], s69 offen offset:2048 sc1
    v_fma_f32 v120, v120, v140, v139
    v_fma_f32 v121, v121, v140, v139
    v_fma_f32 v122, v122, v140, v139
    v_fma_f32 v123, v123, v140, v139
    v_mfma_f32_32x32x16_bf16 v[60:75], v[112:115], a[28:31], v[60:75]
    ds_read_b128 v[108:111], v38 offset:12288
    v_mul_f32 v116, v116, v44
    v_mul_f32 v117, v117, v45
    v_mul_f32 v118, v118, v46
    v_mul_f32 v119, v119, v47
    s_waitcnt lgkmcnt(3)
    v_mfma_f32_32x32x16_bf16 v[60:75], v[92:95], a[32:35], v[60:75]
    ds_read_b128 v[112:115], v38 offset:13312
    buffer_load_dwordx4 v1, s[8:11], s60 offen offset:3072 sc1 lds
    v_mul_f32 v120, v120, v48
    v_mul_f32 v121, v121, v49
    v_mul_f32 v122, v122, v50
    v_mul_f32 v123, v123, v51
    v_mfma_f32_32x32x16_bf16 v[60:75], v[96:99], a[36:39], v[60:75]
    ds_read_b128 v[92:95], v38 offset:14336
    v_exp_f32 v116, v116
    s_waitcnt vmcnt(18)
    s_barrier
    s_waitcnt lgkmcnt(3)
    v_mfma_f32_32x32x16_bf16 v[60:75], v[100:103], a[40:43], v[60:75]
    ds_read_b128 v[96:99], v38 offset:15360
    buffer_load_dwordx4 v[236:239], v2, s[4:7], s69 offen offset:3072 sc1
    v_mul_f32 v52, v52, v44
    v_exp_f32 v117, v117
    v_mul_f32 v53, v53, v45
    v_mfma_f32_32x32x16_bf16 v[60:75], v[104:107], a[44:47], v[60:75]
    ds_read_b128 v[100:103], v38 offset:16384
    v_exp_f32 v118, v118
    v_mul_f32 v54, v54, v46
    s_waitcnt lgkmcnt(3)
    v_mfma_f32_32x32x16_bf16 v[60:75], v[108:111], a[48:51], v[60:75]
    ds_read_b128 v[104:107], v38 offset:17408
    s_add_u32 m0, s32, 131072
    s_add_u32 s60, s38, 229376
    buffer_load_dwordx4 v1, s[8:11], s60 offen offset:0 sc1 lds
    v_exp_f32 v119, v119
    v_mfma_f32_32x32x16_bf16 v[60:75], v[112:115], a[52:55], v[60:75]
    ds_read_b128 v[108:111], v38 offset:18432
    v_mul_f32 v55, v55, v47
    v_exp_f32 v120, v120
    v_mul_f32 v56, v56, v48
    s_waitcnt lgkmcnt(3)
    v_mfma_f32_32x32x16_bf16 v[60:75], v[92:95], a[56:59], v[60:75]
    ds_read_b128 v[112:115], v38 offset:19456
    buffer_load_dwordx4 v[240:243], v3, s[4:7], s69 offen offset:0 sc1
    v_exp_f32 v121, v121
    v_mul_f32 v57, v57, v49
    v_mfma_f32_32x32x16_bf16 v[60:75], v[96:99], a[60:63], v[60:75]
    ds_read_b128 v[92:95], v38 offset:20480
    v_exp_f32 v122, v122
    v_mul_f32 v58, v58, v50
    s_waitcnt lgkmcnt(3)
    v_mfma_f32_32x32x16_bf16 v[60:75], v[100:103], a[64:67], v[60:75]
    ds_read_b128 v[96:99], v38 offset:21504
    buffer_load_dwordx4 v1, s[8:11], s60 offen offset:1024 sc1 lds
    v_exp_f32 v123, v123
    v_mul_f32 v59, v59, v51
    v_fma_f32 v116, v116, v138, v138
    v_mfma_f32_32x32x16_bf16 v[60:75], v[104:107], a[68:71], v[60:75]
    ds_read_b128 v[100:103], v38 offset:22528
    v_fma_f32 v117, v117, v138, v138
    v_rcp_f32 v116, v116
    v_fma_f32 v118, v118, v138, v138
    s_waitcnt lgkmcnt(3)
    v_mfma_f32_32x32x16_bf16 v[60:75], v[108:111], a[72:75], v[60:75]
    ds_read_b128 v[104:107], v38 offset:23552
    buffer_load_dwordx4 v[244:247], v3, s[4:7], s69 offen offset:1024 sc1
    v_rcp_f32 v117, v117
    v_fma_f32 v119, v119, v138, v138
    v_mfma_f32_32x32x16_bf16 v[60:75], v[112:115], a[76:79], v[60:75]
    ds_read_b128 v[108:111], v38 offset:24576
    v_rcp_f32 v118, v118
    v_fma_f32 v120, v120, v138, v138
    s_waitcnt lgkmcnt(3)
    v_mfma_f32_32x32x16_bf16 v[60:75], v[92:95], a[80:83], v[60:75]
    ds_read_b128 v[112:115], v38 offset:25600
    buffer_load_dwordx4 v1, s[8:11], s60 offen offset:2048 sc1 lds
    v_rcp_f32 v119, v119
    v_fma_f32 v121, v121, v138, v138
    v_mfma_f32_32x32x16_bf16 v[60:75], v[96:99], a[84:87], v[60:75]
    ds_read_b128 v[92:95], v38 offset:26624
    v_rcp_f32 v120, v120
    v_fma_f32 v122, v122, v138, v138
    s_waitcnt lgkmcnt(3)
    v_mfma_f32_32x32x16_bf16 v[60:75], v[100:103], a[88:91], v[60:75]
    ds_read_b128 v[96:99], v38 offset:27648
    buffer_load_dwordx4 v[248:251], v3, s[4:7], s69 offen offset:2048 sc1
    v_rcp_f32 v121, v121
    v_fma_f32 v123, v123, v138, v138
    v_mfma_f32_32x32x16_bf16 v[60:75], v[104:107], a[92:95], v[60:75]
    ds_read_b128 v[100:103], v38 offset:28672
    v_rcp_f32 v122, v122
    v_rcp_f32 v123, v123
    s_waitcnt lgkmcnt(3)
    v_mfma_f32_32x32x16_bf16 v[60:75], v[108:111], a[96:99], v[60:75]
    ds_read_b128 v[104:107], v38 offset:29696
    buffer_load_dwordx4 v1, s[8:11], s60 offen offset:3072 sc1 lds
    s_add_u32 s65, s55, 15738368
    v_mul_f32 v116, v116, v52
    v_mul_f32 v117, v117, v53
    v_cvt_pk_bf16_f32 v128, v116, v117
    v_mfma_f32_32x32x16_bf16 v[60:75], v[112:115], a[100:103], v[60:75]
    ds_read_b128 v[108:111], v38 offset:30720
    v_mul_f32 v118, v118, v54
    v_mul_f32 v119, v119, v55
    s_waitcnt vmcnt(18)
    s_barrier
    s_waitcnt lgkmcnt(3)
    v_mfma_f32_32x32x16_bf16 v[60:75], v[92:95], a[104:107], v[60:75]
    ds_read_b128 v[112:115], v38 offset:31744
    s_add_u32 s71, s40, 16384
    buffer_load_dwordx4 a[160:163], v3, s[4:7], s71 offen offset:3072 sc1
    v_cvt_pk_bf16_f32 v129, v118, v119
    v_mul_f32 v120, v120, v56
    v_mul_f32 v121, v121, v57
    v_mfma_f32_32x32x16_bf16 v[60:75], v[96:99], a[108:111], v[60:75]
    ds_read_b128 v[92:95], v38 offset:32768
    v_cvt_pk_bf16_f32 v130, v120, v121
    v_mul_f32 v122, v122, v58
    v_mul_f32 v123, v123, v59
    v_cvt_pk_bf16_f32 v131, v122, v123
    s_waitcnt lgkmcnt(3)
    v_mfma_f32_32x32x16_bf16 v[60:75], v[100:103], a[112:115], v[60:75]
    ds_read_b128 v[96:99], v38 offset:33792
    s_add_u32 m0, s32, 147456
    s_add_u32 s60, s38, 245760
    buffer_load_dwordx4 v1, s[8:11], s60 offen offset:0 sc1 lds
    v_mfma_f32_32x32x16_bf16 v[60:75], v[104:107], a[116:119], v[60:75]
    ds_read_b128 v[100:103], v38 offset:34816
    s_waitcnt lgkmcnt(3)
    v_mfma_f32_32x32x16_bf16 v[60:75], v[108:111], a[120:123], v[60:75]
    ds_read_b128 v[104:107], v38 offset:35840
    buffer_store_dwordx4 v[128:131], v11, s[4:7], s65 offen sc1
    v_mfma_f32_32x32x16_bf16 v[60:75], v[112:115], a[124:127], v[60:75]
    ds_read_b128 v[108:111], v38 offset:36864
    s_waitcnt lgkmcnt(3)
    v_mfma_f32_32x32x16_bf16 v[60:75], v[92:95], a[128:131], v[60:75]
    ds_read_b128 v[112:115], v38 offset:37888
    buffer_load_dwordx4 v1, s[8:11], s60 offen offset:1024 sc1 lds
    v_mfma_f32_32x32x16_bf16 v[60:75], v[96:99], a[132:135], v[60:75]
    ds_read_b128 v[92:95], v38 offset:38912
    s_waitcnt lgkmcnt(3)
    v_mfma_f32_32x32x16_bf16 v[60:75], v[100:103], a[136:139], v[60:75]
    ds_read_b128 v[96:99], v38 offset:39936
    buffer_load_dwordx4 a[164:167], v4, s[4:7], s71 offen offset:0 sc1
    v_mfma_f32_32x32x16_bf16 v[60:75], v[104:107], a[140:143], v[60:75]
    ds_read_b128 v[100:103], v38 offset:40960
    s_waitcnt lgkmcnt(3)
    v_mfma_f32_32x32x16_bf16 v[60:75], v[108:111], a[144:147], v[60:75]
    ds_read_b128 v[104:107], v38 offset:41984
    buffer_load_dwordx4 v1, s[8:11], s60 offen offset:2048 sc1 lds
    v_mfma_f32_32x32x16_bf16 v[60:75], v[112:115], a[148:151], v[60:75]
    ds_read_b128 v[108:111], v38 offset:43008
    s_waitcnt lgkmcnt(3)
    v_mfma_f32_32x32x16_bf16 v[60:75], v[92:95], a[152:155], v[60:75]
    ds_read_b128 v[112:115], v38 offset:44032
    buffer_load_dwordx4 a[168:171], v4, s[4:7], s71 offen offset:1024 sc1
    v_mfma_f32_32x32x16_bf16 v[60:75], v[96:99], a[156:159], v[60:75]
    ds_read_b128 v[92:95], v38 offset:45056
    v_mfma_f32_32x32x16_bf16 v[60:75], v[32:35], v[132:135], v[60:75]
    buffer_load_dwordx4 v1, s[8:11], s60 offen offset:3072 sc1 lds
    s_waitcnt lgkmcnt(3)
    v_mfma_f32_32x32x16_bf16 v[76:91], v[100:103], a[0:3], 0
    ds_read_b128 v[96:99], v38 offset:46080
    v_mfma_f32_32x32x16_bf16 v[76:91], v[104:107], a[4:7], v[76:91]
    ds_read_b128 v[100:103], v38 offset:47104
    buffer_load_dwordx4 a[172:175], v4, s[4:7], s71 offen offset:2048 sc1
    s_waitcnt vmcnt(17)
    s_barrier
    s_waitcnt lgkmcnt(3)
    v_mfma_f32_32x32x16_bf16 v[76:91], v[108:111], a[8:11], v[76:91]
    ds_read_b128 v[104:107], v38 offset:48128
    v_mfma_f32_32x32x16_bf16 v[76:91], v[112:115], a[12:15], v[76:91]
    ds_read_b128 v[108:111], v38 offset:49152
    s_add_u32 m0, s32, 0
    s_add_u32 s60, s38, 262144
    buffer_load_dwordx4 v1, s[8:11], s60 offen offset:0 sc1 lds
    v_mul_f32 v116, v60, v60
    s_waitcnt lgkmcnt(3)
    v_mfma_f32_32x32x16_bf16 v[76:91], v[92:95], a[16:19], v[76:91]
    ds_read_b128 v[112:115], v38 offset:50176
    v_mul_f32 v117, v61, v61
    v_mul_f32 v118, v62, v62
    v_mul_f32 v119, v63, v63
    v_mul_f32 v120, v64, v64
    v_mul_f32 v121, v65, v65
    v_mfma_f32_32x32x16_bf16 v[76:91], v[96:99], a[20:23], v[76:91]
    ds_read_b128 v[92:95], v38 offset:51200
    buffer_load_dwordx4 a[176:179], v4, s[4:7], s71 offen offset:3072 sc1
    v_mul_f32 v122, v66, v66
    v_mul_f32 v123, v67, v67
    v_fma_f32 v116, v116, v140, v139
    s_waitcnt lgkmcnt(3)
    v_mfma_f32_32x32x16_bf16 v[76:91], v[100:103], a[24:27], v[76:91]
    ds_read_b128 v[96:99], v38 offset:52224
    v_fma_f32 v117, v117, v140, v139
    v_fma_f32 v118, v118, v140, v139
    v_fma_f32 v119, v119, v140, v139
    v_fma_f32 v120, v120, v140, v139
    v_fma_f32 v121, v121, v140, v139
    v_mfma_f32_32x32x16_bf16 v[76:91], v[104:107], a[28:31], v[76:91]
    ds_read_b128 v[100:103], v38 offset:53248
    buffer_load_dwordx4 v1, s[8:11], s60 offen offset:1024 sc1 lds
    v_fma_f32 v122, v122, v140, v139
    v_fma_f32 v123, v123, v140, v139
    v_mul_f32 v116, v116, v60
    s_waitcnt lgkmcnt(3)
    v_mfma_f32_32x32x16_bf16 v[76:91], v[108:111], a[32:35], v[76:91]
    ds_read_b128 v[104:107], v38 offset:54272
    v_mul_f32 v117, v117, v61
    v_mul_f32 v118, v118, v62
    v_mul_f32 v119, v119, v63
    v_mul_f32 v120, v120, v64
    v_mul_f32 v121, v121, v65
    v_mfma_f32_32x32x16_bf16 v[76:91], v[112:115], a[36:39], v[76:91]
    ds_read_b128 v[108:111], v38 offset:55296
    s_add_u32 s71, s40, 32768
    buffer_load_dwordx4 a[180:183], v1, s[4:7], s71 offen offset:0 sc1
    v_mul_f32 v122, v122, v66
    v_mul_f32 v123, v123, v67
    s_waitcnt lgkmcnt(3)
    v_mfma_f32_32x32x16_bf16 v[76:91], v[92:95], a[40:43], v[76:91]
    ds_read_b128 v[112:115], v38 offset:56320
    v_exp_f32 v116, v116
    v_mul_f32 v68, v68, v60
    v_exp_f32 v117, v117
    v_mfma_f32_32x32x16_bf16 v[76:91], v[96:99], a[44:47], v[76:91]
    ds_read_b128 v[92:95], v38 offset:57344
    buffer_load_dwordx4 v1, s[8:11], s60 offen offset:2048 sc1 lds
    v_mul_f32 v69, v69, v61
    v_exp_f32 v118, v118
    s_waitcnt lgkmcnt(3)
    v_mfma_f32_32x32x16_bf16 v[76:91], v[100:103], a[48:51], v[76:91]
    ds_read_b128 v[96:99], v38 offset:58368
    v_mul_f32 v70, v70, v62
    v_exp_f32 v119, v119
    v_mul_f32 v71, v71, v63
    v_mfma_f32_32x32x16_bf16 v[76:91], v[104:107], a[52:55], v[76:91]
    ds_read_b128 v[100:103], v38 offset:59392
    buffer_load_dwordx4 a[184:187], v1, s[4:7], s71 offen offset:1024 sc1
    v_exp_f32 v120, v120
    v_mul_f32 v72, v72, v64
    s_waitcnt lgkmcnt(3)
    v_mfma_f32_32x32x16_bf16 v[76:91], v[108:111], a[56:59], v[76:91]
    ds_read_b128 v[104:107], v38 offset:60416
    v_exp_f32 v121, v121
    v_mul_f32 v73, v73, v65
    v_exp_f32 v122, v122
    v_mfma_f32_32x32x16_bf16 v[76:91], v[112:115], a[60:63], v[76:91]
    ds_read_b128 v[108:111], v38 offset:61440
    buffer_load_dwordx4 v1, s[8:11], s60 offen offset:3072 sc1 lds
    v_mul_f32 v74, v74, v66
    v_exp_f32 v123, v123
    s_waitcnt lgkmcnt(3)
    v_mfma_f32_32x32x16_bf16 v[76:91], v[92:95], a[64:67], v[76:91]
    ds_read_b128 v[112:115], v38 offset:62464
    v_mul_f32 v75, v75, v67
    v_fma_f32 v116, v116, v138, v138
    v_fma_f32 v117, v117, v138, v138
    v_rcp_f32 v116, v116
    v_mfma_f32_32x32x16_bf16 v[76:91], v[96:99], a[68:71], v[76:91]
    ds_read_b128 v[92:95], v38 offset:63488
    buffer_load_dwordx4 a[188:191], v1, s[4:7], s71 offen offset:2048 sc1
    v_fma_f32 v118, v118, v138, v138
    s_waitcnt vmcnt(17)
    s_barrier
    s_waitcnt lgkmcnt(3)
    v_mfma_f32_32x32x16_bf16 v[76:91], v[100:103], a[72:75], v[76:91]
    ds_read_b128 v[96:99], v38 offset:64512
    v_rcp_f32 v117, v117
    v_fma_f32 v119, v119, v138, v138
    v_rcp_f32 v118, v118
    v_mfma_f32_32x32x16_bf16 v[76:91], v[104:107], a[76:79], v[76:91]
    ds_read_b128 v[100:103], v39 offset:0
    buffer_load_dwordx4 a[192:195], v1, s[4:7], s71 offen offset:3072 sc1
    v_fma_f32 v120, v120, v138, v138
    v_rcp_f32 v119, v119
    s_waitcnt lgkmcnt(3)
    v_mfma_f32_32x32x16_bf16 v[76:91], v[108:111], a[80:83], v[76:91]
    ds_read_b128 v[104:107], v39 offset:1024
    v_fma_f32 v121, v121, v138, v138
    v_rcp_f32 v120, v120
    v_fma_f32 v122, v122, v138, v138
    v_mfma_f32_32x32x16_bf16 v[76:91], v[112:115], a[84:87], v[76:91]
    ds_read_b128 v[108:111], v39 offset:2048
    buffer_load_dwordx4 a[196:199], v2, s[4:7], s71 offen offset:0 sc1
    v_rcp_f32 v121, v121
    v_fma_f32 v123, v123, v138, v138
    s_waitcnt lgkmcnt(3)
    v_mfma_f32_32x32x16_bf16 v[76:91], v[92:95], a[88:91], v[76:91]
    ds_read_b128 v[112:115], v39 offset:3072
    v_rcp_f32 v122, v122
    v_rcp_f32 v123, v123
    s_add_u32 s65, s55, 15738880
    v_mfma_f32_32x32x16_bf16 v[76:91], v[96:99], a[92:95], v[76:91]
    ds_read_b128 v[92:95], v39 offset:4096
    buffer_load_dwordx4 a[200:203], v2, s[4:7], s71 offen offset:1024 sc1
    v_mul_f32 v116, v116, v68
    v_mul_f32 v117, v117, v69
    v_cvt_pk_bf16_f32 v124, v116, v117
    s_waitcnt lgkmcnt(3)
    v_mfma_f32_32x32x16_bf16 v[76:91], v[100:103], a[96:99], v[76:91]
    ds_read_b128 v[96:99], v39 offset:5120
    v_mul_f32 v118, v118, v70
    v_mul_f32 v119, v119, v71
    v_cvt_pk_bf16_f32 v125, v118, v119
    v_mul_f32 v120, v120, v72
    v_mul_f32 v121, v121, v73
    v_mfma_f32_32x32x16_bf16 v[76:91], v[104:107], a[100:103], v[76:91]
    ds_read_b128 v[100:103], v39 offset:6144
    buffer_load_dwordx4 a[204:207], v2, s[4:7], s71 offen offset:2048 sc1
    v_cvt_pk_bf16_f32 v126, v120, v121
    v_mul_f32 v122, v122, v74
    v_mul_f32 v123, v123, v75
    s_waitcnt lgkmcnt(3)
    v_mfma_f32_32x32x16_bf16 v[76:91], v[108:111], a[104:107], v[76:91]
    ds_read_b128 v[104:107], v39 offset:7168
    v_cvt_pk_bf16_f32 v127, v122, v123
    v_mfma_f32_32x32x16_bf16 v[76:91], v[112:115], a[108:111], v[76:91]
    ds_read_b128 v[108:111], v39 offset:8192
    buffer_store_dwordx4 v[124:127], v11, s[4:7], s65 offen sc1
    s_waitcnt lgkmcnt(3)
    v_mfma_f32_32x32x16_bf16 v[76:91], v[92:95], a[112:115], v[76:91]
    ds_read_b128 v[112:115], v39 offset:9216
    v_mfma_f32_32x32x16_bf16 v[76:91], v[96:99], a[116:119], v[76:91]
    ds_read_b128 v[92:95], v39 offset:10240
    s_add_u32 m0, s54, 16384
    s_add_u32 s60, s38, 278528
    s_sub_u32 s60, s60, s54
    buffer_load_dwordx4 v1, s[8:11], s60 offen offset:0 sc1 lds
    s_waitcnt lgkmcnt(3)
    v_mfma_f32_32x32x16_bf16 v[76:91], v[100:103], a[120:123], v[76:91]
    ds_read_b128 v[96:99], v39 offset:11264
    v_mfma_f32_32x32x16_bf16 v[76:91], v[104:107], a[124:127], v[76:91]
    ds_read_b128 v[100:103], v39 offset:12288
    buffer_load_dwordx4 v1, s[8:11], s60 offen offset:1024 sc1 lds
    s_waitcnt lgkmcnt(3)
    v_mfma_f32_32x32x16_bf16 v[76:91], v[108:111], a[128:131], v[76:91]
    ds_read_b128 v[104:107], v39 offset:13312
    v_mfma_f32_32x32x16_bf16 v[76:91], v[112:115], a[132:135], v[76:91]
    ds_read_b128 v[108:111], v39 offset:14336
    buffer_load_dwordx4 a[208:211], v2, s[4:7], s71 offen offset:3072 sc1
    s_waitcnt vmcnt(17)
    s_barrier
    s_waitcnt lgkmcnt(3)
    v_mfma_f32_32x32x16_bf16 v[76:91], v[92:95], a[136:139], v[76:91]
    ds_read_b128 v[112:115], v39 offset:15360
    v_mfma_f32_32x32x16_bf16 v[76:91], v[96:99], a[140:143], v[76:91]
    ds_read_b128 v[92:95], v39 offset:16384
    buffer_load_dwordx4 a[212:215], v3, s[4:7], s71 offen offset:0 sc1
    s_waitcnt lgkmcnt(3)
    v_mfma_f32_32x32x16_bf16 v[76:91], v[100:103], a[144:147], v[76:91]
    ds_read_b128 v[96:99], v39 offset:17408
    v_mfma_f32_32x32x16_bf16 v[76:91], v[104:107], a[148:151], v[76:91]
    ds_read_b128 v[100:103], v39 offset:18432
    buffer_load_dwordx4 a[216:219], v3, s[4:7], s71 offen offset:1024 sc1
    s_waitcnt lgkmcnt(3)
    v_mfma_f32_32x32x16_bf16 v[76:91], v[108:111], a[152:155], v[76:91]
    ds_read_b128 v[104:107], v39 offset:19456
    v_mfma_f32_32x32x16_bf16 v[76:91], v[112:115], a[156:159], v[76:91]
    ds_read_b128 v[108:111], v39 offset:20480
    buffer_load_dwordx4 a[220:223], v3, s[4:7], s71 offen offset:2048 sc1
    v_mfma_f32_32x32x16_bf16 v[76:91], v[34:37], v[132:135], v[76:91]
    s_waitcnt lgkmcnt(3)
    v_mfma_f32_32x32x16_bf16 v[44:59], v[92:95], a[0:3], 0
    ds_read_b128 v[112:115], v39 offset:21504
    buffer_load_dwordx4 a[224:227], v3, s[4:7], s71 offen offset:3072 sc1
    v_mfma_f32_32x32x16_bf16 v[44:59], v[96:99], a[4:7], v[44:59]
    ds_read_b128 v[92:95], v39 offset:22528
    s_waitcnt lgkmcnt(3)
    v_mfma_f32_32x32x16_bf16 v[44:59], v[100:103], a[8:11], v[44:59]
    ds_read_b128 v[96:99], v39 offset:23552
    buffer_load_dwordx4 a[228:231], v4, s[4:7], s71 offen offset:0 sc1
    v_mfma_f32_32x32x16_bf16 v[44:59], v[104:107], a[12:15], v[44:59]
    ds_read_b128 v[100:103], v39 offset:24576
    v_mul_f32 v116, v76, v76
    v_mul_f32 v117, v77, v77
    v_mul_f32 v118, v78, v78
    v_mul_f32 v119, v79, v79
    s_waitcnt lgkmcnt(3)
    v_mfma_f32_32x32x16_bf16 v[44:59], v[108:111], a[16:19], v[44:59]
    ds_read_b128 v[104:107], v39 offset:25600
    buffer_load_dwordx4 a[232:235], v4, s[4:7], s71 offen offset:1024 sc1
    v_mul_f32 v120, v80, v80
    v_mul_f32 v121, v81, v81
    v_mul_f32 v122, v82, v82
    v_mul_f32 v123, v83, v83
    v_mfma_f32_32x32x16_bf16 v[44:59], v[112:115], a[20:23], v[44:59]
    ds_read_b128 v[108:111], v39 offset:26624
    v_fma_f32 v116, v116, v140, v139
    v_fma_f32 v117, v117, v140, v139
    v_fma_f32 v118, v118, v140, v139
    v_fma_f32 v119, v119, v140, v139
    s_waitcnt lgkmcnt(3)
    v_mfma_f32_32x32x16_bf16 v[44:59], v[92:95], a[24:27], v[44:59]
    ds_read_b128 v[112:115], v39 offset:27648
    buffer_load_dwordx4 a[236:239], v4, s[4:7], s71 offen offset:2048 sc1
    v_fma_f32 v120, v120, v140, v139
    v_fma_f32 v121, v121, v140, v139
    v_fma_f32 v122, v122, v140, v139
    v_fma_f32 v123, v123, v140, v139
    v_mfma_f32_32x32x16_bf16 v[44:59], v[96:99], a[28:31], v[44:59]
    ds_read_b128 v[92:95], v39 offset:28672
    v_mul_f32 v116, v116, v76
    v_mul_f32 v117, v117, v77
    v_mul_f32 v118, v118, v78
    v_mul_f32 v119, v119, v79
    s_waitcnt lgkmcnt(3)
    v_mfma_f32_32x32x16_bf16 v[44:59], v[100:103], a[32:35], v[44:59]
    ds_read_b128 v[96:99], v39 offset:29696
    s_add_u32 s68, s45, 22888448
    s_waitcnt vmcnt(10)
    s_cmp_lg_u32 s24, 0
    s_cbranch_scc1 pubf_25
    buffer_store_dword v6, v5, s[4:7], s68 offen sc1
    s_branch pubd_26
pubf_25:
    buffer_store_dword v6, v5, s[4:7], s68 offen
pubd_26:
    v_mfma_f32_32x32x16_bf16 v[44:59], v[104:107], a[36:39], v[44:59]
    ds_read_b128 v[100:103], v39 offset:30720
    v_mul_f32 v120, v120, v80
    v_mul_f32 v121, v121, v81
    s_barrier
    s_waitcnt lgkmcnt(3)
    v_mfma_f32_32x32x16_bf16 v[44:59], v[108:111], a[40:43], v[44:59]
    ds_read_b128 v[104:107], v39 offset:31744
    buffer_load_dwordx4 a[240:243], v4, s[4:7], s71 offen offset:3072 sc1
    v_mul_f32 v122, v122, v82
    v_mul_f32 v123, v123, v83
    v_exp_f32 v116, v116
    v_mfma_f32_32x32x16_bf16 v[44:59], v[112:115], a[44:47], v[44:59]
    ds_read_b128 v[108:111], v1 offset:0
    v_mul_f32 v84, v84, v76
    v_exp_f32 v117, v117
    v_mul_f32 v85, v85, v77
    s_waitcnt lgkmcnt(3)
    v_mfma_f32_32x32x16_bf16 v[44:59], v[92:95], a[48:51], v[44:59]
    ds_read_b128 v[112:115], v1 offset:1024
    s_add_u32 s71, s40, 49152
    buffer_load_dwordx4 a[244:247], v1, s[4:7], s71 offen offset:0 sc1
    v_exp_f32 v118, v118
    v_mul_f32 v86, v86, v78
    v_mfma_f32_32x32x16_bf16 v[44:59], v[96:99], a[52:55], v[44:59]
    ds_read_b128 v[92:95], v1 offset:2048
    v_exp_f32 v119, v119
    v_mul_f32 v87, v87, v79
    s_waitcnt lgkmcnt(3)
    v_mfma_f32_32x32x16_bf16 v[44:59], v[100:103], a[56:59], v[44:59]
    ds_read_b128 v[96:99], v1 offset:3072
    buffer_load_dwordx4 a[248:251], v1, s[4:7], s71 offen offset:1024 sc1
    v_exp_f32 v120, v120
    v_mul_f32 v88, v88, v80
    v_mfma_f32_32x32x16_bf16 v[44:59], v[104:107], a[60:63], v[44:59]
    ds_read_b128 v[100:103], v1 offset:4096
    v_exp_f32 v121, v121
    v_mul_f32 v89, v89, v81
    s_waitcnt lgkmcnt(3)
    v_mfma_f32_32x32x16_bf16 v[44:59], v[108:111], a[64:67], v[44:59]
    ds_read_b128 v[104:107], v1 offset:5120
    buffer_load_dwordx4 a[252:255], v1, s[4:7], s71 offen offset:2048 sc1
    v_exp_f32 v122, v122
    v_mul_f32 v90, v90, v82
    v_mfma_f32_32x32x16_bf16 v[44:59], v[112:115], a[68:71], v[44:59]
    ds_read_b128 v[108:111], v1 offset:6144
    v_exp_f32 v123, v123
    v_mul_f32 v91, v91, v83
    v_fma_f32 v116, v116, v138, v138
    s_waitcnt lgkmcnt(3)
    v_mfma_f32_32x32x16_bf16 v[44:59], v[92:95], a[72:75], v[44:59]
    ds_read_b128 v[112:115], v1 offset:7168
    buffer_load_dwordx4 v[252:255], v1, s[4:7], s71 offen offset:3072 sc1
    v_fma_f32 v117, v117, v138, v138
    v_rcp_f32 v116, v116
    v_fma_f32 v118, v118, v138, v138
    v_mfma_f32_32x32x16_bf16 v[44:59], v[96:99], a[76:79], v[44:59]
    ds_read_b128 v[92:95], v1 offset:8192
    v_rcp_f32 v117, v117
    v_fma_f32 v119, v119, v138, v138
    s_add_u32 s62, s16, 1
    s_and_b32 s62, s62, 3
    s_mul_i32 s62, s62, 55296
    s_add_u32 s73, s62, s53
    s_waitcnt lgkmcnt(3)
    v_mfma_f32_32x32x16_bf16 v[44:59], v[100:103], a[80:83], v[44:59]
    ds_read_b128 v[96:99], v1 offset:9216
    s_add_u32 s63, s50, 22888448
    buffer_load_dword v141, v9, s[4:7], s63 offen sc1
    v_rcp_f32 v118, v118
    v_fma_f32 v120, v120, v138, v138
    v_mfma_f32_32x32x16_bf16 v[44:59], v[104:107], a[84:87], v[44:59]
    ds_read_b128 v[100:103], v1 offset:10240
    v_rcp_f32 v119, v119
    v_fma_f32 v121, v121, v138, v138
    s_add_u32 s62, s16, 2
    s_and_b32 s62, s62, 3
    s_mul_i32 s62, s62, 55296
    s_add_u32 s74, s62, s53
    s_waitcnt lgkmcnt(3)
    v_mfma_f32_32x32x16_bf16 v[44:59], v[108:111], a[88:91], v[44:59]
    ds_read_b128 v[104:107], v1 offset:11264
    s_add_u32 m0, s54, 24576
    s_add_u32 s60, s40, 69632
    buffer_load_dwordx4 v1, s[4:7], s60 offen offset:0 sc1 lds
    v_rcp_f32 v120, v120
    v_mfma_f32_32x32x16_bf16 v[44:59], v[112:115], a[92:95], v[44:59]
    ds_read_b128 v[108:111], v1 offset:12288
    v_fma_f32 v122, v122, v138, v138
    v_rcp_f32 v121, v121
    v_fma_f32 v123, v123, v138, v138
    s_waitcnt lgkmcnt(3)
    v_mfma_f32_32x32x16_bf16 v[44:59], v[92:95], a[96:99], v[44:59]
    ds_read_b128 v[112:115], v1 offset:13312
    buffer_load_dwordx4 v1, s[4:7], s60 offen offset:1024 sc1 lds
    v_rcp_f32 v122, v122
    v_rcp_f32 v123, v123
    v_mfma_f32_32x32x16_bf16 v[44:59], v[96:99], a[100:103], v[44:59]
    ds_read_b128 v[92:95], v1 offset:14336
    s_add_u32 s65, s33, 15739392
    v_mul_f32 v116, v116, v84
    s_waitcnt vmcnt(17)
    s_barrier
    s_waitcnt lgkmcnt(3)
    v_mfma_f32_32x32x16_bf16 v[44:59], v[100:103], a[104:107], v[44:59]
    ds_read_b128 v[96:99], v1 offset:15360
    s_add_u32 m0, s32, 32768
    s_add_u32 s60, s40, 53248
    buffer_load_dwordx4 v1, s[4:7], s60 offen offset:0 sc1 lds
    v_mul_f32 v117, v117, v85
    v_cvt_pk_bf16_f32 v128, v116, v117
    v_mfma_f32_32x32x16_bf16 v[44:59], v[104:107], a[108:111], v[44:59]
    ds_read_b128 v[100:103], v1 offset:16384
    v_mul_f32 v118, v118, v86
    v_mul_f32 v119, v119, v87
    v_cvt_pk_bf16_f32 v129, v118, v119
    v_mul_f32 v120, v120, v88
    s_waitcnt lgkmcnt(3)
    v_mfma_f32_32x32x16_bf16 v[44:59], v[108:111], a[112:115], v[44:59]
    ds_read_b128 v[104:107], v1 offset:17408
    buffer_load_dwordx4 v1, s[4:7], s60 offen offset:1024 sc1 lds
    v_mul_f32 v121, v121, v89
    v_cvt_pk_bf16_f32 v130, v120, v121
    v_mul_f32 v122, v122, v90
    v_mul_f32 v123, v123, v91
    v_mfma_f32_32x32x16_bf16 v[44:59], v[112:115], a[116:119], v[44:59]
    ds_read_b128 v[108:111], v1 offset:18432
    v_cvt_pk_bf16_f32 v131, v122, v123
    s_add_u32 s62, s16, 3
    s_and_b32 s62, s62, 3
    s_mul_i32 s62, s62, 55296
    s_add_u32 s75, s62, s53
    s_waitcnt lgkmcnt(3)
    v_mfma_f32_32x32x16_bf16 v[44:59], v[92:95], a[120:123], v[44:59]
    ds_read_b128 v[112:115], v1 offset:19456
    buffer_store_dwordx4 v[128:131], v11, s[4:7], s65 offen sc1
    s_add_u32 s62, s16, 4
    s_and_b32 s62, s62, 3
    s_mul_i32 s62, s62, 55296
    s_add_u32 s76, s62, s53
    v_mfma_f32_32x32x16_bf16 v[44:59], v[96:99], a[124:127], v[44:59]
    ds_read_b128 v[92:95], v1 offset:20480
    s_waitcnt lgkmcnt(3)
    v_mfma_f32_32x32x16_bf16 v[44:59], v[100:103], a[128:131], v[44:59]
    ds_read_b128 v[96:99], v1 offset:21504
    buffer_load_dwordx4 v1, s[4:7], s60 offen offset:2048 sc1 lds
    v_mfma_f32_32x32x16_bf16 v[44:59], v[104:107], a[132:135], v[44:59]
    ds_read_b128 v[100:103], v1 offset:22528
    s_waitcnt lgkmcnt(3)
    v_mfma_f32_32x32x16_bf16 v[44:59], v[108:111], a[136:139], v[44:59]
    ds_read_b128 v[104:107], v1 offset:23552
    buffer_load_dwordx4 v1, s[4:7], s60 offen offset:3072 sc1 lds
    v_mfma_f32_32x32x16_bf16 v[44:59], v[112:115], a[140:143], v[44:59]
    s_waitcnt lgkmcnt(2)
    v_mfma_f32_32x32x16_bf16 v[44:59], v[92:95], a[144:147], v[44:59]
    s_add_u32 m0, s32, 49152
    s_add_u32 s60, s40, 57344
    buffer_load_dwordx4 v1, s[4:7], s60 offen offset:0 sc1 lds
    v_mfma_f32_32x32x16_bf16 v[44:59], v[96:99], a[148:151], v[44:59]
    s_waitcnt lgkmcnt(0)
    v_mfma_f32_32x32x16_bf16 v[44:59], v[100:103], a[152:155], v[44:59]
    buffer_load_dwordx4 v1, s[4:7], s60 offen offset:1024 sc1 lds
    v_mfma_f32_32x32x16_bf16 v[44:59], v[104:107], a[156:159], v[44:59]
    v_mfma_f32_32x32x16_bf16 v[44:59], v[36:39], v[132:135], v[44:59]
    buffer_load_dwordx4 v1, s[4:7], s60 offen offset:2048 sc1 lds
    s_waitcnt vmcnt(10)
    v_cmp_eq_u32 vcc, -1, v141
    s_nop 0
    s_cbranch_vccz cok_28
    s_mov_b32 s31, 0
cre_27:
    buffer_load_dword v141, v9, s[4:7], s63 offen sc1
    s_add_u32 s31, s31, 1
    s_waitcnt vmcnt(0)
    v_cmp_eq_u32 vcc, -1, v141
    s_nop 0
    s_cbranch_vccz cok_28
    s_cmp_lt_u32 s31, 32768
    s_cbranch_scc1 cre_27
    s_endpgm
cok_28:
    s_cmp_lt_u32 s16, 2
    s_cselect_b32 s64, s73, 0x40000000
    buffer_load_dwordx4 a[72:75], v1, s[4:7], s64 offen offset:0 sc1
    buffer_load_dwordx4 a[76:79], v1, s[4:7], s73 offen offset:1024 sc1
    buffer_load_dwordx4 a[80:83], v1, s[4:7], s73 offen offset:2048 sc1
    buffer_load_dwordx4 a[84:87], v1, s[4:7], s73 offen offset:3072 sc1
    buffer_load_dwordx4 a[88:91], v2, s[4:7], s73 offen offset:0 sc1
    buffer_load_dwordx4 a[92:95], v2, s[4:7], s73 offen offset:1024 sc1
    buffer_load_dwordx4 a[96:99], v2, s[4:7], s73 offen offset:2048 sc1
    buffer_load_dwordx4 a[100:103], v2, s[4:7], s73 offen offset:3072 sc1
    v_mul_f32 v116, v44, v44
    v_mul_f32 v117, v45, v45
    v_mul_f32 v118, v46, v46
    v_mul_f32 v119, v47, v47
    v_mul_f32 v120, v48, v48
    v_mul_f32 v121, v49, v49
    v_mul_f32 v122, v50, v50
    buffer_load_dwordx4 v1, s[4:7], s60 offen offset:3072 sc1 lds
    v_mul_f32 v123, v51, v51
    v_fma_f32 v116, v116, v140, v139
    v_fma_f32 v117, v117, v140, v139
    v_fma_f32 v118, v118, v140, v139
    v_fma_f32 v119, v119, v140, v139
    v_fma_f32 v120, v120, v140, v139
    v_fma_f32 v121, v121, v140, v139
    s_add_u32 m0, s32, 65536
    s_add_u32 s60, s40, 61440
    buffer_load_dwordx4 v1, s[4:7], s60 offen offset:0 sc1 lds
    v_fma_f32 v122, v122, v140, v139
    v_fma_f32 v123, v123, v140, v139
    v_mul_f32 v116, v116, v44
    v_mul_f32 v117, v117, v45
    v_mul_f32 v118, v118, v46
    v_mul_f32 v119, v119, v47
    v_mul_f32 v120, v120, v48
    buffer_load_dwordx4 v1, s[4:7], s60 offen offset:1024 sc1 lds
    v_mul_f32 v121, v121, v49
    v_mul_f32 v122, v122, v50
    v_mul_f32 v123, v123, v51
    v_exp_f32 v116, v116
    v_mul_f32 v52, v52, v44
    v_exp_f32 v117, v117
    v_mul_f32 v53, v53, v45
    buffer_load_dwordx4 v1, s[4:7], s60 offen offset:2048 sc1 lds
    v_exp_f32 v118, v118
    v_mul_f32 v54, v54, v46
    v_exp_f32 v119, v119
    v_mul_f32 v55, v55, v47
    v_exp_f32 v120, v120
    v_mul_f32 v56, v56, v48
    v_exp_f32 v121, v121
    buffer_load_dwordx4 v1, s[4:7], s60 offen offset:3072 sc1 lds
    v_mul_f32 v57, v57, v49
    v_exp_f32 v122, v122
    v_mul_f32 v58, v58, v50
    v_exp_f32 v123, v123
    v_mul_f32 v59, v59, v51
    v_fma_f32 v116, v116, v138, v138
    v_fma_f32 v117, v117, v138, v138
    s_add_u32 m0, s32, 81920
    s_add_u32 s60, s40, 65536
    buffer_load_dwordx4 v1, s[4:7], s60 offen offset:0 sc1 lds
    v_rcp_f32 v116, v116
    v_fma_f32 v118, v118, v138, v138
    v_rcp_f32 v117, v117
    v_fma_f32 v119, v119, v138, v138
    v_rcp_f32 v118, v118
    v_fma_f32 v120, v120, v138, v138
    v_rcp_f32 v119, v119
    buffer_load_dwordx4 v1, s[4:7], s60 offen offset:1024 sc1 lds
    v_fma_f32 v121, v121, v138, v138
    v_rcp_f32 v120, v120
    v_fma_f32 v122, v122, v138, v138
    v_rcp_f32 v121, v121
    v_fma_f32 v123, v123, v138, v138
    v_rcp_f32 v122, v122
    v_rcp_f32 v123, v123
    buffer_load_dwordx4 v1, s[4:7], s60 offen offset:2048 sc1 lds
    s_add_u32 s65, s33, 15739904
    v_mul_f32 v116, v116, v52
    v_mul_f32 v117, v117, v53
    v_cvt_pk_bf16_f32 v124, v116, v117
    v_mul_f32 v118, v118, v54
    v_mul_f32 v119, v119, v55
    v_cvt_pk_bf16_f32 v125, v118, v119
    buffer_load_dwordx4 v1, s[4:7], s60 offen offset:3072 sc1 lds
    v_mul_f32 v120, v120, v56
    v_mul_f32 v121, v121, v57
    v_cvt_pk_bf16_f32 v126, v120, v121
    v_mul_f32 v122, v122, v58
    v_mul_f32 v123, v123, v59
    v_cvt_pk_bf16_f32 v127, v122, v123
    buffer_store_dwordx4 v[124:127], v11, s[4:7], s65 offen sc1
    v_add_u32 v118, s32, v1
    v_add_u32 v119, s54, v1
    v_add_u32 v120, s32, v38
    s_add_u32 s61, s42, 12984320
    v_add_u32 v116, s61, v14
    s_add_u32 s61, s43, 22855680
    v_writelane_b32 v116, s61, 63
    s_barrier
    s_waitcnt vmcnt(17)
    v_mfma_f32_16x16x32_bf16 v[44:47], v[144:147], a[72:75], 0
    v_mfma_f32_16x16x32_bf16 v[48:51], v[148:151], a[72:75], 0
    v_mfma_f32_16x16x32_bf16 v[52:55], v[152:155], a[72:75], 0
    v_mfma_f32_16x16x32_bf16 v[56:59], v[156:159], a[72:75], 0
    buffer_load_dwordx4 a[104:107], v3, s[4:7], s73 offen offset:0 sc1
    v_mfma_f32_16x16x32_bf16 v[60:63], v[160:163], a[72:75], 0
    s_waitcnt vmcnt(17)
    v_mfma_f32_16x16x32_bf16 v[44:47], v[164:167], a[76:79], v[44:47]
    v_mfma_f32_16x16x32_bf16 v[48:51], v[168:171], a[76:79], v[48:51]
    v_mfma_f32_16x16x32_bf16 v[52:55], v[172:175], a[76:79], v[52:55]
    buffer_load_dwordx4 a[108:111], v3, s[4:7], s73 offen offset:1024 sc1
    v_mfma_f32_16x16x32_bf16 v[56:59], v[176:179], a[76:79], v[56:59]
    v_mfma_f32_16x16x32_bf16 v[60:63], v[180:183], a[76:79], v[60:63]
    s_waitcnt vmcnt(17)
    v_mfma_f32_16x16x32_bf16 v[44:47], v[184:187], a[80:83], v[44:47]
    v_mfma_f32_16x16x32_bf16 v[48:51], v[188:191], a[80:83], v[48:51]
    s_cmp_lt_u32 s16, 2
    s_cselect_b32 s64, s74, 0x40000000
    buffer_load_dwordx4 a[112:115], v1, s[4:7], s64 offen offset:0 sc1
    v_mfma_f32_16x16x32_bf16 v[52:55], v[192:195], a[80:83], v[52:55]
    v_mfma_f32_16x16x32_bf16 v[56:59], v[196:199], a[80:83], v[56:59]
    v_mfma_f32_16x16x32_bf16 v[60:63], v[200:203], a[80:83], v[60:63]
    s_waitcnt vmcnt(17)
    v_mfma_f32_16x16x32_bf16 v[44:47], v[204:207], a[84:87], v[44:47]
    s_add_u32 s61, s41, 10362880
    buffer_load_dwordx4 v[104:107], v12, s[4:7], s61 offen sc1
    buffer_load_dwordx4 v[108:111], v12, s[4:7], s61 offen offset:2048 sc1
    buffer_load_dwordx2 v[112:113], v13, s[4:7], s61 offen sc1
    buffer_load_dword v117, v116, s[4:7], 0 offen sc1
    v_mfma_f32_16x16x32_bf16 v[48:51], v[208:211], a[84:87], v[48:51]
    v_mfma_f32_16x16x32_bf16 v[52:55], v[212:215], a[84:87], v[52:55]
    v_mfma_f32_16x16x32_bf16 v[56:59], v[216:219], a[84:87], v[56:59]
    v_mfma_f32_16x16x32_bf16 v[60:63], v[220:223], a[84:87], v[60:63]
    buffer_load_dwordx4 a[116:119], v1, s[4:7], s74 offen offset:1024 sc1
    s_waitcnt vmcnt(21)
    v_mfma_f32_16x16x32_bf16 v[44:47], v[224:227], a[88:91], v[44:47]
    v_mfma_f32_16x16x32_bf16 v[48:51], v[228:231], a[88:91], v[48:51]
    v_mfma_f32_16x16x32_bf16 v[52:55], v[232:235], a[88:91], v[52:55]
    v_mfma_f32_16x16x32_bf16 v[56:59], v[236:239], a[88:91], v[56:59]
    buffer_load_dwordx4 a[120:123], v1, s[4:7], s74 offen offset:2048 sc1
    v_mfma_f32_16x16x32_bf16 v[60:63], v[240:243], a[88:91], v[60:63]
    s_waitcnt vmcnt(21)
    v_mfma_f32_16x16x32_bf16 v[44:47], v[244:247], a[92:95], v[44:47]
    v_mfma_f32_16x16x32_bf16 v[48:51], v[248:251], a[92:95], v[48:51]
    v_mfma_f32_16x16x32_bf16 v[52:55], a[160:163], a[92:95], v[52:55]
    buffer_load_dwordx4 a[124:127], v1, s[4:7], s74 offen offset:3072 sc1
    v_mfma_f32_16x16x32_bf16 v[56:59], a[164:167], a[92:95], v[56:59]
    v_mfma_f32_16x16x32_bf16 v[60:63], a[168:171], a[92:95], v[60:63]
    s_waitcnt vmcnt(21)
    v_mfma_f32_16x16x32_bf16 v[44:47], a[172:175], a[96:99], v[44:47]
    v_mfma_f32_16x16x32_bf16 v[48:51], a[176:179], a[96:99], v[48:51]
    buffer_load_dwordx4 a[128:131], v2, s[4:7], s74 offen offset:0 sc1
    v_mfma_f32_16x16x32_bf16 v[52:55], a[180:183], a[96:99], v[52:55]
    v_mfma_f32_16x16x32_bf16 v[56:59], a[184:187], a[96:99], v[56:59]
    v_mfma_f32_16x16x32_bf16 v[60:63], a[188:191], a[96:99], v[60:63]
    s_waitcnt vmcnt(21)
    v_mfma_f32_16x16x32_bf16 v[44:47], a[192:195], a[100:103], v[44:47]
    buffer_load_dwordx4 a[132:135], v2, s[4:7], s74 offen offset:1024 sc1
    v_mfma_f32_16x16x32_bf16 v[48:51], a[196:199], a[100:103], v[48:51]
    v_mfma_f32_16x16x32_bf16 v[52:55], a[200:203], a[100:103], v[52:55]
    v_mfma_f32_16x16x32_bf16 v[56:59], a[204:207], a[100:103], v[56:59]
    v_mfma_f32_16x16x32_bf16 v[60:63], a[208:211], a[100:103], v[60:63]
    buffer_load_dwordx4 a[136:139], v2, s[4:7], s74 offen offset:2048 sc1
    s_waitcnt vmcnt(12)
    v_mfma_f32_16x16x32_bf16 v[44:47], a[212:215], a[104:107], v[44:47]
    v_mfma_f32_16x16x32_bf16 v[48:51], a[216:219], a[104:107], v[48:51]
    v_mfma_f32_16x16x32_bf16 v[52:55], a[220:223], a[104:107], v[52:55]
    v_mfma_f32_16x16x32_bf16 v[56:59], a[224:227], a[104:107], v[56:59]
    buffer_load_dwordx4 a[140:143], v2, s[4:7], s74 offen offset:3072 sc1
    v_mfma_f32_16x16x32_bf16 v[60:63], a[228:231], a[104:107], v[60:63]
    s_waitcnt vmcnt(12)
    v_mfma_f32_16x16x32_bf16 v[44:47], a[232:235], a[108:111], v[44:47]
    v_mfma_f32_16x16x32_bf16 v[48:51], a[236:239], a[108:111], v[48:51]
    v_mfma_f32_16x16x32_bf16 v[52:55], a[240:243], a[108:111], v[52:55]
    buffer_load_dwordx4 a[144:147], v3, s[4:7], s74 offen offset:0 sc1
    v_mfma_f32_16x16x32_bf16 v[56:59], a[244:247], a[108:111], v[56:59]
    v_mfma_f32_16x16x32_bf16 v[60:63], a[248:251], a[108:111], v[60:63]
    s_waitcnt vmcnt(12)
    v_mfma_f32_16x16x32_bf16 v[64:67], v[144:147], a[112:115], 0
    v_mfma_f32_16x16x32_bf16 v[68:71], v[148:151], a[112:115], 0
    buffer_load_dwordx4 a[148:151], v3, s[4:7], s74 offen offset:1024 sc1
    v_mfma_f32_16x16x32_bf16 v[72:75], v[152:155], a[112:115], 0
    v_mfma_f32_16x16x32_bf16 v[76:79], v[156:159], a[112:115], 0
    v_mfma_f32_16x16x32_bf16 v[80:83], v[160:163], a[112:115], 0
    s_waitcnt vmcnt(8)
    v_mfma_f32_16x16x32_bf16 v[64:67], v[164:167], a[116:119], v[64:67]
    s_cmp_lt_u32 s16, 2
    s_cselect_b32 s64, s75, 0x40000000
    buffer_load_dwordx4 a[152:155], v1, s[4:7], s64 offen offset:0 sc1
    v_mfma_f32_16x16x32_bf16 v[68:71], v[168:171], a[116:119], v[68:71]
    v_mfma_f32_16x16x32_bf16 v[72:75], v[172:175], a[116:119], v[72:75]
    v_mfma_f32_16x16x32_bf16 v[76:79], v[176:179], a[116:119], v[76:79]
    v_mfma_f32_16x16x32_bf16 v[80:83], v[180:183], a[116:119], v[80:83]
    buffer_load_dwordx4 a[156:159], v1, s[4:7], s75 offen offset:1024 sc1
    s_add_u32 s63, s45, 22880256
    s_cmp_lg_u32 s24, 0
    s_cbranch_scc1 pubf_29
    buffer_store_dword v6, v5, s[4:7], s63 offen sc1
    s_branch pubd_30
pubf_29:
    buffer_store_dword v6, v5, s[4:7], s63 offen
pubd_30:
    s_waitcnt vmcnt(10)
    v_mfma_f32_16x16x32_bf16 v[64:67], v[184:187], a[120:123], v[64:67]
    ds_read_b128 a[0:3], v118 offset:32768
    ds_read_b128 a[4:7], v118 offset:33792
    v_mfma_f32_16x16x32_bf16 v[68:71], v[188:191], a[120:123], v[68:71]
    ds_read_b128 a[8:11], v118 offset:34816
    ds_read_b128 a[12:15], v118 offset:35840
    v_mfma_f32_16x16x32_bf16 v[72:75], v[192:195], a[120:123], v[72:75]
    ds_read_b128 a[16:19], v118 offset:49152
    ds_read_b128 a[20:23], v118 offset:50176
    v_mfma_f32_16x16x32_bf16 v[76:79], v[196:199], a[120:123], v[76:79]
    buffer_load_dwordx4 a[72:75], v1, s[4:7], s75 offen offset:2048 sc1
    ds_read_b128 a[24:27], v118 offset:51200
    v_mfma_f32_16x16x32_bf16 v[80:83], v[200:203], a[120:123], v[80:83]
    ds_read_b128 a[28:31], v118 offset:52224
    ds_read_b128 a[32:35], v120 offset:0
    s_waitcnt vmcnt(10)
    v_mfma_f32_16x16x32_bf16 v[64:67], v[204:207], a[124:127], v[64:67]
    ds_read_b128 a[36:39], v120 offset:1024
    ds_read_b128 a[40:43], v120 offset:2048
    v_mfma_f32_16x16x32_bf16 v[68:71], v[208:211], a[124:127], v[68:71]
    ds_read_b128 a[44:47], v120 offset:3072
    ds_read_b128 a[48:51], v120 offset:16384
    v_mfma_f32_16x16x32_bf16 v[72:75], v[212:215], a[124:127], v[72:75]
    buffer_load_dwordx4 a[76:79], v1, s[4:7], s75 offen offset:3072 sc1
    ds_read_b128 a[52:55], v120 offset:17408
    v_mfma_f32_16x16x32_bf16 v[76:79], v[216:219], a[124:127], v[76:79]
    ds_read_b128 a[56:59], v120 offset:18432
    ds_read_b128 a[60:63], v120 offset:19456
    v_mfma_f32_16x16x32_bf16 v[80:83], v[220:223], a[124:127], v[80:83]
    ds_read_b128 a[64:67], v119 offset:24576
    ds_read_b128 a[68:71], v119 offset:25600
    s_waitcnt vmcnt(10)
    v_mfma_f32_16x16x32_bf16 v[64:67], v[224:227], a[128:131], v[64:67]
    v_mfma_f32_16x16x32_bf16 v[68:71], v[228:231], a[128:131], v[68:71]
    buffer_load_dwordx4 a[80:83], v2, s[4:7], s75 offen offset:0 sc1
    v_mfma_f32_16x16x32_bf16 v[72:75], v[232:235], a[128:131], v[72:75]
    v_mfma_f32_16x16x32_bf16 v[76:79], v[236:239], a[128:131], v[76:79]
    v_mfma_f32_16x16x32_bf16 v[80:83], v[240:243], a[128:131], v[80:83]
    s_waitcnt vmcnt(10)
    v_mfma_f32_16x16x32_bf16 v[64:67], v[244:247], a[132:135], v[64:67]
    buffer_load_dwordx4 a[84:87], v2, s[4:7], s75 offen offset:1024 sc1
    v_mfma_f32_16x16x32_bf16 v[68:71], v[248:251], a[132:135], v[68:71]
    v_mfma_f32_16x16x32_bf16 v[72:75], a[160:163], a[132:135], v[72:75]
    v_mfma_f32_16x16x32_bf16 v[76:79], a[164:167], a[132:135], v[76:79]
    v_mfma_f32_16x16x32_bf16 v[80:83], a[168:171], a[132:135], v[80:83]
    buffer_load_dwordx4 a[88:91], v2, s[4:7], s75 offen offset:2048 sc1
    s_waitcnt vmcnt(11)
    v_mfma_f32_16x16x32_bf16 v[64:67], a[172:175], a[136:139], v[64:67]
    v_mfma_f32_16x16x32_bf16 v[68:71], a[176:179], a[136:139], v[68:71]
    v_mfma_f32_16x16x32_bf16 v[72:75], a[180:183], a[136:139], v[72:75]
    v_mfma_f32_16x16x32_bf16 v[76:79], a[184:187], a[136:139], v[76:79]
    buffer_load_dwordx4 a[92:95], v2, s[4:7], s75 offen offset:3072 sc1
    v_mfma_f32_16x16x32_bf16 v[80:83], a[188:191], a[136:139], v[80:83]
    s_waitcnt vmcnt(11)
    v_mfma_f32_16x16x32_bf16 v[64:67], a[192:195], a[140:143], v[64:67]
    v_mfma_f32_16x16x32_bf16 v[68:71], a[196:199], a[140:143], v[68:71]
    v_mfma_f32_16x16x32_bf16 v[72:75], a[200:203], a[140:143], v[72:75]
    buffer_load_dwordx4 a[96:99], v3, s[4:7], s75 offen offset:0 sc1
    v_mfma_f32_16x16x32_bf16 v[76:79], a[204:207], a[140:143], v[76:79]
    v_mfma_f32_16x16x32_bf16 v[80:83], a[208:211], a[140:143], v[80:83]
    s_waitcnt vmcnt(11)
    v_mfma_f32_16x16x32_bf16 v[64:67], a[212:215], a[144:147], v[64:67]
    v_mfma_f32_16x16x32_bf16 v[68:71], a[216:219], a[144:147], v[68:71]
    buffer_load_dwordx4 a[100:103], v3, s[4:7], s75 offen offset:1024 sc1
    v_mfma_f32_16x16x32_bf16 v[72:75], a[220:223], a[144:147], v[72:75]
    v_mfma_f32_16x16x32_bf16 v[76:79], a[224:227], a[144:147], v[76:79]
    v_mfma_f32_16x16x32_bf16 v[80:83], a[228:231], a[144:147], v[80:83]
    s_waitcnt vmcnt(11)
    v_mfma_f32_16x16x32_bf16 v[64:67], a[232:235], a[148:151], v[64:67]
    s_add_u32 s63, s50, 22880256
    buffer_load_dword v122, v9, s[4:7], s63 offen sc1
    v_mfma_f32_16x16x32_bf16 v[68:71], a[236:239], a[148:151], v[68:71]
    v_mfma_f32_16x16x32_bf16 v[72:75], a[240:243], a[148:151], v[72:75]
    v_mfma_f32_16x16x32_bf16 v[76:79], a[244:247], a[148:151], v[76:79]
    v_mfma_f32_16x16x32_bf16 v[80:83], a[248:251], a[148:151], v[80:83]
    s_add_u32 m0, s32, 98304
    s_add_u32 s60, s37, 32768
    buffer_load_dwordx4 v1, s[4:7], s60 offen offset:0 sc1 lds
    s_waitcnt vmcnt(12)
    v_mfma_f32_16x16x32_bf16 v[124:127], v[144:147], a[152:155], 0
    v_mfma_f32_16x16x32_bf16 v[128:131], v[148:151], a[152:155], 0
    v_mfma_f32_16x16x32_bf16 v[132:135], v[152:155], a[152:155], 0
    v_mfma_f32_16x16x32_bf16 v[136:139], v[156:159], a[152:155], 0
    buffer_load_dwordx4 v1, s[4:7], s60 offen offset:1024 sc1 lds
    v_mfma_f32_16x16x32_bf16 v[140:143], v[160:163], a[152:155], 0
    s_waitcnt vmcnt(12)
    v_mfma_f32_16x16x32_bf16 v[124:127], v[164:167], a[156:159], v[124:127]
    v_mfma_f32_16x16x32_bf16 v[128:131], v[168:171], a[156:159], v[128:131]
    v_mfma_f32_16x16x32_bf16 v[132:135], v[172:175], a[156:159], v[132:135]
    buffer_load_dwordx4 v1, s[4:7], s60 offen offset:2048 sc1 lds
    v_mfma_f32_16x16x32_bf16 v[136:139], v[176:179], a[156:159], v[136:139]
    v_mfma_f32_16x16x32_bf16 v[140:143], v[180:183], a[156:159], v[140:143]
    s_waitcnt vmcnt(11)
    v_mfma_f32_16x16x32_bf16 v[124:127], v[184:187], a[72:75], v[124:127]
    v_lshlrev_b32 v84, 16, v104
    v_and_b32 v85, 0xffff0000, v104
    v_mfma_f32_16x16x32_bf16 v[128:131], v[188:191], a[72:75], v[128:131]
    buffer_load_dwordx4 v1, s[4:7], s60 offen offset:3072 sc1 lds
    v_lshlrev_b32 v86, 16, v105
    v_mfma_f32_16x16x32_bf16 v[132:135], v[192:195], a[72:75], v[132:135]
    v_and_b32 v87, 0xffff0000, v105
    v_lshlrev_b32 v88, 16, v106
    v_mfma_f32_16x16x32_bf16 v[136:139], v[196:199], a[72:75], v[136:139]
    v_and_b32 v89, 0xffff0000, v106
    v_lshlrev_b32 v90, 16, v107
    v_mfma_f32_16x16x32_bf16 v[140:143], v[200:203], a[72:75], v[140:143]
    v_and_b32 v91, 0xffff0000, v107
    v_lshlrev_b32 v92, 16, v108
    s_waitcnt vmcnt(4)
    v_cmp_eq_u32 vcc, -1, v122
    s_nop 0
    s_cbranch_vccz cok_32
    s_mov_b32 s31, 0
cre_31:
    buffer_load_dword v122, v9, s[4:7], s63 offen sc1
    s_add_u32 s31, s31, 1
    s_waitcnt vmcnt(0)
    v_cmp_eq_u32 vcc, -1, v122
    s_nop 0
    s_cbranch_vccz cok_32
    s_cmp_lt_u32 s31, 32768
    s_cbranch_scc1 cre_31
    s_endpgm
cok_32:
    v_mfma_f32_16x16x32_bf16 v[124:127], v[204:207], a[76:79], v[124:127]
    buffer_load_dwordx4 a[104:107], v3, s[4:7], s73 offen offset:2048 sc1
    v_and_b32 v93, 0xffff0000, v108
    v_mfma_f32_16x16x32_bf16 v[128:131], v[208:211], a[76:79], v[128:131]
    v_lshlrev_b32 v94, 16, v109
    v_and_b32 v95, 0xffff0000, v109
    v_mfma_f32_16x16x32_bf16 v[132:135], v[212:215], a[76:79], v[132:135]
    v_lshlrev_b32 v96, 16, v110
    v_and_b32 v97, 0xffff0000, v110
    v_mfma_f32_16x16x32_bf16 v[136:139], v[216:219], a[76:79], v[136:139]
    v_lshlrev_b32 v98, 16, v111
    v_and_b32 v99, 0xffff0000, v111
    v_mfma_f32_16x16x32_bf16 v[140:143], v[220:223], a[76:79], v[140:143]
    buffer_load_dwordx4 a[108:111], v3, s[4:7], s73 offen offset:3072 sc1
    v_lshlrev_b32 v100, 16, v112
    v_mfma_f32_16x16x32_bf16 v[124:127], v[224:227], a[80:83], v[124:127]
    v_and_b32 v101, 0xffff0000, v112
    v_lshlrev_b32 v102, 16, v113
    v_mfma_f32_16x16x32_bf16 v[128:131], v[228:231], a[80:83], v[128:131]
    v_and_b32 v103, 0xffff0000, v113
    v_mfma_f32_16x16x32_bf16 v[132:135], v[232:235], a[80:83], v[132:135]
    v_mfma_f32_16x16x32_bf16 v[136:139], v[236:239], a[80:83], v[136:139]
    buffer_load_dwordx4 a[112:115], v4, s[4:7], s73 offen offset:0 sc1
    v_mfma_f32_16x16x32_bf16 v[140:143], v[240:243], a[80:83], v[140:143]
    v_mfma_f32_16x16x32_bf16 v[124:127], v[244:247], a[84:87], v[124:127]
    v_mfma_f32_16x16x32_bf16 v[128:131], v[248:251], a[84:87], v[128:131]
    v_mfma_f32_16x16x32_bf16 v[132:135], a[160:163], a[84:87], v[132:135]
    buffer_load_dwordx4 a[116:119], v4, s[4:7], s73 offen offset:1024 sc1
    v_mfma_f32_16x16x32_bf16 v[136:139], a[164:167], a[84:87], v[136:139]
    v_mfma_f32_16x16x32_bf16 v[140:143], a[168:171], a[84:87], v[140:143]
    v_mfma_f32_16x16x32_bf16 v[124:127], a[172:175], a[88:91], v[124:127]
    v_mfma_f32_16x16x32_bf16 v[128:131], a[176:179], a[88:91], v[128:131]
    buffer_load_dwordx4 a[120:123], v3, s[4:7], s74 offen offset:2048 sc1
    v_mfma_f32_16x16x32_bf16 v[132:135], a[180:183], a[88:91], v[132:135]
    v_mfma_f32_16x16x32_bf16 v[136:139], a[184:187], a[88:91], v[136:139]
    v_mfma_f32_16x16x32_bf16 v[140:143], a[188:191], a[88:91], v[140:143]
    s_waitcnt lgkmcnt(0)
    s_barrier
    v_mfma_f32_16x16x32_bf16 v[124:127], a[192:195], a[92:95], v[124:127]
    buffer_load_dwordx4 a[124:127], v3, s[4:7], s74 offen offset:3072 sc1
    v_mfma_f32_16x16x32_bf16 v[128:131], a[196:199], a[92:95], v[128:131]
    v_mfma_f32_16x16x32_bf16 v[132:135], a[200:203], a[92:95], v[132:135]
    v_mfma_f32_16x16x32_bf16 v[136:139], a[204:207], a[92:95], v[136:139]
    v_mfma_f32_16x16x32_bf16 v[140:143], a[208:211], a[92:95], v[140:143]
    buffer_load_dwordx4 a[128:131], v4, s[4:7], s74 offen offset:0 sc1
    v_mfma_f32_16x16x32_bf16 v[124:127], a[212:215], a[96:99], v[124:127]
    v_mfma_f32_16x16x32_bf16 v[128:131], a[216:219], a[96:99], v[128:131]
    v_mfma_f32_16x16x32_bf16 v[132:135], a[220:223], a[96:99], v[132:135]
    v_mfma_f32_16x16x32_bf16 v[136:139], a[224:227], a[96:99], v[136:139]
    buffer_load_dwordx4 a[132:135], v4, s[4:7], s74 offen offset:1024 sc1
    v_mfma_f32_16x16x32_bf16 v[140:143], a[228:231], a[96:99], v[140:143]
    v_mfma_f32_16x16x32_bf16 v[124:127], a[232:235], a[100:103], v[124:127]
    v_mfma_f32_16x16x32_bf16 v[128:131], a[236:239], a[100:103], v[128:131]
    v_mfma_f32_16x16x32_bf16 v[132:135], a[240:243], a[100:103], v[132:135]
    buffer_load_dwordx4 a[136:139], v3, s[4:7], s75 offen offset:2048 sc1
    v_mfma_f32_16x16x32_bf16 v[136:139], a[244:247], a[100:103], v[136:139]
    v_mfma_f32_16x16x32_bf16 v[140:143], a[248:251], a[100:103], v[140:143]
    s_waitcnt vmcnt(8)
    v_mfma_f32_16x16x32_bf16 v[44:47], a[252:255], a[104:107], v[44:47]
    v_mfma_f32_16x16x32_bf16 v[48:51], v[252:255], a[104:107], v[48:51]
    buffer_load_dwordx4 a[140:143], v3, s[4:7], s75 offen offset:3072 sc1
    v_mfma_f32_16x16x32_bf16 v[52:55], a[0:3], a[104:107], v[52:55]
    v_mfma_f32_16x16x32_bf16 v[56:59], a[4:7], a[104:107], v[56:59]
    v_mfma_f32_16x16x32_bf16 v[60:63], a[8:11], a[104:107], v[60:63]
    s_waitcnt vmcnt(8)
    v_mfma_f32_16x16x32_bf16 v[44:47], a[12:15], a[108:111], v[44:47]
    buffer_load_dwordx4 a[144:147], v4, s[4:7], s75 offen offset:0 sc1
    v_mfma_f32_16x16x32_bf16 v[48:51], a[16:19], a[108:111], v[48:51]
    v_mfma_f32_16x16x32_bf16 v[52:55], a[20:23], a[108:111], v[52:55]
    v_mfma_f32_16x16x32_bf16 v[56:59], a[24:27], a[108:111], v[56:59]
    v_mfma_f32_16x16x32_bf16 v[60:63], a[28:31], a[108:111], v[60:63]
    buffer_load_dwordx4 a[148:151], v4, s[4:7], s75 offen offset:1024 sc1
    s_waitcnt vmcnt(9)
    v_mfma_f32_16x16x32_bf16 v[44:47], a[32:35], a[112:115], v[44:47]
    v_mfma_f32_16x16x32_bf16 v[48:51], a[36:39], a[112:115], v[48:51]
    v_mfma_f32_16x16x32_bf16 v[52:55], a[40:43], a[112:115], v[52:55]
    v_mfma_f32_16x16x32_bf16 v[56:59], a[44:47], a[112:115], v[56:59]
    s_cmp_lt_u32 s16, 2
    s_cselect_b32 s64, s76, 0x40000000
    buffer_load_dwordx4 a[152:155], v1, s[4:7], s64 offen offset:0 sc1
    v_mfma_f32_16x16x32_bf16 v[60:63], a[48:51], a[112:115], v[60:63]
    s_waitcnt vmcnt(9)
    v_mfma_f32_16x16x32_bf16 v[44:47], a[52:55], a[116:119], v[44:47]
    v_mfma_f32_16x16x32_bf16 v[48:51], a[56:59], a[116:119], v[48:51]
    v_mfma_f32_16x16x32_bf16 v[52:55], a[60:63], a[116:119], v[52:55]
    buffer_load_dwordx4 a[156:159], v1, s[4:7], s76 offen offset:1024 sc1
    v_mfma_f32_16x16x32_bf16 v[56:59], a[64:67], a[116:119], v[56:59]
    v_mfma_f32_16x16x32_bf16 v[60:63], a[68:71], a[116:119], v[60:63]
    s_waitcnt vmcnt(9)
    v_mfma_f32_16x16x32_bf16 v[64:67], a[252:255], a[120:123], v[64:67]
    v_mfma_f32_16x16x32_bf16 v[68:71], v[252:255], a[120:123], v[68:71]
    ds_write_b128 v40, v[44:47] offset:0
    buffer_load_dwordx4 a[72:75], v1, s[4:7], s76 offen offset:2048 sc1
    v_mfma_f32_16x16x32_bf16 v[72:75], a[0:3], a[120:123], v[72:75]
    v_mfma_f32_16x16x32_bf16 v[76:79], a[4:7], a[120:123], v[76:79]
    v_mfma_f32_16x16x32_bf16 v[80:83], a[8:11], a[120:123], v[80:83]
    s_waitcnt vmcnt(9)
    v_mfma_f32_16x16x32_bf16 v[64:67], a[12:15], a[124:127], v[64:67]
    ds_write_b128 v40, v[48:51] offset:1024
    buffer_load_dwordx4 a[76:79], v1, s[4:7], s76 offen offset:3072 sc1
    v_mfma_f32_16x16x32_bf16 v[68:71], a[16:19], a[124:127], v[68:71]
    v_mfma_f32_16x16x32_bf16 v[72:75], a[20:23], a[124:127], v[72:75]
    v_mfma_f32_16x16x32_bf16 v[76:79], a[24:27], a[124:127], v[76:79]
    v_mfma_f32_16x16x32_bf16 v[80:83], a[28:31], a[124:127], v[80:83]
    ds_write_b128 v40, v[52:55] offset:2048
    buffer_load_dwordx4 a[80:83], v2, s[4:7], s76 offen offset:0 sc1
    s_waitcnt vmcnt(10)
    v_mfma_f32_16x16x32_bf16 v[64:67], a[32:35], a[128:131], v[64:67]
    v_mfma_f32_16x16x32_bf16 v[68:71], a[36:39], a[128:131], v[68:71]
    v_mfma_f32_16x16x32_bf16 v[72:75], a[40:43], a[128:131], v[72:75]
    v_mfma_f32_16x16x32_bf16 v[76:79], a[44:47], a[128:131], v[76:79]
    ds_write_b128 v40, v[56:59] offset:3072
    buffer_load_dwordx4 a[84:87], v2, s[4:7], s76 offen offset:1024 sc1
    v_mfma_f32_16x16x32_bf16 v[80:83], a[48:51], a[128:131], v[80:83]
    s_waitcnt vmcnt(10)
    v_mfma_f32_16x16x32_bf16 v[64:67], a[52:55], a[132:135], v[64:67]
    v_mfma_f32_16x16x32_bf16 v[68:71], a[56:59], a[132:135], v[68:71]
    v_mfma_f32_16x16x32_bf16 v[72:75], a[60:63], a[132:135], v[72:75]
    ds_write_b128 v40, v[60:63] offset:4096
    buffer_load_dwordx4 a[88:91], v2, s[4:7], s76 offen offset:2048 sc1
    v_mfma_f32_16x16x32_bf16 v[76:79], a[64:67], a[132:135], v[76:79]
    v_mfma_f32_16x16x32_bf16 v[80:83], a[68:71], a[132:135], v[80:83]
    s_waitcnt vmcnt(10)
    v_mfma_f32_16x16x32_bf16 v[124:127], a[252:255], a[136:139], v[124:127]
    v_mfma_f32_16x16x32_bf16 v[128:131], v[252:255], a[136:139], v[128:131]
    ds_write_b128 v41, v[64:67] offset:5120
    buffer_load_dwordx4 a[92:95], v2, s[4:7], s76 offen offset:3072 sc1
    v_mfma_f32_16x16x32_bf16 v[132:135], a[0:3], a[136:139], v[132:135]
    v_mfma_f32_16x16x32_bf16 v[136:139], a[4:7], a[136:139], v[136:139]
    v_mfma_f32_16x16x32_bf16 v[140:143], a[8:11], a[136:139], v[140:143]
    s_waitcnt vmcnt(10)
    v_mfma_f32_16x16x32_bf16 v[124:127], a[12:15], a[140:143], v[124:127]
    ds_write_b128 v41, v[68:71] offset:6144
    buffer_load_dwordx4 a[96:99], v3, s[4:7], s76 offen offset:0 sc1
    v_mfma_f32_16x16x32_bf16 v[128:131], a[16:19], a[140:143], v[128:131]
    v_mfma_f32_16x16x32_bf16 v[132:135], a[20:23], a[140:143], v[132:135]
    v_mfma_f32_16x16x32_bf16 v[136:139], a[24:27], a[140:143], v[136:139]
    v_mfma_f32_16x16x32_bf16 v[140:143], a[28:31], a[140:143], v[140:143]
    ds_write_b128 v41, v[72:75] offset:7168
    buffer_load_dwordx4 a[100:103], v3, s[4:7], s76 offen offset:1024 sc1
    s_waitcnt vmcnt(11)
    v_mfma_f32_16x16x32_bf16 v[124:127], a[32:35], a[144:147], v[124:127]
    v_mfma_f32_16x16x32_bf16 v[128:131], a[36:39], a[144:147], v[128:131]
    v_mfma_f32_16x16x32_bf16 v[132:135], a[40:43], a[144:147], v[132:135]
    v_mfma_f32_16x16x32_bf16 v[136:139], a[44:47], a[144:147], v[136:139]
    ds_write_b128 v41, v[76:79] offset:8192
    buffer_load_dwordx4 a[104:107], v3, s[4:7], s76 offen offset:2048 sc1
    v_mfma_f32_16x16x32_bf16 v[140:143], a[48:51], a[144:147], v[140:143]
    s_waitcnt vmcnt(11)
    v_mfma_f32_16x16x32_bf16 v[124:127], a[52:55], a[148:151], v[124:127]
    v_mfma_f32_16x16x32_bf16 v[128:131], a[56:59], a[148:151], v[128:131]
    v_mfma_f32_16x16x32_bf16 v[132:135], a[60:63], a[148:151], v[132:135]
    ds_write_b128 v41, v[80:83] offset:9216
    buffer_load_dwordx4 a[108:111], v3, s[4:7], s76 offen offset:3072 sc1
    v_mfma_f32_16x16x32_bf16 v[136:139], a[64:67], a[148:151], v[136:139]
    v_mfma_f32_16x16x32_bf16 v[140:143], a[68:71], a[148:151], v[140:143]
    s_waitcnt vmcnt(11)
    v_mfma_f32_16x16x32_bf16 v[64:67], v[144:147], a[152:155], 0
    v_mfma_f32_16x16x32_bf16 v[68:71], v[148:151], a[152:155], 0
    ds_write_b128 v42, v[124:127] offset:10240
    buffer_load_dwordx4 a[112:115], v4, s[4:7], s76 offen offset:0 sc1
    v_mfma_f32_16x16x32_bf16 v[72:75], v[152:155], a[152:155], 0
    v_mfma_f32_16x16x32_bf16 v[76:79], v[156:159], a[152:155], 0
    v_mfma_f32_16x16x32_bf16 v[80:83], v[160:163], a[152:155], 0
    s_waitcnt vmcnt(11)
    v_mfma_f32_16x16x32_bf16 v[64:67], v[164:167], a[156:159], v[64:67]
    ds_write_b128 v42, v[128:131] offset:11264
    buffer_load_dwordx4 a[116:119], v4, s[4:7], s76 offen offset:1024 sc1
    v_mfma_f32_16x16x32_bf16 v[68:71], v[168:171], a[156:159], v[68:71]
    v_mfma_f32_16x16x32_bf16 v[72:75], v[172:175], a[156:159], v[72:75]
    v_mfma_f32_16x16x32_bf16 v[76:79], v[176:179], a[156:159], v[76:79]
    v_mfma_f32_16x16x32_bf16 v[80:83], v[180:183], a[156:159], v[80:83]
    ds_write_b128 v42, v[132:135] offset:12288
    s_add_u32 m0, s32, 114688
    s_add_u32 s60, s37, 49152
    buffer_load_dwordx4 v1, s[4:7], s60 offen offset:0 sc1 lds
    s_waitcnt vmcnt(12)
    v_mfma_f32_16x16x32_bf16 v[64:67], v[184:187], a[72:75], v[64:67]
    v_mfma_f32_16x16x32_bf16 v[68:71], v[188:191], a[72:75], v[68:71]
    v_mfma_f32_16x16x32_bf16 v[72:75], v[192:195], a[72:75], v[72:75]
    v_mfma_f32_16x16x32_bf16 v[76:79], v[196:199], a[72:75], v[76:79]
    ds_write_b128 v42, v[136:139] offset:13312
    buffer_load_dwordx4 v1, s[4:7], s60 offen offset:1024 sc1 lds
    v_mfma_f32_16x16x32_bf16 v[80:83], v[200:203], a[72:75], v[80:83]
    s_waitcnt vmcnt(12)
    v_mfma_f32_16x16x32_bf16 v[64:67], v[204:207], a[76:79], v[64:67]
    v_mfma_f32_16x16x32_bf16 v[68:71], v[208:211], a[76:79], v[68:71]
    v_mfma_f32_16x16x32_bf16 v[72:75], v[212:215], a[76:79], v[72:75]
    ds_write_b128 v42, v[140:143] offset:14336
    buffer_load_dwordx4 v1, s[4:7], s60 offen offset:2048 sc1 lds
    v_mfma_f32_16x16x32_bf16 v[76:79], v[216:219], a[76:79], v[76:79]
    v_mfma_f32_16x16x32_bf16 v[80:83], v[220:223], a[76:79], v[80:83]
    s_waitcnt vmcnt(12)
    v_mfma_f32_16x16x32_bf16 v[64:67], v[224:227], a[80:83], v[64:67]
    v_mfma_f32_16x16x32_bf16 v[68:71], v[228:231], a[80:83], v[68:71]
    buffer_load_dwordx4 v1, s[4:7], s60 offen offset:3072 sc1 lds
    v_mfma_f32_16x16x32_bf16 v[72:75], v[232:235], a[80:83], v[72:75]
    v_mfma_f32_16x16x32_bf16 v[76:79], v[236:239], a[80:83], v[76:79]
    v_mfma_f32_16x16x32_bf16 v[80:83], v[240:243], a[80:83], v[80:83]
    s_waitcnt lgkmcnt(0)
    s_barrier
    s_waitcnt vmcnt(12)
    v_mfma_f32_16x16x32_bf16 v[64:67], v[244:247], a[84:87], v[64:67]
    s_add_u32 m0, s32, 131072
    s_add_u32 s60, s37, 65536
    buffer_load_dwordx4 v1, s[4:7], s60 offen offset:0 sc1 lds
    v_mfma_f32_16x16x32_bf16 v[68:71], v[248:251], a[84:87], v[68:71]
    ds_read_b128 v[104:107], v15 offset:0
    ds_read_b128 v[108:111], v15 offset:1024
    v_mfma_f32_16x16x32_bf16 v[72:75], a[160:163], a[84:87], v[72:75]
    ds_read_b128 v[112:115], v15 offset:2048
    ds_read_b128 v[116:119], v15 offset:3072
    v_mfma_f32_16x16x32_bf16 v[76:79], a[164:167], a[84:87], v[76:79]
    ds_read_b128 v[120:123], v15 offset:4096
    ds_read_b128 v[124:127], v15 offset:5120
    v_mfma_f32_16x16x32_bf16 v[80:83], a[168:171], a[84:87], v[80:83]
    buffer_load_dwordx4 v1, s[4:7], s60 offen offset:1024 sc1 lds
    ds_read_b128 v[128:131], v15 offset:6144
    s_waitcnt vmcnt(13)
    v_mfma_f32_16x16x32_bf16 v[64:67], a[172:175], a[88:91], v[64:67]
    ds_read_b128 v[132:135], v15 offset:7168
    ds_read_b128 v[136:139], v15 offset:8192
    v_mfma_f32_16x16x32_bf16 v[68:71], a[176:179], a[88:91], v[68:71]
    ds_read_b128 v[140:143], v15 offset:9216
    ds_read_b128 v[44:47], v15 offset:10240
    v_mfma_f32_16x16x32_bf16 v[72:75], a[180:183], a[88:91], v[72:75]
    ds_read_b128 v[48:51], v15 offset:11264
    ds_read_b128 v[52:55], v15 offset:12288
    v_mfma_f32_16x16x32_bf16 v[76:79], a[184:187], a[88:91], v[76:79]
    buffer_load_dwordx4 v1, s[4:7], s60 offen offset:2048 sc1 lds
    ds_read_b128 v[56:59], v15 offset:13312
    v_mfma_f32_16x16x32_bf16 v[80:83], a[188:191], a[88:91], v[80:83]
    ds_read_b128 v[60:63], v15 offset:14336
    s_waitcnt lgkmcnt(14)
    v_add_f32 v84, v84, v104
    s_waitcnt vmcnt(13)
    v_mfma_f32_16x16x32_bf16 v[64:67], a[192:195], a[92:95], v[64:67]
    v_add_f32 v85, v85, v105
    v_add_f32 v86, v86, v106
    v_mfma_f32_16x16x32_bf16 v[68:71], a[196:199], a[92:95], v[68:71]
    v_add_f32 v87, v87, v107
    s_waitcnt lgkmcnt(13)
    v_add_f32 v88, v88, v108
    v_mfma_f32_16x16x32_bf16 v[72:75], a[200:203], a[92:95], v[72:75]
    buffer_load_dwordx4 v1, s[4:7], s60 offen offset:3072 sc1 lds
    v_add_f32 v89, v89, v109
    v_mfma_f32_16x16x32_bf16 v[76:79], a[204:207], a[92:95], v[76:79]
    v_add_f32 v90, v90, v110
    v_add_f32 v91, v91, v111
    v_mfma_f32_16x16x32_bf16 v[80:83], a[208:211], a[92:95], v[80:83]
    s_waitcnt lgkmcnt(12)
    v_add_f32 v92, v92, v112
    s_waitcnt vmcnt(13)
    v_mfma_f32_16x16x32_bf16 v[64:67], a[212:215], a[96:99], v[64:67]
    v_add_f32 v93, v93, v113
    v_add_f32 v94, v94, v114
    v_mfma_f32_16x16x32_bf16 v[68:71], a[216:219], a[96:99], v[68:71]
    s_add_u32 m0, s32, 147456
    s_add_u32 s60, s37, 81920
    buffer_load_dwordx4 v1, s[4:7], s60 offen offset:0 sc1 lds
    v_mfma_f32_16x16x32_bf16 v[72:75], a[220:223], a[96:99], v[72:75]
    v_add_f32 v95, v95, v115
    s_waitcnt lgkmcnt(11)
    v_add_f32 v96, v96, v116
    v_mfma_f32_16x16x32_bf16 v[76:79], a[224:227], a[96:99], v[76:79]
    v_add_f32 v97, v97, v117
    v_add_f32 v98, v98, v118
    v_mfma_f32_16x16x32_bf16 v[80:83], a[228:231], a[96:99], v[80:83]
    v_add_f32 v99, v99, v119
    s_waitcnt lgkmcnt(10)
    v_add_f32 v100, v100, v120
    s_waitcnt vmcnt(13)
    v_mfma_f32_16x16x32_bf16 v[64:67], a[232:235], a[100:103], v[64:67]
    buffer_load_dwordx4 v1, s[4:7], s60 offen offset:1024 sc1 lds
    v_add_f32 v101, v101, v121
    v_mfma_f32_16x16x32_bf16 v[68:71], a[236:239], a[100:103], v[68:71]
    v_add_f32 v102, v102, v122
    v_add_f32 v103, v103, v123
    v_mfma_f32_16x16x32_bf16 v[72:75], a[240:243], a[100:103], v[72:75]
    s_waitcnt lgkmcnt(9)
    v_add_f32 v84, v84, v124
    v_mfma_f32_16x16x32_bf16 v[76:79], a[244:247], a[100:103], v[76:79]
    v_add_f32 v85, v85, v125
    v_add_f32 v86, v86, v126
    v_mfma_f32_16x16x32_bf16 v[80:83], a[248:251], a[100:103], v[80:83]
    buffer_load_dwordx4 v1, s[4:7], s60 offen offset:2048 sc1 lds
    v_add_f32 v87, v87, v127
    s_waitcnt vmcnt(14)
    v_mfma_f32_16x16x32_bf16 v[64:67], a[252:255], a[104:107], v[64:67]
    s_waitcnt lgkmcnt(8)
    v_add_f32 v88, v88, v128
    v_mfma_f32_16x16x32_bf16 v[68:71], v[252:255], a[104:107], v[68:71]
    v_add_f32 v89, v89, v129
    v_add_f32 v90, v90, v130
    v_mfma_f32_16x16x32_bf16 v[72:75], a[0:3], a[104:107], v[72:75]
    v_add_f32 v91, v91, v131
    s_waitcnt lgkmcnt(7)
    v_add_f32 v92, v92, v132
    v_mfma_f32_16x16x32_bf16 v[76:79], a[4:7], a[104:107], v[76:79]
    buffer_load_dwordx4 v1, s[4:7], s60 offen offset:3072 sc1 lds
    v_add_f32 v93, v93, v133
    v_mfma_f32_16x16x32_bf16 v[80:83], a[8:11], a[104:107], v[80:83]
    v_add_f32 v94, v94, v134
    v_add_f32 v95, v95, v135
    s_waitcnt vmcnt(14)
    v_mfma_f32_16x16x32_bf16 v[64:67], a[12:15], a[108:111], v[64:67]
    s_waitcnt lgkmcnt(6)
    v_add_f32 v96, v96, v136
    v_mfma_f32_16x16x32_bf16 v[68:71], a[16:19], a[108:111], v[68:71]
    v_add_f32 v97, v97, v137
    v_add_f32 v98, v98, v138
    v_mfma_f32_16x16x32_bf16 v[72:75], a[20:23], a[108:111], v[72:75]
    s_add_u32 m0, s32, 65536
    s_add_u32 s60, s37, 0
    buffer_load_dwordx4 v1, s[4:7], s60 offen offset:0 sc1 lds
    v_mfma_f32_16x16x32_bf16 v[76:79], a[24:27], a[108:111], v[76:79]
    v_add_f32 v99, v99, v139
    s_waitcnt lgkmcnt(5)
    v_add_f32 v100, v100, v140
    v_mfma_f32_16x16x32_bf16 v[80:83], a[28:31], a[108:111], v[80:83]
    v_add_f32 v101, v101, v141
    v_add_f32 v102, v102, v142
    s_waitcnt vmcnt(14)
    v_mfma_f32_16x16x32_bf16 v[64:67], a[32:35], a[112:115], v[64:67]
    v_add_f32 v103, v103, v143
    s_waitcnt lgkmcnt(4)
    v_add_f32 v84, v84, v44
    v_mfma_f32_16x16x32_bf16 v[68:71], a[36:39], a[112:115], v[68:71]
    v_add_f32 v85, v85, v45
    v_add_f32 v86, v86, v46
    v_mfma_f32_16x16x32_bf16 v[72:75], a[40:43], a[112:115], v[72:75]
    v_add_f32 v87, v87, v47
    s_waitcnt lgkmcnt(3)
    v_add_f32 v88, v88, v48
    v_mfma_f32_16x16x32_bf16 v[76:79], a[44:47], a[112:115], v[76:79]
    v_add_f32 v89, v89, v49
    v_add_f32 v90, v90, v50
    v_mfma_f32_16x16x32_bf16 v[80:83], a[48:51], a[112:115], v[80:83]
    v_add_f32 v91, v91, v51
    s_waitcnt lgkmcnt(2)
    v_add_f32 v92, v92, v52
    s_waitcnt vmcnt(13)
    v_mfma_f32_16x16x32_bf16 v[64:67], a[52:55], a[116:119], v[64:67]
    v_add_f32 v93, v93, v53
    v_add_f32 v94, v94, v54
    v_mfma_f32_16x16x32_bf16 v[68:71], a[56:59], a[116:119], v[68:71]
    v_add_f32 v95, v95, v55
    s_waitcnt lgkmcnt(1)
    v_add_f32 v96, v96, v56
    v_mfma_f32_16x16x32_bf16 v[72:75], a[60:63], a[116:119], v[72:75]
    v_add_f32 v97, v97, v57
    v_add_f32 v98, v98, v58
    v_mfma_f32_16x16x32_bf16 v[76:79], a[64:67], a[116:119], v[76:79]
    v_add_f32 v99, v99, v59
    s_waitcnt lgkmcnt(0)
    v_add_f32 v100, v100, v60
    v_mfma_f32_16x16x32_bf16 v[80:83], a[68:71], a[116:119], v[80:83]
    v_add_f32 v101, v101, v61
    v_add_f32 v102, v102, v62
    v_add_f32 v103, v103, v63
    v_pk_add_f32 v[84:85], v[84:85], v[64:65]
    v_pk_add_f32 v[86:87], v[86:87], v[66:67]
    v_pk_add_f32 v[88:89], v[88:89], v[68:69]
    v_pk_add_f32 v[90:91], v[90:91], v[70:71]
    v_pk_add_f32 v[92:93], v[92:93], v[72:73]
    v_pk_add_f32 v[94:95], v[94:95], v[74:75]
    v_pk_add_f32 v[96:97], v[96:97], v[76:77]
    v_pk_add_f32 v[98:99], v[98:99], v[78:79]
    v_pk_add_f32 v[100:101], v[100:101], v[80:81]
    v_pk_add_f32 v[102:103], v[102:103], v[82:83]
    v_cvt_pk_bf16_f32 v104, v84, v85
    v_cvt_pk_bf16_f32 v105, v86, v87
    v_cvt_pk_bf16_f32 v106, v88, v89
    v_cvt_pk_bf16_f32 v107, v90, v91
    v_cvt_pk_bf16_f32 v108, v92, v93
    v_cvt_pk_bf16_f32 v109, v94, v95
    v_cvt_pk_bf16_f32 v110, v96, v97
    v_cvt_pk_bf16_f32 v111, v98, v99
    v_cvt_pk_bf16_f32 v112, v100, v101
    v_cvt_pk_bf16_f32 v113, v102, v103
    s_cmp_eq_u32 s23, 0
    s_cbranch_scc1 notlast_33
    v_and_b32 v114, 15, v0
    v_mul_u32_u24 v114, 1280, v114
    v_bfe_u32 v115, v0, 4, 2
    v_mad_u32_u24 v114, v115, 40, v114
    buffer_store_dwordx4 v[104:107], v114, s[12:15], s51 offen
    buffer_store_dwordx4 v[108:111], v114, s[12:15], s51 offen offset:16
    buffer_store_dwordx2 v[112:113], v114, s[12:15], s51 offen offset:32
    s_endpgm
notlast_33:
    s_nop 1
    s_add_u32 s61, s41, 10362880
    s_add_u32 s62, s42, 12984320
    s_add_u32 s63, s43, 22855680
    buffer_store_dwordx4 v[104:107], v12, s[4:7], s61 offen
    buffer_store_dwordx4 v[108:111], v12, s[4:7], s61 offen offset:2048
    buffer_store_dwordx2 v[112:113], v13, s[4:7], s61 offen
    v_dot2_f32_bf16 v116, s30, v104, 0
    v_dot2_f32_bf16 v117, v104, v104, 0
    v_dot2_f32_bf16 v118, s30, v105, 0
    v_dot2_f32_bf16 v119, v105, v105, 0
    v_dot2c_f32_bf16 v116, s30, v106
    v_dot2c_f32_bf16 v117, v106, v106
    v_dot2c_f32_bf16 v118, s30, v107
    v_dot2c_f32_bf16 v119, v107, v107
    v_dot2c_f32_bf16 v116, s30, v108
    v_dot2c_f32_bf16 v117, v108, v108
    v_dot2c_f32_bf16 v118, s30, v109
    v_dot2c_f32_bf16 v119, v109, v109
    v_dot2c_f32_bf16 v116, s30, v110
    v_dot2c_f32_bf16 v117, v110, v110
    v_dot2c_f32_bf16 v118, s30, v111
    v_dot2c_f32_bf16 v119, v111, v111
    v_dot2c_f32_bf16 v116, s30, v112
    v_dot2c_f32_bf16 v117, v112, v112
    v_dot2c_f32_bf16 v118, s30, v113
    v_dot2c_f32_bf16 v119, v113, v113
    s_nop 2
    v_pk_add_f32 v[116:117], v[116:117], v[118:119]
    s_nop 1
    v_permlane32_swap_b32 v116, v117
    v_add_f32 v116, v116, v117
    v_mov_b32 v117, v116
    s_nop 1
    v_permlane16_swap_b32 v116, v117
    v_add_f32 v116, v116, v117
    buffer_store_dword v116, v14, s[4:7], s62 offen
    s_waitcnt vmcnt(0)
    s_cmp_lg_u32 s24, 0
    s_cbranch_scc1 pubf_34
    buffer_wbl2 sc1
    s_waitcnt vmcnt(0)
    buffer_store_dword v6, v5, s[4:7], s63 offen sc1
    s_branch pubd_35
pubf_34:
    buffer_store_dword v6, v5, s[4:7], s63 offen
pubd_35:
    buffer_load_dwordx4 v1, s[4:7], s60 offen offset:1024 sc1 lds
    buffer_load_dwordx4 v1, s[4:7], s60 offen offset:2048 sc1 lds
    buffer_load_dwordx4 v1, s[4:7], s60 offen offset:3072 sc1 lds
    s_add_u32 m0, s32, 81920
    s_add_u32 s60, s37, 16384
    buffer_load_dwordx4 v1, s[4:7], s60 offen offset:0 sc1 lds
    buffer_load_dwordx4 v1, s[4:7], s60 offen offset:1024 sc1 lds
    buffer_load_dwordx4 v1, s[4:7], s60 offen offset:2048 sc1 lds
    buffer_load_dwordx4 v1, s[4:7], s60 offen offset:3072 sc1 lds
    s_add_u32 s36, s36, 16384
    s_add_u32 s43, s43, 16384
    s_add_u32 s45, s45, 4096
    s_add_u32 s49, s49, 4096
    s_add_u32 s50, s50, 4096
    s_add_u32 s47, s47, 888832
    s_add_u32 s48, s48, 888832
    s_mov_b32 s23, 1
    s_branch interleave_layers__linear_kernel_hedgehog__geglu_ffn__prompt_kernel_layer
interleave_layers__linear_kernel_hedgehog__geglu_ffn__prompt_kernel_end:
    s_endpgm
.section .rodata,"a"
.p2align 6
.amdhsa_kernel interleave_layers__linear_kernel_hedgehog__geglu_ffn__prompt_kernel
  .amdhsa_next_free_vgpr 512
  .amdhsa_next_free_sgpr 102
  .amdhsa_accum_offset 256
  .amdhsa_group_segment_fixed_size 0
  .amdhsa_kernarg_size 88
  .amdhsa_user_sgpr_count 2
  .amdhsa_user_sgpr_kernarg_segment_ptr 1
  .amdhsa_system_sgpr_workgroup_id_x 1
  .amdhsa_float_denorm_mode_32 3
.end_amdhsa_kernel
```
